```python
import torch

def _softmax(x, axis=-1):
    return torch.softmax(x, dim=axis)
def _gelu(x):
    return torch.nn.functional.gelu(x, approximate="tanh")
def _silu(x):
    return torch.nn.functional.silu(x)
def _sigmoid(x):
    return torch.sigmoid(x)
def _layernorm(x, axis=-1, eps=1e-5):
    m = x.mean(dim=axis, keepdim=True)
    v = x.var(dim=axis, keepdim=True, unbiased=False)
    return (x - m) / torch.sqrt(v + eps)
def _scatter_add(tgt, idx, src, axis=0):
    return tgt.clone().index_add_(axis, idx, src)
def _segment_sum(src, seg, n):
    out = torch.zeros((n,) + src.shape[1:], dtype=src.dtype)
    return out.index_add_(0, seg, src)
def _pad(x, pw):
    flat = tuple(v for pair in reversed(pw) for v in pair)
    return torch.nn.functional.pad(x, flat)

kernel_name = 'recurrent_scan__gqa_block_cached__mixer_token_mlp__prompt'

def setup_inputs():

    _w = (lambda a: (lambda t: t.to(torch.bfloat16) if t.is_floating_point() else t)(torch.as_tensor(a)))
    def _A_setup():
        B, Sq, D = 1, 2048, 640
        Hq, Hkv, Sk, Dh = 32, 32, 2048, 128
        assert Hq % Hkv == 0, (Hq, Hkv)
        return {
            "x": _w((lambda *s: torch.randn(*s, dtype=torch.bfloat16) * 0.1)(B, Sq, D)),
            "k_cache": _w((lambda *s: torch.randn(*s, dtype=torch.bfloat16) * 0.8)(B, Hkv, Sk, Dh)),
            "v_cache": _w((lambda *s: torch.randn(*s, dtype=torch.bfloat16) * 3.2)(B, Hkv, Sk, Dh)),
            "wq": _w((lambda *s: torch.randn(*s, dtype=torch.bfloat16) * 0.8)(D, Hq * Dh) * (D ** -0.5)),
            "wo": _w((lambda *s: torch.randn(*s, dtype=torch.bfloat16) * 3.2)(Hq * Dh, D) * ((Hq * Dh) ** -0.5)),
        }
    _A_in = _A_setup()

    def _B_setup():
        B, S, D, F = 1, 2048, 640, 1728
        return {
            "x": _w((lambda *s: torch.randn(*s, dtype=torch.bfloat16) * 0.1)(B, S, D)),
            "w1": _w((lambda *s: torch.randn(*s, dtype=torch.bfloat16) * 3.2)(S, F) * (S ** -0.5)),
            "b1": _w((lambda *s: torch.randn(*s, dtype=torch.bfloat16) * 3.2)(F) * 0.02),
            "w2": _w((lambda *s: torch.randn(*s, dtype=torch.bfloat16) * 3.2)(F, S) * (F ** -0.5)),
            "b2": _w((lambda *s: torch.randn(*s, dtype=torch.bfloat16) * 3.2)(S) * 0.02),
        }
    _B_in = _B_setup()

    return {
        "A_x": _A_in["x"],
        "A_k_cache": _A_in["k_cache"],
        "A_v_cache": _A_in["v_cache"],
        "A_wq": _A_in["wq"],
        "A_wo": _A_in["wo"],
        "B_x": _B_in["x"],
        "B_w1": _B_in["w1"],
        "B_b1": _B_in["b1"],
        "B_w2": _B_in["w2"],
        "B_b2": _B_in["b2"],
    }

def reference(A_x, A_k_cache, A_v_cache, A_wq, A_wo, B_x, B_w1, B_b1, B_w2, B_b2):
    def _A_ref(x, k_cache, v_cache, wq, wo):
        B, Sq, D = x.shape
        Hq, Dh = 32, 128
        Hkv = k_cache.shape[1]
        rep = Hq // Hkv
        q = (lambda x, *d: x.permute(*d))((x @ wq).reshape(B, Sq, Hq, Dh), 0, 2, 1, 3)
        k = (lambda x, n, axis: torch.repeat_interleave(x, n, dim=axis))(k_cache, rep, axis=1)
        v = (lambda x, n, axis: torch.repeat_interleave(x, n, dim=axis))(v_cache, rep, axis=1)
        scores = torch.einsum("bhqd,bhkd->bhqk", q, k) * (Dh ** -0.5)
        p = _softmax(scores, axis=-1)
        o = torch.einsum("bhqk,bhkd->bhqd", p, v)
        return (lambda x, *d: x.permute(*d))(o, 0, 2, 1, 3).reshape(B, Sq, Hq * Dh) @ wo

    def _B_ref(x, w1, b1, w2, b2):
        B, S, D = x.shape
        h = _layernorm(x, axis=-1)
        u = torch.einsum("bsd,sf->bdf", h, w1) + b1
        u = _gelu(u)
        y = torch.einsum("bdf,fs->bds", u, w2) + b2
        return (lambda x, *d: x.permute(*d))(y, 0, 2, 1)

    x = A_x
    xn = _layernorm(x, axis=-1)
    s = _A_ref(xn, A_k_cache, A_v_cache, A_wq, A_wo)
    g = _silu(_B_ref(xn, B_w1, B_b1, B_w2, B_b2))
    return x + s * g
```

```asm
; @launch grid=(256,1,1) block=(256,1,1) lds=163840
.amdgcn_target "amdgcn-amd-amdhsa--gfx950"
.text
.globl recurrent_scan__gqa_block_cached__mixer_token_mlp__prompt_kernel
.p2align 8
.type recurrent_scan__gqa_block_cached__mixer_token_mlp__prompt_kernel,@function
recurrent_scan__gqa_block_cached__mixer_token_mlp__prompt_kernel:
s_cmp_ge_u32 s2, 256
s_cbranch_scc1 L_done
s_load_dwordx16 s[60:75], s[0:1], 0
s_load_dwordx8 s[76:83], s[0:1], 64
s_load_dwordx2 s[84:85], s[0:1], 96
s_getpc_b64 s[92:93]
L_pc:
s_lshr_b32 s94, s2, 3
v_lshrrev_b32 v4, 3, v0
v_lshl_add_u32 v4, s94, 5, v4
v_lshlrev_b32 v4, 7, v4
v_min_u32 v4, (L_end-L_pc-4), v4
v_mov_b32 v5, s93
v_add_co_u32 v4, vcc, s92, v4
s_nop 1
v_addc_co_u32 v5, vcc, 0, v5, vcc
global_load_dword v198, v[4:5], off
v_lshrrev_b32 v60, 6, v0
v_and_b32 v61, 63, v0
v_readfirstlane_b32 s40, v60
v_lshlrev_b32 v1, 4, v61
v_lshrrev_b32 v161, 5, v0
v_and_b32 v162, 31, v0
v_mul_u32_u24 v160, 1280, v161
v_lshl_add_u32 v160, v162, 3, v160
s_mul_i32 s95, s2, 10240
s_and_b32 s86, s2, 7
s_lshr_b32 s87, s2, 3
s_lshl_b32 s88, s86, 2
s_lshr_b32 s92, s2, 6
s_add_u32 s88, s88, s92
s_and_b32 s89, s87, 7
v_lshrrev_b32 v62, 4, v61
v_and_b32 v59, 15, v61
s_lshl_b32 s92, s40, 4
v_add_u32 v60, s92, v62
v_lshrrev_b32 v20, 3, v61
v_mul_u32_u24 v20, 1280, v20
v_and_b32 v21, 7, v61
v_xor_b32 v21, v21, v62
v_xor_b32 v22, 0, v21
v_lshl_add_u32 v22, v22, 4, v20
v_add_u32 v32, 0, v22
v_xor_b32 v22, 4, v21
v_lshl_add_u32 v22, v22, 4, v20
v_add_u32 v33, 9216, v22
v_xor_b32 v22, 0, v21
v_lshl_add_u32 v22, v22, 4, v20
v_add_u32 v34, 18432, v22
v_xor_b32 v22, 4, v21
v_lshl_add_u32 v22, v22, 4, v20
v_add_u32 v35, 27648, v22
v_lshlrev_b32 v20, 2, v62
v_xor_b32 v20, v20, v59
v_lshlrev_b32 v20, 4, v20
v_mul_u32_u24 v21, 8192, v60
v_add_u32 v20, v21, v20
v_add_u32 v28, 0, v20
v_add_u32 v29, 31744, v20
v_add_u32 v30, 63488, v20
v_add_u32 v31, 95232, v20
s_lshl_b32 s47, s40, 13
s_lshl_b32 s92, s40, 12
s_add_u32 s48, s92, 0
s_add_u32 s52, s92, 65536
s_add_u32 s49, s92, 16384
s_add_u32 s53, s92, 81920
s_add_u32 s50, s92, 32768
s_add_u32 s54, s92, 98304
s_add_u32 s51, s92, 49152
s_add_u32 s55, s92, 114688
s_waitcnt lgkmcnt(0)
s_mov_b32 s36, s60
s_mov_b32 s37, s61
s_mov_b32 s38, 2621440
s_mov_b32 s39, 0x20000
buffer_load_dwordx2 v[64:65], v160, s[36:39], s95 offen offset:0
buffer_load_dwordx2 v[66:67], v160, s[36:39], s95 offen offset:256
buffer_load_dwordx2 v[68:69], v160, s[36:39], s95 offen offset:512
buffer_load_dwordx2 v[70:71], v160, s[36:39], s95 offen offset:768
buffer_load_dwordx2 v[72:73], v160, s[36:39], s95 offen offset:1024
s_lshl_b32 s92, s89, 2
s_add_u32 s92, s92, s40
s_mul_i32 s92, s92, 81920
s_add_u32 s4, s60, s92
s_addc_u32 s5, s61, 0
s_mov_b32 s6, 81920
s_mov_b32 s7, 0x20000
s_lshl_b32 s92, s88, 8
s_add_u32 s8, s66, s92
s_addc_u32 s9, s67, 0
s_mov_b32 s10, 5234944
s_mov_b32 s11, 0x20000
s_add_u32 s92, s88, s89
s_and_b32 s92, s92, 3
s_mov_b32 s70, 0x65832140
s_mov_b32 s71, 0x97
s_cmp_eq_u32 s92, 1
s_cselect_b32 s70, 0x69432501, s70
s_cselect_b32 s71, 0x87, s71
s_cmp_eq_u32 s92, 2
s_cselect_b32 s70, 0x75436102, s70
s_cselect_b32 s71, 0x98, s71
s_cmp_eq_u32 s92, 3
s_cselect_b32 s70, 0x65472103, s70
s_cselect_b32 s71, 0x98, s71
s_bfe_u32 s43, s70, 0x40000
s_mul_i32 s43, s43, 128
s_add_u32 m0, s47, 0
s_nop 0
buffer_load_dwordx4 v32, s[4:7], s43 offen offset:0 lds
buffer_load_dwordx4 v33, s[4:7], s43 offen offset:1024 lds
buffer_load_dwordx4 v34, s[4:7], s43 offen offset:2048 lds
buffer_load_dwordx4 v35, s[4:7], s43 offen offset:3072 lds
s_add_u32 s43, s43, 40960
s_add_u32 m0, s47, 4096
s_nop 0
buffer_load_dwordx4 v32, s[4:7], s43 offen offset:0 lds
buffer_load_dwordx4 v33, s[4:7], s43 offen offset:1024 lds
buffer_load_dwordx4 v34, s[4:7], s43 offen offset:2048 lds
buffer_load_dwordx4 v35, s[4:7], s43 offen offset:3072 lds
s_bfe_u32 s42, s70, 0x40000
s_mul_i32 s42, s42, 524288
s_mov_b32 m0, s52
s_nop 0
buffer_load_dwordx4 v28, s[8:11], s42 offen offset:0 lds
buffer_load_dwordx4 v29, s[8:11], s42 offen offset:1024 lds
buffer_load_dwordx4 v30, s[8:11], s42 offen offset:2048 lds
buffer_load_dwordx4 v31, s[8:11], s42 offen offset:3072 lds
v_mul_u32_u24 v160, 1296, v161
v_lshl_add_u32 v160, v162, 3, v160
v_add_u32 v160, 114688, v160
v_min_u32 v162, 1, v162
v_lshlrev_b32 v162, 31, v162
v_lshl_add_u32 v161, v161, 3, v162
s_lshl_b32 s92, s2, 7
s_add_u32 s92, s92, 0
s_add_u32 s20, s84, s92
s_addc_u32 s21, s85, 0
s_mov_b32 s22, 64
s_mov_b32 s23, 0x20000
v_lshrrev_b32 v40, 2, v59
v_mul_u32_u24 v40, 1296, v40
v_and_b32 v41, 3, v0
v_lshl_add_u32 v40, v41, 3, v40
v_add_u32 v40, 114688, v40
v_lshrrev_b32 v41, 4, v0
v_lshl_add_u32 v165, v41, 5, v40
v_and_b32 v42, 1, v62
s_lshl_b32 s92, s40, 1
s_add_u32 s92, s92, 32
v_add_u32 v42, s92, v42
v_lshl_add_u32 v166, v42, 5, v40
v_add_u32 v43, 0, v41
v_mul_u32_u24 v44, 52, v43
v_lshrrev_b32 v44, 8, v44
v_mul_u32_u24 v45, 5, v44
v_sub_u32 v45, v43, v45
v_mul_u32_u24 v44, 327680, v44
v_lshl_add_u32 v44, v45, 10, v44
v_lshl_add_u32 v167, v59, 4, v44
v_add_u32 v43, 16, v41
v_mul_u32_u24 v44, 52, v43
v_lshrrev_b32 v44, 8, v44
v_mul_u32_u24 v45, 5, v44
v_sub_u32 v45, v43, v45
v_mul_u32_u24 v44, 327680, v44
v_lshl_add_u32 v44, v45, 10, v44
v_lshl_add_u32 v168, v59, 4, v44
v_mov_b32 v43, v42
v_mul_u32_u24 v44, 52, v43
v_lshrrev_b32 v44, 8, v44
v_mul_u32_u24 v45, 5, v44
v_sub_u32 v45, v43, v45
v_mul_u32_u24 v44, 327680, v44
v_lshl_add_u32 v44, v45, 10, v44
v_lshl_add_u32 v169, v59, 4, v44
v_lshrrev_b32 v43, 5, v61
v_lshl_add_u32 v169, v43, 31, v169
s_lshr_b32 s92, s2, 2
s_mul_i32 s92, s92, 5120
s_and_b32 s93, s2, 3
s_lshl_b32 s93, s93, 8
s_add_u32 s92, s92, s93
s_add_u32 s92, s92, 4194304
s_add_u32 s28, s84, s92
s_addc_u32 s29, s85, 0
s_mov_b32 s30, 2298112
s_mov_b32 s31, 0x20000
s_add_u32 s56, s84, 65536
s_addc_u32 s57, s85, 0
s_mov_b32 s58, 6144
s_mov_b32 s59, 0x20000
s_load_dword s82, s[84:85], 65536
v_lshrrev_b32 v20, 2, v59
v_lshl_add_u32 v21, v62, 3, v20
v_lshlrev_b32 v21, 8, v21
v_and_b32 v22, 3, v59
v_lshl_add_u32 v21, v22, 4, v21
v_add_u32 v21, 65536, v21
v_xor_b32 v23, s40, v20
v_lshl_add_u32 v204, v23, 6, v21
v_xor_b32 v23, 0, v20
v_lshl_add_u32 v24, v23, 6, v21
v_xor_b32 v23, 1, v20
v_lshl_add_u32 v25, v23, 6, v21
v_xor_b32 v23, 2, v20
v_lshl_add_u32 v26, v23, 6, v21
v_xor_b32 v23, 3, v20
v_lshl_add_u32 v27, v23, 6, v21
v_lshrrev_b32 v23, 1, v59
v_xor_b32 v23, v23, v62
v_lshlrev_b32 v21, 7, v59
v_add_u32 v21, s47, v21
v_xor_b32 v40, 0, v23
v_lshl_add_u32 v41, v40, 4, v21
v_xor_b32 v40, 4, v23
v_lshl_add_u32 v42, v40, 4, v21
v_mov_b32 v208, v61
v_mov_b32 v209, v62
v_add_u32 v61, 131072, v41
v_add_u32 v62, 131072, v42
s_waitcnt vmcnt(16)
v_lshlrev_b32 v80, 16, v64
v_and_b32 v81, 0xffff0000, v64
v_lshlrev_b32 v82, 16, v65
v_and_b32 v83, 0xffff0000, v65
s_waitcnt vmcnt(15)
v_lshlrev_b32 v84, 16, v66
v_and_b32 v85, 0xffff0000, v66
v_lshlrev_b32 v86, 16, v67
v_and_b32 v87, 0xffff0000, v67
s_waitcnt vmcnt(14)
v_lshlrev_b32 v88, 16, v68
v_and_b32 v89, 0xffff0000, v68
v_lshlrev_b32 v90, 16, v69
v_and_b32 v91, 0xffff0000, v69
s_waitcnt vmcnt(13)
v_lshlrev_b32 v92, 16, v70
v_and_b32 v93, 0xffff0000, v70
v_lshlrev_b32 v94, 16, v71
v_and_b32 v95, 0xffff0000, v71
s_waitcnt vmcnt(12)
v_lshlrev_b32 v96, 16, v72
v_and_b32 v97, 0xffff0000, v72
v_lshlrev_b32 v98, 16, v73
v_and_b32 v99, 0xffff0000, v73
v_pk_add_f32 v[100:101], v[80:81], v[82:83]
v_pk_add_f32 v[102:103], v[84:85], v[86:87]
v_pk_add_f32 v[100:101], v[100:101], v[88:89]
v_pk_add_f32 v[102:103], v[102:103], v[90:91]
v_pk_add_f32 v[100:101], v[100:101], v[92:93]
v_pk_add_f32 v[102:103], v[102:103], v[94:95]
v_pk_add_f32 v[100:101], v[100:101], v[96:97]
v_pk_add_f32 v[102:103], v[102:103], v[98:99]
v_pk_add_f32 v[100:101], v[100:101], v[102:103]
v_add_f32 v100, v100, v101
s_nop 1
v_add_f32_dpp v100, v100, v100 quad_perm:[1,0,3,2] row_mask:0xf bank_mask:0xf
s_nop 1
v_add_f32_dpp v100, v100, v100 quad_perm:[2,3,0,1] row_mask:0xf bank_mask:0xf
s_nop 1
v_add_f32_dpp v100, v100, v100 row_half_mirror row_mask:0xf bank_mask:0xf
s_nop 1
v_add_f32_dpp v100, v100, v100 row_mirror row_mask:0xf bank_mask:0xf
v_mov_b32 v101, v100
s_nop 1
v_permlane16_swap_b32 v100, v101
v_add_f32 v100, v100, v101
v_mul_f32 v100, 0xbacccccd, v100
v_mov_b32 v64, v100
v_pk_add_f32 v[80:81], v[80:81], v[100:101] op_sel_hi:[1,0]
v_pk_add_f32 v[82:83], v[82:83], v[100:101] op_sel_hi:[1,0]
v_pk_add_f32 v[84:85], v[84:85], v[100:101] op_sel_hi:[1,0]
v_pk_add_f32 v[86:87], v[86:87], v[100:101] op_sel_hi:[1,0]
v_pk_add_f32 v[88:89], v[88:89], v[100:101] op_sel_hi:[1,0]
v_pk_add_f32 v[90:91], v[90:91], v[100:101] op_sel_hi:[1,0]
v_pk_add_f32 v[92:93], v[92:93], v[100:101] op_sel_hi:[1,0]
v_pk_add_f32 v[94:95], v[94:95], v[100:101] op_sel_hi:[1,0]
v_pk_add_f32 v[96:97], v[96:97], v[100:101] op_sel_hi:[1,0]
v_pk_add_f32 v[98:99], v[98:99], v[100:101] op_sel_hi:[1,0]
v_pk_mul_f32 v[100:101], v[80:81], v[80:81]
v_pk_mul_f32 v[102:103], v[82:83], v[82:83]
v_pk_fma_f32 v[100:101], v[84:85], v[84:85], v[100:101]
v_pk_fma_f32 v[102:103], v[86:87], v[86:87], v[102:103]
v_pk_fma_f32 v[100:101], v[88:89], v[88:89], v[100:101]
v_pk_fma_f32 v[102:103], v[90:91], v[90:91], v[102:103]
v_pk_fma_f32 v[100:101], v[92:93], v[92:93], v[100:101]
v_pk_fma_f32 v[102:103], v[94:95], v[94:95], v[102:103]
v_pk_fma_f32 v[100:101], v[96:97], v[96:97], v[100:101]
v_pk_fma_f32 v[102:103], v[98:99], v[98:99], v[102:103]
v_pk_add_f32 v[100:101], v[100:101], v[102:103]
v_add_f32 v100, v100, v101
s_nop 1
v_add_f32_dpp v100, v100, v100 quad_perm:[1,0,3,2] row_mask:0xf bank_mask:0xf
s_nop 1
v_add_f32_dpp v100, v100, v100 quad_perm:[2,3,0,1] row_mask:0xf bank_mask:0xf
s_nop 1
v_add_f32_dpp v100, v100, v100 row_half_mirror row_mask:0xf bank_mask:0xf
s_nop 1
v_add_f32_dpp v100, v100, v100 row_mirror row_mask:0xf bank_mask:0xf
v_mov_b32 v101, v100
s_nop 1
v_permlane16_swap_b32 v100, v101
v_add_f32 v100, v100, v101
v_mul_f32 v100, 0x3acccccd, v100
v_add_f32 v100, 0x3727c5ac, v100
v_rsq_f32 v100, v100
s_nop 0
v_mul_f32 v65, 0x3e0293ee, v100
buffer_store_dwordx2 v[64:65], v161, s[20:23], 0 offen sc1
v_pk_mul_f32 v[140:141], v[80:81], v[100:101] op_sel_hi:[1,0]
v_pk_mul_f32 v[142:143], v[82:83], v[100:101] op_sel_hi:[1,0]
v_pk_mul_f32 v[144:145], v[84:85], v[100:101] op_sel_hi:[1,0]
v_pk_mul_f32 v[146:147], v[86:87], v[100:101] op_sel_hi:[1,0]
v_pk_mul_f32 v[148:149], v[88:89], v[100:101] op_sel_hi:[1,0]
v_pk_mul_f32 v[150:151], v[90:91], v[100:101] op_sel_hi:[1,0]
v_pk_mul_f32 v[152:153], v[92:93], v[100:101] op_sel_hi:[1,0]
v_pk_mul_f32 v[154:155], v[94:95], v[100:101] op_sel_hi:[1,0]
v_pk_mul_f32 v[156:157], v[96:97], v[100:101] op_sel_hi:[1,0]
v_pk_mul_f32 v[158:159], v[98:99], v[100:101] op_sel_hi:[1,0]
v_cvt_pk_bf16_f32 v104, v140, v141
v_cvt_pk_bf16_f32 v105, v142, v143
v_cvt_pk_bf16_f32 v106, v144, v145
v_cvt_pk_bf16_f32 v107, v146, v147
v_cvt_pk_bf16_f32 v108, v148, v149
v_cvt_pk_bf16_f32 v109, v150, v151
v_cvt_pk_bf16_f32 v110, v152, v153
v_cvt_pk_bf16_f32 v111, v154, v155
v_cvt_pk_bf16_f32 v112, v156, v157
v_cvt_pk_bf16_f32 v113, v158, v159
v_lshlrev_b32 v80, 16, v104
v_and_b32 v81, 0xffff0000, v104
v_lshlrev_b32 v82, 16, v105
v_and_b32 v83, 0xffff0000, v105
v_lshlrev_b32 v84, 16, v106
v_and_b32 v85, 0xffff0000, v106
v_lshlrev_b32 v86, 16, v107
v_and_b32 v87, 0xffff0000, v107
v_lshlrev_b32 v88, 16, v108
v_and_b32 v89, 0xffff0000, v108
v_lshlrev_b32 v90, 16, v109
v_and_b32 v91, 0xffff0000, v109
v_lshlrev_b32 v92, 16, v110
v_and_b32 v93, 0xffff0000, v110
v_lshlrev_b32 v94, 16, v111
v_and_b32 v95, 0xffff0000, v111
v_lshlrev_b32 v96, 16, v112
v_and_b32 v97, 0xffff0000, v112
v_lshlrev_b32 v98, 16, v113
v_and_b32 v99, 0xffff0000, v113
v_pk_add_f32 v[100:101], v[80:81], v[82:83]
v_pk_add_f32 v[102:103], v[84:85], v[86:87]
v_pk_add_f32 v[100:101], v[100:101], v[88:89]
v_pk_add_f32 v[102:103], v[102:103], v[90:91]
v_pk_add_f32 v[100:101], v[100:101], v[92:93]
v_pk_add_f32 v[102:103], v[102:103], v[94:95]
v_pk_add_f32 v[100:101], v[100:101], v[96:97]
v_pk_add_f32 v[102:103], v[102:103], v[98:99]
s_bfe_u32 s43, s70, 0x40004
s_mul_i32 s43, s43, 128
s_add_u32 m0, s47, 32768
s_nop 0
buffer_load_dwordx4 v32, s[4:7], s43 offen offset:0 lds
v_pk_add_f32 v[100:101], v[100:101], v[102:103]
v_add_f32 v100, v100, v101
s_nop 1
v_add_f32_dpp v100, v100, v100 quad_perm:[1,0,3,2] row_mask:0xf bank_mask:0xf
s_nop 1
v_add_f32_dpp v100, v100, v100 quad_perm:[2,3,0,1] row_mask:0xf bank_mask:0xf
s_nop 1
v_add_f32_dpp v100, v100, v100 row_half_mirror row_mask:0xf bank_mask:0xf
buffer_load_dwordx4 v33, s[4:7], s43 offen offset:1024 lds
s_nop 0
v_add_f32_dpp v100, v100, v100 row_mirror row_mask:0xf bank_mask:0xf
v_mov_b32 v101, v100
s_nop 1
v_permlane16_swap_b32 v100, v101
v_add_f32 v100, v100, v101
v_mul_f32 v100, 0xbacccccd, v100
buffer_load_dwordx4 v34, s[4:7], s43 offen offset:2048 lds
v_pk_add_f32 v[80:81], v[80:81], v[100:101] op_sel_hi:[1,0]
v_pk_add_f32 v[82:83], v[82:83], v[100:101] op_sel_hi:[1,0]
v_pk_add_f32 v[84:85], v[84:85], v[100:101] op_sel_hi:[1,0]
v_pk_add_f32 v[86:87], v[86:87], v[100:101] op_sel_hi:[1,0]
v_pk_add_f32 v[88:89], v[88:89], v[100:101] op_sel_hi:[1,0]
buffer_load_dwordx4 v35, s[4:7], s43 offen offset:3072 lds
v_pk_add_f32 v[90:91], v[90:91], v[100:101] op_sel_hi:[1,0]
v_pk_add_f32 v[92:93], v[92:93], v[100:101] op_sel_hi:[1,0]
v_pk_add_f32 v[94:95], v[94:95], v[100:101] op_sel_hi:[1,0]
v_pk_add_f32 v[96:97], v[96:97], v[100:101] op_sel_hi:[1,0]
v_pk_add_f32 v[98:99], v[98:99], v[100:101] op_sel_hi:[1,0]
s_add_u32 s43, s43, 40960
s_add_u32 m0, s47, 36864
s_nop 0
buffer_load_dwordx4 v32, s[4:7], s43 offen offset:0 lds
v_pk_mul_f32 v[100:101], v[80:81], v[80:81]
v_pk_mul_f32 v[102:103], v[82:83], v[82:83]
v_pk_fma_f32 v[100:101], v[84:85], v[84:85], v[100:101]
v_pk_fma_f32 v[102:103], v[86:87], v[86:87], v[102:103]
v_pk_fma_f32 v[100:101], v[88:89], v[88:89], v[100:101]
v_pk_fma_f32 v[102:103], v[90:91], v[90:91], v[102:103]
buffer_load_dwordx4 v33, s[4:7], s43 offen offset:1024 lds
v_pk_fma_f32 v[100:101], v[92:93], v[92:93], v[100:101]
v_pk_fma_f32 v[102:103], v[94:95], v[94:95], v[102:103]
v_pk_fma_f32 v[100:101], v[96:97], v[96:97], v[100:101]
v_pk_fma_f32 v[102:103], v[98:99], v[98:99], v[102:103]
v_pk_add_f32 v[100:101], v[100:101], v[102:103]
buffer_load_dwordx4 v34, s[4:7], s43 offen offset:2048 lds
v_add_f32 v100, v100, v101
s_nop 1
v_add_f32_dpp v100, v100, v100 quad_perm:[1,0,3,2] row_mask:0xf bank_mask:0xf
s_nop 1
v_add_f32_dpp v100, v100, v100 quad_perm:[2,3,0,1] row_mask:0xf bank_mask:0xf
s_nop 1
v_add_f32_dpp v100, v100, v100 row_half_mirror row_mask:0xf bank_mask:0xf
s_nop 1
v_add_f32_dpp v100, v100, v100 row_mirror row_mask:0xf bank_mask:0xf
buffer_load_dwordx4 v35, s[4:7], s43 offen offset:3072 lds
v_mov_b32 v101, v100
s_nop 1
v_permlane16_swap_b32 v100, v101
v_add_f32 v100, v100, v101
v_mul_f32 v100, 0x3acccccd, v100
v_add_f32 v100, 0x3727c5ac, v100
s_bfe_u32 s42, s70, 0x40004
s_mul_i32 s42, s42, 524288
s_mov_b32 m0, s53
v_rsq_f32 v100, v100
s_nop 0
v_pk_mul_f32 v[140:141], v[80:81], v[100:101] op_sel_hi:[1,0]
v_pk_mul_f32 v[142:143], v[82:83], v[100:101] op_sel_hi:[1,0]
v_pk_mul_f32 v[144:145], v[84:85], v[100:101] op_sel_hi:[1,0]
v_pk_mul_f32 v[146:147], v[86:87], v[100:101] op_sel_hi:[1,0]
v_pk_mul_f32 v[148:149], v[88:89], v[100:101] op_sel_hi:[1,0]
buffer_load_dwordx4 v28, s[8:11], s42 offen offset:0 lds
v_pk_mul_f32 v[150:151], v[90:91], v[100:101] op_sel_hi:[1,0]
v_pk_mul_f32 v[152:153], v[92:93], v[100:101] op_sel_hi:[1,0]
v_pk_mul_f32 v[154:155], v[94:95], v[100:101] op_sel_hi:[1,0]
v_pk_mul_f32 v[156:157], v[96:97], v[100:101] op_sel_hi:[1,0]
v_pk_mul_f32 v[158:159], v[98:99], v[100:101] op_sel_hi:[1,0]
buffer_load_dwordx4 v29, s[8:11], s42 offen offset:1024 lds
v_cvt_pk_bf16_f32 v124, v140, v141
v_cvt_pk_bf16_f32 v125, v142, v143
v_cvt_pk_bf16_f32 v126, v144, v145
v_cvt_pk_bf16_f32 v127, v146, v147
v_cvt_pk_bf16_f32 v128, v148, v149
buffer_load_dwordx4 v30, s[8:11], s42 offen offset:2048 lds
v_cvt_pk_bf16_f32 v129, v150, v151
v_cvt_pk_bf16_f32 v130, v152, v153
v_cvt_pk_bf16_f32 v131, v154, v155
v_cvt_pk_bf16_f32 v132, v156, v157
v_cvt_pk_bf16_f32 v133, v158, v159
buffer_load_dwordx4 v31, s[8:11], s42 offen offset:3072 lds
ds_write_b64 v160, v[124:125] offset:0
ds_write_b64 v160, v[126:127] offset:256
ds_write_b64 v160, v[128:129] offset:512
ds_write_b64 v160, v[130:131] offset:768
ds_write_b64 v160, v[132:133] offset:1024
v_mov_b32 v206, 0x3f803f80
v_cmp_gt_u32 vcc, 2, v59
s_nop 1
v_cndmask_b32 v192, 0, v206, vcc
v_mov_b32 v205, 0x44444444
v_mov_b32 v206, 0xeeeeeeee
v_cmp_eq_u32 vcc, 1, v59
s_nop 1
v_cndmask_b32 v205, v205, v206, vcc
v_mov_b32 v193, v192
v_mov_b32 v194, v192
v_mov_b32 v195, v192
v_mov_b32 v46, 0
v_mov_b32 v47, 0
v_mov_b32 v48, 0
v_mov_b32 v49, 0
v_mov_b32 v50, 0
v_mov_b32 v51, 0
v_mov_b32 v52, 0
v_mov_b32 v53, 0
s_waitcnt lgkmcnt(0)
s_add_u32 s82, s82, 1
s_waitcnt vmcnt(13)
s_barrier
ds_read_b128 a[0:3], v41 offset:0
ds_read_b128 a[4:7], v41 offset:2048
ds_read_b128 a[8:11], v41 offset:4096
ds_read_b128 a[12:15], v41 offset:6144
ds_read_b128 a[16:19], v42 offset:0
ds_read_b128 a[20:23], v42 offset:2048
ds_read_b128 a[24:27], v42 offset:4096
ds_read_b128 a[28:31], v42 offset:6144
ds_read_b64_tr_b16 v[64:65], v165 offset:0
ds_read_b64_tr_b16 v[66:67], v165 offset:5184
ds_read_b64_tr_b16 v[68:69], v165 offset:512
ds_read_b64_tr_b16 v[70:71], v165 offset:5696
ds_read_b64_tr_b16 v[72:73], v166 offset:0
ds_read_b64_tr_b16 v[74:75], v166 offset:5184
ds_read_b64_tr_b16 a[192:193], v24 offset:0
ds_read_b64_tr_b16 a[194:195], v24 offset:1024
ds_read_b64_tr_b16 a[196:197], v24 offset:8192
ds_read_b64_tr_b16 a[198:199], v24 offset:9216
ds_read_b64_tr_b16 a[200:201], v24 offset:8
ds_read_b64_tr_b16 a[202:203], v24 offset:1032
ds_read_b64_tr_b16 a[204:205], v24 offset:8200
ds_read_b64_tr_b16 a[206:207], v24 offset:9224
ds_read_b64_tr_b16 a[208:209], v25 offset:0
ds_read_b64_tr_b16 a[210:211], v25 offset:1024
ds_read_b64_tr_b16 a[212:213], v25 offset:8192
ds_read_b64_tr_b16 a[214:215], v25 offset:9216
s_waitcnt lgkmcnt(15)
buffer_store_dwordx4 v[64:67], v167, s[28:31], 0 offen sc1
s_waitcnt lgkmcnt(14)
buffer_store_dwordx4 v[68:71], v168, s[28:31], 0 offen sc1
s_waitcnt lgkmcnt(12)
buffer_store_dwordx4 v[72:75], v169, s[28:31], 0 offen sc1
ds_read_b64_tr_b16 a[216:217], v25 offset:8
ds_read_b64_tr_b16 a[218:219], v25 offset:1032
ds_read_b64_tr_b16 a[220:221], v25 offset:8200
ds_read_b64_tr_b16 a[222:223], v25 offset:9224
ds_read_b64_tr_b16 a[224:225], v26 offset:0
ds_read_b64_tr_b16 a[226:227], v26 offset:1024
ds_read_b64_tr_b16 a[228:229], v26 offset:8192
ds_read_b64_tr_b16 a[230:231], v26 offset:9216
s_waitcnt lgkmcnt(12)
v_mfma_f32_16x16x32_bf16 v[64:67], a[192:195], a[0:3], 0
ds_read_b64_tr_b16 a[128:129], v204 offset:0
ds_read_b64_tr_b16 a[232:233], v26 offset:8
v_mfma_f32_16x16x32_bf16 v[64:67], a[196:199], a[16:19], v[64:67]
s_bfe_u32 s43, s70, 0x40008
s_mul_i32 s43, s43, 128
v_mfma_f32_16x16x32_bf16 v[68:71], a[192:195], a[4:7], 0
s_add_u32 m0, s47, 131072
v_mfma_f32_16x16x32_bf16 v[68:71], a[196:199], a[20:23], v[68:71]
buffer_load_dwordx4 v32, s[4:7], s43 offen offset:0 lds
v_mfma_f32_16x16x32_bf16 v[72:75], a[192:195], a[8:11], 0
ds_read_b64_tr_b16 a[130:131], v204 offset:1024
ds_read_b64_tr_b16 a[234:235], v26 offset:1032
v_mfma_f32_16x16x32_bf16 v[72:75], a[196:199], a[24:27], v[72:75]
buffer_load_dwordx4 v33, s[4:7], s43 offen offset:1024 lds
v_mfma_f32_16x16x32_bf16 v[76:79], a[192:195], a[12:15], 0
ds_read_b64_tr_b16 a[132:133], v204 offset:8192
ds_read_b64_tr_b16 a[236:237], v26 offset:8200
v_mfma_f32_16x16x32_bf16 v[76:79], a[196:199], a[28:31], v[76:79]
buffer_load_dwordx4 v34, s[4:7], s43 offen offset:2048 lds
v_mfma_f32_16x16x32_bf16 v[80:83], a[200:203], a[0:3], 0
ds_read_b64_tr_b16 a[134:135], v204 offset:9216
ds_read_b64_tr_b16 a[136:137], v204 offset:8
v_mfma_f32_16x16x32_bf16 v[80:83], a[204:207], a[16:19], v[80:83]
ds_read_b64_tr_b16 a[238:239], v26 offset:9224
v_mfma_f32_16x16x32_bf16 v[84:87], a[200:203], a[4:7], 0
buffer_load_dwordx4 v35, s[4:7], s43 offen offset:3072 lds
v_mfma_f32_16x16x32_bf16 v[84:87], a[204:207], a[20:23], v[84:87]
ds_read_b64_tr_b16 a[138:139], v204 offset:1032
ds_read_b64_tr_b16 a[240:241], v27 offset:0
v_mfma_f32_16x16x32_bf16 v[88:91], a[200:203], a[8:11], 0
s_add_u32 s43, s43, 40960
s_add_u32 m0, s47, 135168
v_mfma_f32_16x16x32_bf16 v[88:91], a[204:207], a[24:27], v[88:91]
buffer_load_dwordx4 v32, s[4:7], s43 offen offset:0 lds
v_mfma_f32_16x16x32_bf16 v[92:95], a[200:203], a[12:15], 0
ds_read_b64_tr_b16 a[140:141], v204 offset:8200
ds_read_b64_tr_b16 a[142:143], v204 offset:9224
v_mfma_f32_16x16x32_bf16 v[92:95], a[204:207], a[28:31], v[92:95]
ds_read_b64_tr_b16 a[242:243], v27 offset:1024
buffer_load_dwordx4 v33, s[4:7], s43 offen offset:1024 lds
s_waitcnt lgkmcnt(15)
v_mfma_f32_16x16x32_bf16 v[96:99], a[208:211], a[0:3], 0
ds_read_b64_tr_b16 a[244:245], v27 offset:8192
v_mfma_f32_16x16x32_bf16 v[96:99], a[212:215], a[16:19], v[96:99]
buffer_load_dwordx4 v34, s[4:7], s43 offen offset:2048 lds
v_mfma_f32_16x16x32_bf16 v[100:103], a[208:211], a[4:7], 0
buffer_load_dwordx4 v35, s[4:7], s43 offen offset:3072 lds
v_mfma_f32_16x16x32_bf16 v[100:103], a[212:215], a[20:23], v[100:103]
s_waitcnt lgkmcnt(2)
v_smfmac_f32_16x16x64_bf16 v[46:49], v[192:195], a[128:135], v205
v_smfmac_f32_16x16x64_bf16 v[50:53], v[192:195], a[136:143], v205
ds_read_b64_tr_b16 a[246:247], v27 offset:9216
s_bfe_u32 s42, s70, 0x40008
v_mfma_f32_16x16x32_bf16 v[104:107], a[208:211], a[8:11], 0
s_mul_i32 s42, s42, 524288
s_mov_b32 m0, s54
v_mfma_f32_16x16x32_bf16 v[104:107], a[212:215], a[24:27], v[104:107]
ds_read_b64_tr_b16 a[248:249], v27 offset:8
v_mfma_f32_16x16x32_bf16 v[108:111], a[208:211], a[12:15], 0
buffer_load_dwordx4 v28, s[8:11], s42 offen offset:0 lds
v_mfma_f32_16x16x32_bf16 v[108:111], a[212:215], a[28:31], v[108:111]
ds_read_b64_tr_b16 a[250:251], v27 offset:1032
v_mfma_f32_16x16x32_bf16 v[112:115], a[216:219], a[0:3], 0
buffer_load_dwordx4 v29, s[8:11], s42 offen offset:1024 lds
v_mfma_f32_16x16x32_bf16 v[112:115], a[220:223], a[16:19], v[112:115]
ds_read_b64_tr_b16 a[252:253], v27 offset:8200
v_mfma_f32_16x16x32_bf16 v[116:119], a[216:219], a[4:7], 0
buffer_load_dwordx4 v30, s[8:11], s42 offen offset:2048 lds
v_mfma_f32_16x16x32_bf16 v[116:119], a[220:223], a[20:23], v[116:119]
ds_read_b64_tr_b16 a[254:255], v27 offset:9224
v_mfma_f32_16x16x32_bf16 v[120:123], a[216:219], a[8:11], 0
buffer_load_dwordx4 v31, s[8:11], s42 offen offset:3072 lds
v_mfma_f32_16x16x32_bf16 v[120:123], a[220:223], a[24:27], v[120:123]
s_waitcnt vmcnt(15)
s_barrier
v_mfma_f32_16x16x32_bf16 v[124:127], a[216:219], a[12:15], 0
ds_read_b64_tr_b16 a[192:193], v24 offset:16384
ds_read_b64_tr_b16 a[194:195], v24 offset:17408
v_mfma_f32_16x16x32_bf16 v[124:127], a[220:223], a[28:31], v[124:127]
s_bfe_u32 s42, s70, 0x4000c
s_mul_i32 s42, s42, 524288
v_mfma_f32_16x16x32_bf16 v[128:131], a[224:227], a[0:3], 0
s_mov_b32 m0, s55
ds_read_b64_tr_b16 a[196:197], v24 offset:24576
v_mfma_f32_16x16x32_bf16 v[128:131], a[228:231], a[16:19], v[128:131]
buffer_load_dwordx4 v28, s[8:11], s42 offen offset:0 lds
v_mfma_f32_16x16x32_bf16 v[132:135], a[224:227], a[4:7], 0
ds_read_b64_tr_b16 a[198:199], v24 offset:25600
v_mfma_f32_16x16x32_bf16 v[132:135], a[228:231], a[20:23], v[132:135]
buffer_load_dwordx4 v29, s[8:11], s42 offen offset:1024 lds
v_mfma_f32_16x16x32_bf16 v[136:139], a[224:227], a[8:11], 0
ds_read_b64_tr_b16 a[200:201], v24 offset:16392
ds_read_b64_tr_b16 a[202:203], v24 offset:17416
v_mfma_f32_16x16x32_bf16 v[136:139], a[228:231], a[24:27], v[136:139]
buffer_load_dwordx4 v30, s[8:11], s42 offen offset:2048 lds
v_mfma_f32_16x16x32_bf16 v[140:143], a[224:227], a[12:15], 0
ds_read_b64_tr_b16 a[204:205], v24 offset:24584
v_mfma_f32_16x16x32_bf16 v[140:143], a[228:231], a[28:31], v[140:143]
buffer_load_dwordx4 v31, s[8:11], s42 offen offset:3072 lds
v_mfma_f32_16x16x32_bf16 v[144:147], a[232:235], a[0:3], 0
ds_read_b64_tr_b16 a[206:207], v24 offset:25608
ds_read_b64_tr_b16 a[208:209], v25 offset:16384
v_mfma_f32_16x16x32_bf16 v[144:147], a[236:239], a[16:19], v[144:147]
s_bfe_u32 s43, s70, 0x4000c
s_mul_i32 s43, s43, 128
v_mfma_f32_16x16x32_bf16 v[148:151], a[232:235], a[4:7], 0
s_add_u32 m0, s47, 0
v_mfma_f32_16x16x32_bf16 v[148:151], a[236:239], a[20:23], v[148:151]
buffer_load_dwordx4 v32, s[4:7], s43 offen offset:0 lds
v_mfma_f32_16x16x32_bf16 v[152:155], a[232:235], a[8:11], 0
ds_read_b64_tr_b16 a[210:211], v25 offset:17408
v_mfma_f32_16x16x32_bf16 v[152:155], a[236:239], a[24:27], v[152:155]
buffer_load_dwordx4 v33, s[4:7], s43 offen offset:1024 lds
v_mfma_f32_16x16x32_bf16 v[156:159], a[232:235], a[12:15], 0
ds_read_b64_tr_b16 a[212:213], v25 offset:24576
ds_read_b64_tr_b16 a[214:215], v25 offset:25600
v_mfma_f32_16x16x32_bf16 v[156:159], a[236:239], a[28:31], v[156:159]
buffer_load_dwordx4 v34, s[4:7], s43 offen offset:2048 lds
s_waitcnt lgkmcnt(12)
v_mfma_f32_16x16x32_bf16 v[160:163], a[240:243], a[0:3], 0
ds_read_b128 a[32:35], v41 offset:32768
v_mfma_f32_16x16x32_bf16 v[160:163], a[244:247], a[16:19], v[160:163]
ds_read_b128 a[36:39], v41 offset:34816
ds_read_b64_tr_b16 a[216:217], v25 offset:16392
v_mfma_f32_16x16x32_bf16 v[164:167], a[240:243], a[4:7], 0
buffer_load_dwordx4 v35, s[4:7], s43 offen offset:3072 lds
v_mfma_f32_16x16x32_bf16 v[164:167], a[244:247], a[20:23], v[164:167]
ds_read_b128 a[40:43], v41 offset:36864
ds_read_b64_tr_b16 a[218:219], v25 offset:17416
v_mfma_f32_16x16x32_bf16 v[168:171], a[240:243], a[8:11], 0
ds_read_b128 a[44:47], v41 offset:38912
ds_read_b64_tr_b16 a[220:221], v25 offset:24584
v_mfma_f32_16x16x32_bf16 v[168:171], a[244:247], a[24:27], v[168:171]
s_add_u32 s43, s43, 40960
s_add_u32 m0, s47, 4096
v_mfma_f32_16x16x32_bf16 v[172:175], a[240:243], a[12:15], 0
buffer_load_dwordx4 v32, s[4:7], s43 offen offset:0 lds
v_mfma_f32_16x16x32_bf16 v[172:175], a[244:247], a[28:31], v[172:175]
ds_read_b128 a[48:51], v42 offset:32768
ds_read_b64_tr_b16 a[222:223], v25 offset:25608
v_mfma_f32_16x16x32_bf16 v[176:179], a[248:251], a[0:3], 0
ds_read_b128 a[52:55], v42 offset:34816
v_mfma_f32_16x16x32_bf16 v[176:179], a[252:255], a[16:19], v[176:179]
buffer_load_dwordx4 v33, s[4:7], s43 offen offset:1024 lds
v_mfma_f32_16x16x32_bf16 v[180:183], a[248:251], a[4:7], 0
ds_read_b128 a[56:59], v42 offset:36864
ds_read_b64_tr_b16 a[224:225], v26 offset:16384
v_mfma_f32_16x16x32_bf16 v[180:183], a[252:255], a[20:23], v[180:183]
ds_read_b128 a[60:63], v42 offset:38912
ds_read_b64_tr_b16 a[226:227], v26 offset:17408
v_mfma_f32_16x16x32_bf16 v[184:187], a[248:251], a[8:11], 0
buffer_load_dwordx4 v34, s[4:7], s43 offen offset:2048 lds
v_mfma_f32_16x16x32_bf16 v[184:187], a[252:255], a[24:27], v[184:187]
ds_read_b64_tr_b16 a[228:229], v26 offset:24576
v_mfma_f32_16x16x32_bf16 v[188:191], a[248:251], a[12:15], 0
buffer_load_dwordx4 v35, s[4:7], s43 offen offset:3072 lds
v_mfma_f32_16x16x32_bf16 v[188:191], a[252:255], a[28:31], v[188:191]
ds_read_b64_tr_b16 a[230:231], v26 offset:25600
s_waitcnt lgkmcnt(3)
v_mfma_f32_16x16x32_bf16 v[64:67], a[192:195], a[32:35], v[64:67]
ds_read_b64_tr_b16 a[128:129], v204 offset:16384
ds_read_b64_tr_b16 a[232:233], v26 offset:16392
v_mfma_f32_16x16x32_bf16 v[64:67], a[196:199], a[48:51], v[64:67]
v_xor_b32 v23, v209, v59
v_mfma_f32_16x16x32_bf16 v[68:71], a[192:195], a[36:39], v[68:71]
ds_read_b64_tr_b16 a[130:131], v204 offset:17408
ds_read_b64_tr_b16 a[234:235], v26 offset:17416
v_mfma_f32_16x16x32_bf16 v[68:71], a[196:199], a[52:55], v[68:71]
s_bfe_u32 s43, s70, 0x40010
s_mul_i32 s43, s43, 128
v_mfma_f32_16x16x32_bf16 v[72:75], a[192:195], a[40:43], v[72:75]
s_add_u32 m0, s47, 32768
v_mfma_f32_16x16x32_bf16 v[72:75], a[196:199], a[56:59], v[72:75]
buffer_load_dwordx4 v32, s[4:7], s43 offen offset:0 lds
v_mfma_f32_16x16x32_bf16 v[76:79], a[192:195], a[44:47], v[76:79]
ds_read_b64_tr_b16 a[132:133], v204 offset:24576
ds_read_b64_tr_b16 a[236:237], v26 offset:24584
v_mfma_f32_16x16x32_bf16 v[76:79], a[196:199], a[60:63], v[76:79]
v_lshlrev_b32 v21, 8, v59
ds_read_b64_tr_b16 a[134:135], v204 offset:25600
v_mfma_f32_16x16x32_bf16 v[80:83], a[200:203], a[32:35], v[80:83]
ds_read_b64_tr_b16 a[136:137], v204 offset:16392
ds_read_b64_tr_b16 a[238:239], v26 offset:25608
v_mfma_f32_16x16x32_bf16 v[80:83], a[204:207], a[48:51], v[80:83]
ds_read_b64_tr_b16 a[138:139], v204 offset:17416
v_mfma_f32_16x16x32_bf16 v[84:87], a[200:203], a[36:39], v[84:87]
buffer_load_dwordx4 v33, s[4:7], s43 offen offset:1024 lds
v_mfma_f32_16x16x32_bf16 v[84:87], a[204:207], a[52:55], v[84:87]
v_xor_b32 v40, 0, v23
ds_read_b64_tr_b16 a[240:241], v27 offset:16384
v_mfma_f32_16x16x32_bf16 v[88:91], a[200:203], a[40:43], v[88:91]
ds_read_b64_tr_b16 a[140:141], v204 offset:24584
ds_read_b64_tr_b16 a[142:143], v204 offset:25608
v_mfma_f32_16x16x32_bf16 v[88:91], a[204:207], a[56:59], v[88:91]
ds_read_b64_tr_b16 a[242:243], v27 offset:17408
v_lshl_add_u32 v2, v40, 4, v21
v_mfma_f32_16x16x32_bf16 v[92:95], a[200:203], a[44:47], v[92:95]
ds_read_b64_tr_b16 a[244:245], v27 offset:24576
v_mfma_f32_16x16x32_bf16 v[92:95], a[204:207], a[60:63], v[92:95]
buffer_load_dwordx4 v34, s[4:7], s43 offen offset:2048 lds
v_mfma_f32_16x16x32_bf16 v[96:99], a[208:211], a[32:35], v[96:99]
v_xor_b32 v40, 4, v23
ds_read_b64_tr_b16 a[246:247], v27 offset:25600
v_mfma_f32_16x16x32_bf16 v[96:99], a[212:215], a[48:51], v[96:99]
ds_read_b64_tr_b16 a[248:249], v27 offset:16392
v_lshl_add_u32 v3, v40, 4, v21
v_mfma_f32_16x16x32_bf16 v[100:103], a[208:211], a[36:39], v[100:103]
buffer_load_dwordx4 v35, s[4:7], s43 offen offset:3072 lds
v_mfma_f32_16x16x32_bf16 v[100:103], a[212:215], a[52:55], v[100:103]
s_waitcnt lgkmcnt(4)
v_smfmac_f32_16x16x64_bf16 v[46:49], v[192:195], a[128:135], v205
v_smfmac_f32_16x16x64_bf16 v[50:53], v[192:195], a[136:143], v205
ds_read_b64_tr_b16 a[250:251], v27 offset:17416
v_xor_b32 v40, 8, v23
v_mfma_f32_16x16x32_bf16 v[104:107], a[208:211], a[40:43], v[104:107]
ds_read_b64_tr_b16 a[252:253], v27 offset:24584
v_mfma_f32_16x16x32_bf16 v[104:107], a[212:215], a[56:59], v[104:107]
ds_read_b64_tr_b16 a[254:255], v27 offset:25608
s_add_u32 s43, s43, 40960
v_mfma_f32_16x16x32_bf16 v[108:111], a[208:211], a[44:47], v[108:111]
s_add_u32 m0, s47, 36864
v_mfma_f32_16x16x32_bf16 v[108:111], a[212:215], a[60:63], v[108:111]
buffer_load_dwordx4 v32, s[4:7], s43 offen offset:0 lds
v_mfma_f32_16x16x32_bf16 v[112:115], a[216:219], a[32:35], v[112:115]
v_lshl_add_u32 v4, v40, 4, v21
s_waitcnt vmcnt(17)
v_mfma_f32_16x16x32_bf16 v[112:115], a[220:223], a[48:51], v[112:115]
s_barrier
v_xor_b32 v40, 12, v23
v_mfma_f32_16x16x32_bf16 v[116:119], a[216:219], a[36:39], v[116:119]
ds_read_b64_tr_b16 a[192:193], v24 offset:32768
ds_read_b64_tr_b16 a[194:195], v24 offset:33792
v_mfma_f32_16x16x32_bf16 v[116:119], a[220:223], a[52:55], v[116:119]
buffer_load_dwordx4 v33, s[4:7], s43 offen offset:1024 lds
v_mfma_f32_16x16x32_bf16 v[120:123], a[216:219], a[40:43], v[120:123]
v_lshl_add_u32 v5, v40, 4, v21
ds_read_b64_tr_b16 a[196:197], v24 offset:40960
v_mfma_f32_16x16x32_bf16 v[120:123], a[220:223], a[56:59], v[120:123]
v_mfma_f32_16x16x32_bf16 v[124:127], a[216:219], a[44:47], v[124:127]
ds_read_b64_tr_b16 a[198:199], v24 offset:41984
v_lshl_add_u32 v23, v209, 2, v20
v_mfma_f32_16x16x32_bf16 v[124:127], a[220:223], a[60:63], v[124:127]
buffer_load_dwordx4 v34, s[4:7], s43 offen offset:2048 lds
v_mfma_f32_16x16x32_bf16 v[128:131], a[224:227], a[32:35], v[128:131]
ds_read_b64_tr_b16 a[200:201], v24 offset:32776
v_mfma_f32_16x16x32_bf16 v[128:131], a[228:231], a[48:51], v[128:131]
v_mul_u32_u24 v44, 160, v23
v_mfma_f32_16x16x32_bf16 v[132:135], a[224:227], a[36:39], v[132:135]
ds_read_b64_tr_b16 a[202:203], v24 offset:33800
v_mfma_f32_16x16x32_bf16 v[132:135], a[228:231], a[52:55], v[132:135]
v_mfma_f32_16x16x32_bf16 v[136:139], a[224:227], a[40:43], v[136:139]
ds_read_b64_tr_b16 a[204:205], v24 offset:40968
v_mfma_f32_16x16x32_bf16 v[136:139], a[228:231], a[56:59], v[136:139]
buffer_load_dwordx4 v35, s[4:7], s43 offen offset:3072 lds
v_mfma_f32_16x16x32_bf16 v[140:143], a[224:227], a[44:47], v[140:143]
v_lshl_add_u32 v44, v22, 3, v44
ds_read_b64_tr_b16 a[206:207], v24 offset:41992
v_mfma_f32_16x16x32_bf16 v[140:143], a[228:231], a[60:63], v[140:143]
v_add_u32 v44, s47, v44
v_mfma_f32_16x16x32_bf16 v[144:147], a[232:235], a[32:35], v[144:147]
ds_read_b64_tr_b16 a[208:209], v25 offset:32768
v_mfma_f32_16x16x32_bf16 v[144:147], a[236:239], a[48:51], v[144:147]
v_mfma_f32_16x16x32_bf16 v[148:151], a[232:235], a[36:39], v[148:151]
ds_read_b64_tr_b16 a[210:211], v25 offset:33792
v_add_u32 v43, 131072, v44
v_mfma_f32_16x16x32_bf16 v[148:151], a[236:239], a[52:55], v[148:151]
v_mfma_f32_16x16x32_bf16 v[152:155], a[232:235], a[40:43], v[152:155]
ds_read_b64_tr_b16 a[212:213], v25 offset:40960
s_bfe_u32 s42, s70, 0x40010
v_mfma_f32_16x16x32_bf16 v[152:155], a[236:239], a[56:59], v[152:155]
s_mul_i32 s42, s42, 524288
s_mov_b32 m0, s52
v_mfma_f32_16x16x32_bf16 v[156:159], a[232:235], a[44:47], v[156:159]
v_lshlrev_b32 v21, 8, v23
ds_read_b64_tr_b16 a[214:215], v25 offset:41984
v_mfma_f32_16x16x32_bf16 v[156:159], a[236:239], a[60:63], v[156:159]
ds_read_b128 a[0:3], v61 offset:0
s_waitcnt lgkmcnt(13)
v_mfma_f32_16x16x32_bf16 v[160:163], a[240:243], a[32:35], v[160:163]
buffer_load_dwordx4 v28, s[8:11], s42 offen offset:0 lds
v_mfma_f32_16x16x32_bf16 v[160:163], a[244:247], a[48:51], v[160:163]
ds_read_b128 a[4:7], v61 offset:2048
ds_read_b64_tr_b16 a[216:217], v25 offset:32776
v_mfma_f32_16x16x32_bf16 v[164:167], a[240:243], a[36:39], v[164:167]
v_lshl_add_u32 v21, v22, 3, v21
ds_read_b128 a[8:11], v61 offset:4096
v_mfma_f32_16x16x32_bf16 v[164:167], a[244:247], a[52:55], v[164:167]
ds_read_b64_tr_b16 a[218:219], v25 offset:33800
ds_read_b128 a[12:15], v61 offset:6144
v_mfma_f32_16x16x32_bf16 v[168:171], a[240:243], a[40:43], v[168:171]
buffer_load_dwordx4 v29, s[8:11], s42 offen offset:1024 lds
v_mfma_f32_16x16x32_bf16 v[168:171], a[244:247], a[56:59], v[168:171]
v_add_u32 v21, 65536, v21
ds_read_b64_tr_b16 a[220:221], v25 offset:40968
v_mfma_f32_16x16x32_bf16 v[172:175], a[240:243], a[44:47], v[172:175]
ds_read_b128 a[16:19], v62 offset:0
ds_read_b64_tr_b16 a[222:223], v25 offset:41992
v_mfma_f32_16x16x32_bf16 v[172:175], a[244:247], a[60:63], v[172:175]
ds_read_b128 a[20:23], v62 offset:2048
v_and_b32 v23, 7, v23
v_mfma_f32_16x16x32_bf16 v[176:179], a[248:251], a[32:35], v[176:179]
buffer_load_dwordx4 v30, s[8:11], s42 offen offset:2048 lds
v_mfma_f32_16x16x32_bf16 v[176:179], a[252:255], a[48:51], v[176:179]
ds_read_b128 a[24:27], v62 offset:4096
ds_read_b64_tr_b16 a[224:225], v26 offset:32768
v_mfma_f32_16x16x32_bf16 v[180:183], a[248:251], a[36:39], v[180:183]
ds_read_b128 a[28:31], v62 offset:6144
v_xor_b32 v40, 0, v23
v_mfma_f32_16x16x32_bf16 v[180:183], a[252:255], a[52:55], v[180:183]
ds_read_b64_tr_b16 a[226:227], v26 offset:33792
v_mfma_f32_16x16x32_bf16 v[184:187], a[248:251], a[40:43], v[184:187]
buffer_load_dwordx4 v31, s[8:11], s42 offen offset:3072 lds
v_mfma_f32_16x16x32_bf16 v[184:187], a[252:255], a[56:59], v[184:187]
ds_read_b64_tr_b16 a[228:229], v26 offset:40960
v_lshl_add_u32 v6, v40, 5, v21
v_mfma_f32_16x16x32_bf16 v[188:191], a[248:251], a[44:47], v[188:191]
ds_read_b64_tr_b16 a[230:231], v26 offset:41984
v_mfma_f32_16x16x32_bf16 v[188:191], a[252:255], a[60:63], v[188:191]
s_waitcnt lgkmcnt(3)
v_mfma_f32_16x16x32_bf16 v[64:67], a[192:195], a[0:3], v[64:67]
ds_read_b64_tr_b16 a[128:129], v204 offset:32768
ds_read_b64_tr_b16 a[232:233], v26 offset:32776
v_mfma_f32_16x16x32_bf16 v[64:67], a[196:199], a[16:19], v[64:67]
v_xor_b32 v40, 1, v23
v_mfma_f32_16x16x32_bf16 v[68:71], a[192:195], a[4:7], v[68:71]
ds_read_b64_tr_b16 a[130:131], v204 offset:33792
ds_read_b64_tr_b16 a[234:235], v26 offset:33800
v_mfma_f32_16x16x32_bf16 v[68:71], a[196:199], a[20:23], v[68:71]
s_bfe_u32 s43, s70, 0x40014
s_mul_i32 s43, s43, 128
v_mfma_f32_16x16x32_bf16 v[72:75], a[192:195], a[8:11], v[72:75]
s_add_u32 m0, s47, 131072
v_mfma_f32_16x16x32_bf16 v[72:75], a[196:199], a[24:27], v[72:75]
buffer_load_dwordx4 v32, s[4:7], s43 offen offset:0 lds
v_mfma_f32_16x16x32_bf16 v[76:79], a[192:195], a[12:15], v[76:79]
ds_read_b64_tr_b16 a[132:133], v204 offset:40960
ds_read_b64_tr_b16 a[236:237], v26 offset:40968
v_mfma_f32_16x16x32_bf16 v[76:79], a[196:199], a[28:31], v[76:79]
v_lshl_add_u32 v7, v40, 5, v21
ds_read_b64_tr_b16 a[134:135], v204 offset:41984
v_mfma_f32_16x16x32_bf16 v[80:83], a[200:203], a[0:3], v[80:83]
ds_read_b64_tr_b16 a[136:137], v204 offset:32776
ds_read_b64_tr_b16 a[238:239], v26 offset:41992
v_mfma_f32_16x16x32_bf16 v[80:83], a[204:207], a[16:19], v[80:83]
ds_read_b64_tr_b16 a[138:139], v204 offset:33800
v_mfma_f32_16x16x32_bf16 v[84:87], a[200:203], a[4:7], v[84:87]
buffer_load_dwordx4 v33, s[4:7], s43 offen offset:1024 lds
v_mfma_f32_16x16x32_bf16 v[84:87], a[204:207], a[20:23], v[84:87]
v_xor_b32 v40, 2, v23
ds_read_b64_tr_b16 a[240:241], v27 offset:32768
v_mfma_f32_16x16x32_bf16 v[88:91], a[200:203], a[8:11], v[88:91]
ds_read_b64_tr_b16 a[140:141], v204 offset:40968
ds_read_b64_tr_b16 a[142:143], v204 offset:41992
v_mfma_f32_16x16x32_bf16 v[88:91], a[204:207], a[24:27], v[88:91]
ds_read_b64_tr_b16 a[242:243], v27 offset:33792
v_lshl_add_u32 v8, v40, 5, v21
v_mfma_f32_16x16x32_bf16 v[92:95], a[200:203], a[12:15], v[92:95]
ds_read_b64_tr_b16 a[244:245], v27 offset:40960
v_mfma_f32_16x16x32_bf16 v[92:95], a[204:207], a[28:31], v[92:95]
buffer_load_dwordx4 v34, s[4:7], s43 offen offset:2048 lds
v_mfma_f32_16x16x32_bf16 v[96:99], a[208:211], a[0:3], v[96:99]
s_lshl_b32 s92, s2, 2
v_xor_b32 v40, 3, v23
v_mfma_f32_16x16x32_bf16 v[96:99], a[212:215], a[16:19], v[96:99]
ds_read_b64_tr_b16 a[246:247], v27 offset:41984
s_add_u32 s92, s92, 1024
v_mfma_f32_16x16x32_bf16 v[100:103], a[208:211], a[4:7], v[100:103]
ds_read_b64_tr_b16 a[248:249], v27 offset:32776
v_add_u32 v54, s40, v1
v_mfma_f32_16x16x32_bf16 v[100:103], a[212:215], a[20:23], v[100:103]
s_waitcnt lgkmcnt(4)
v_smfmac_f32_16x16x64_bf16 v[46:49], v[192:195], a[128:135], v205
v_smfmac_f32_16x16x64_bf16 v[50:53], v[192:195], a[136:143], v205
v_lshl_add_u32 v9, v40, 5, v21
v_min_u32 v54, 1, v54
v_mfma_f32_16x16x32_bf16 v[104:107], a[208:211], a[8:11], v[104:107]
buffer_load_dwordx4 v35, s[4:7], s43 offen offset:3072 lds
v_mfma_f32_16x16x32_bf16 v[104:107], a[212:215], a[24:27], v[104:107]
ds_read_b64_tr_b16 a[250:251], v27 offset:33800
v_lshlrev_b32 v54, 31, v54
v_mfma_f32_16x16x32_bf16 v[108:111], a[208:211], a[12:15], v[108:111]
v_xor_b32 v40, 4, v23
ds_read_b64_tr_b16 a[252:253], v27 offset:40968
v_mfma_f32_16x16x32_bf16 v[108:111], a[212:215], a[28:31], v[108:111]
v_mov_b32 v55, s82
ds_read_b64_tr_b16 a[254:255], v27 offset:41992
v_mfma_f32_16x16x32_bf16 v[112:115], a[216:219], a[0:3], v[112:115]
s_add_u32 s43, s43, 40960
s_add_u32 m0, s47, 135168
v_mfma_f32_16x16x32_bf16 v[112:115], a[220:223], a[16:19], v[112:115]
buffer_load_dwordx4 v32, s[4:7], s43 offen offset:0 lds
v_mfma_f32_16x16x32_bf16 v[116:119], a[216:219], a[4:7], v[116:119]
v_lshl_add_u32 v10, v40, 5, v21
s_waitcnt vmcnt(25)
v_mfma_f32_16x16x32_bf16 v[116:119], a[220:223], a[20:23], v[116:119]
s_barrier
v_mfma_f32_16x16x32_bf16 v[120:123], a[216:219], a[8:11], v[120:123]
buffer_store_dword v55, v54, s[56:59], s92 offen sc1
v_mfma_f32_16x16x32_bf16 v[120:123], a[220:223], a[24:27], v[120:123]
v_xor_b32 v40, 5, v23
ds_read_b64_tr_b16 a[192:193], v24 offset:49152
v_mfma_f32_16x16x32_bf16 v[124:127], a[216:219], a[12:15], v[124:127]
ds_read_b64_tr_b16 a[194:195], v24 offset:50176
v_mfma_f32_16x16x32_bf16 v[124:127], a[220:223], a[28:31], v[124:127]
buffer_load_dwordx4 v33, s[4:7], s43 offen offset:1024 lds
v_mfma_f32_16x16x32_bf16 v[128:131], a[224:227], a[0:3], v[128:131]
v_lshl_add_u32 v11, v40, 5, v21
ds_read_b64_tr_b16 a[196:197], v24 offset:57344
v_mfma_f32_16x16x32_bf16 v[128:131], a[228:231], a[16:19], v[128:131]
ds_read_b64_tr_b16 a[198:199], v24 offset:58368
v_xor_b32 v40, 6, v23
v_mfma_f32_16x16x32_bf16 v[132:135], a[224:227], a[4:7], v[132:135]
buffer_load_dwordx4 v34, s[4:7], s43 offen offset:2048 lds
v_mfma_f32_16x16x32_bf16 v[132:135], a[228:231], a[20:23], v[132:135]
ds_read_b64_tr_b16 a[200:201], v24 offset:49160
v_lshl_add_u32 v12, v40, 5, v21
v_mfma_f32_16x16x32_bf16 v[136:139], a[224:227], a[8:11], v[136:139]
ds_read_b64_tr_b16 a[202:203], v24 offset:50184
ds_read_b64_tr_b16 a[204:205], v24 offset:57352
v_mfma_f32_16x16x32_bf16 v[136:139], a[228:231], a[24:27], v[136:139]
buffer_load_dwordx4 v35, s[4:7], s43 offen offset:3072 lds
v_mfma_f32_16x16x32_bf16 v[140:143], a[224:227], a[12:15], v[140:143]
v_xor_b32 v40, 7, v23
ds_read_b64_tr_b16 a[206:207], v24 offset:58376
v_mfma_f32_16x16x32_bf16 v[140:143], a[228:231], a[28:31], v[140:143]
v_lshl_add_u32 v13, v40, 5, v21
v_mfma_f32_16x16x32_bf16 v[144:147], a[232:235], a[0:3], v[144:147]
ds_read_b64_tr_b16 a[208:209], v25 offset:49152
v_mfma_f32_16x16x32_bf16 v[144:147], a[236:239], a[16:19], v[144:147]
v_mfma_f32_16x16x32_bf16 v[148:151], a[232:235], a[4:7], v[148:151]
ds_read_b64_tr_b16 a[210:211], v25 offset:50176
v_lshlrev_b32 v21, 8, v60
v_mfma_f32_16x16x32_bf16 v[148:151], a[236:239], a[20:23], v[148:151]
v_mfma_f32_16x16x32_bf16 v[152:155], a[232:235], a[8:11], v[152:155]
ds_read_b64_tr_b16 a[212:213], v25 offset:57344
s_bfe_u32 s42, s70, 0x40014
v_mfma_f32_16x16x32_bf16 v[152:155], a[236:239], a[24:27], v[152:155]
s_mul_i32 s42, s42, 524288
s_mov_b32 m0, s53
v_mfma_f32_16x16x32_bf16 v[156:159], a[232:235], a[12:15], v[156:159]
v_add_u32 v40, 0, v209
ds_read_b64_tr_b16 a[214:215], v25 offset:58368
v_mfma_f32_16x16x32_bf16 v[156:159], a[236:239], a[28:31], v[156:159]
s_waitcnt vmcnt(21)
ds_read_b128 a[32:35], v41 offset:0
s_waitcnt lgkmcnt(13)
v_mfma_f32_16x16x32_bf16 v[160:163], a[240:243], a[0:3], v[160:163]
buffer_load_dwordx4 v28, s[8:11], s42 offen offset:0 lds
v_mfma_f32_16x16x32_bf16 v[160:163], a[244:247], a[16:19], v[160:163]
ds_read_b128 a[36:39], v41 offset:2048
ds_read_b64_tr_b16 a[216:217], v25 offset:49160
v_mfma_f32_16x16x32_bf16 v[164:167], a[240:243], a[4:7], v[164:167]
v_xor_b32 v40, v40, v59
ds_read_b128 a[40:43], v41 offset:4096
v_mfma_f32_16x16x32_bf16 v[164:167], a[244:247], a[20:23], v[164:167]
ds_read_b64_tr_b16 a[218:219], v25 offset:50184
ds_read_b128 a[44:47], v41 offset:6144
v_mfma_f32_16x16x32_bf16 v[168:171], a[240:243], a[8:11], v[168:171]
buffer_load_dwordx4 v29, s[8:11], s42 offen offset:1024 lds
v_mfma_f32_16x16x32_bf16 v[168:171], a[244:247], a[24:27], v[168:171]
v_lshl_add_u32 v14, v40, 4, v21
ds_read_b64_tr_b16 a[220:221], v25 offset:57352
v_mfma_f32_16x16x32_bf16 v[172:175], a[240:243], a[12:15], v[172:175]
ds_read_b128 a[48:51], v42 offset:0
ds_read_b64_tr_b16 a[222:223], v25 offset:58376
v_mfma_f32_16x16x32_bf16 v[172:175], a[244:247], a[28:31], v[172:175]
ds_read_b128 a[52:55], v42 offset:2048
v_add_u32 v40, 4, v209
v_mfma_f32_16x16x32_bf16 v[176:179], a[248:251], a[0:3], v[176:179]
buffer_load_dwordx4 v30, s[8:11], s42 offen offset:2048 lds
v_mfma_f32_16x16x32_bf16 v[176:179], a[252:255], a[16:19], v[176:179]
ds_read_b128 a[56:59], v42 offset:4096
ds_read_b64_tr_b16 a[224:225], v26 offset:49152
v_mfma_f32_16x16x32_bf16 v[180:183], a[248:251], a[4:7], v[180:183]
ds_read_b128 a[60:63], v42 offset:6144
v_xor_b32 v40, v40, v59
v_mfma_f32_16x16x32_bf16 v[180:183], a[252:255], a[20:23], v[180:183]
ds_read_b64_tr_b16 a[226:227], v26 offset:50176
v_mfma_f32_16x16x32_bf16 v[184:187], a[248:251], a[8:11], v[184:187]
buffer_load_dwordx4 v31, s[8:11], s42 offen offset:3072 lds
v_mfma_f32_16x16x32_bf16 v[184:187], a[252:255], a[24:27], v[184:187]
ds_read_b64_tr_b16 a[228:229], v26 offset:57344
v_lshl_add_u32 v15, v40, 4, v21
v_mfma_f32_16x16x32_bf16 v[188:191], a[248:251], a[12:15], v[188:191]
ds_read_b64_tr_b16 a[230:231], v26 offset:58368
v_mfma_f32_16x16x32_bf16 v[188:191], a[252:255], a[28:31], v[188:191]
s_waitcnt lgkmcnt(3)
v_mfma_f32_16x16x32_bf16 v[64:67], a[192:195], a[32:35], v[64:67]
ds_read_b64_tr_b16 a[128:129], v204 offset:49152
ds_read_b64_tr_b16 a[232:233], v26 offset:49160
v_mfma_f32_16x16x32_bf16 v[64:67], a[196:199], a[48:51], v[64:67]
v_add_u32 v40, 8, v209
v_mfma_f32_16x16x32_bf16 v[68:71], a[192:195], a[36:39], v[68:71]
s_lshl_b32 s92, s88, 19
ds_read_b64_tr_b16 a[130:131], v204 offset:50176
v_mfma_f32_16x16x32_bf16 v[68:71], a[196:199], a[52:55], v[68:71]
ds_read_b64_tr_b16 a[234:235], v26 offset:50184
s_bfe_u32 s43, s70, 0x40018
v_mfma_f32_16x16x32_bf16 v[72:75], a[192:195], a[40:43], v[72:75]
s_mul_i32 s43, s43, 128
s_add_u32 m0, s47, 0
v_mfma_f32_16x16x32_bf16 v[72:75], a[196:199], a[56:59], v[72:75]
buffer_load_dwordx4 v32, s[4:7], s43 offen offset:0 lds
v_mfma_f32_16x16x32_bf16 v[76:79], a[192:195], a[44:47], v[76:79]
ds_read_b64_tr_b16 a[132:133], v204 offset:57344
ds_read_b64_tr_b16 a[236:237], v26 offset:57352
v_mfma_f32_16x16x32_bf16 v[76:79], a[196:199], a[60:63], v[76:79]
v_xor_b32 v40, v40, v59
ds_read_b64_tr_b16 a[134:135], v204 offset:58368
v_mfma_f32_16x16x32_bf16 v[80:83], a[200:203], a[32:35], v[80:83]
ds_read_b64_tr_b16 a[136:137], v204 offset:49160
ds_read_b64_tr_b16 a[238:239], v26 offset:58376
v_mfma_f32_16x16x32_bf16 v[80:83], a[204:207], a[48:51], v[80:83]
s_add_u32 s12, s62, s92
s_addc_u32 s13, s63, 0
ds_read_b64_tr_b16 a[138:139], v204 offset:50184
v_mfma_f32_16x16x32_bf16 v[84:87], a[200:203], a[36:39], v[84:87]
buffer_load_dwordx4 v33, s[4:7], s43 offen offset:1024 lds
v_mfma_f32_16x16x32_bf16 v[84:87], a[204:207], a[52:55], v[84:87]
v_lshl_add_u32 v16, v40, 4, v21
ds_read_b64_tr_b16 a[240:241], v27 offset:49152
v_mfma_f32_16x16x32_bf16 v[88:91], a[200:203], a[40:43], v[88:91]
ds_read_b64_tr_b16 a[140:141], v204 offset:57352
ds_read_b64_tr_b16 a[142:143], v204 offset:58376
v_mfma_f32_16x16x32_bf16 v[88:91], a[204:207], a[56:59], v[88:91]
ds_read_b64_tr_b16 a[242:243], v27 offset:50176
v_add_u32 v40, 12, v209
v_mfma_f32_16x16x32_bf16 v[92:95], a[200:203], a[44:47], v[92:95]
s_mov_b32 s14, 524288
ds_read_b64_tr_b16 a[244:245], v27 offset:57344
v_mfma_f32_16x16x32_bf16 v[92:95], a[204:207], a[60:63], v[92:95]
buffer_load_dwordx4 v34, s[4:7], s43 offen offset:2048 lds
v_mfma_f32_16x16x32_bf16 v[96:99], a[208:211], a[32:35], v[96:99]
v_xor_b32 v40, v40, v59
ds_read_b64_tr_b16 a[246:247], v27 offset:58368
v_mfma_f32_16x16x32_bf16 v[96:99], a[212:215], a[48:51], v[96:99]
ds_read_b64_tr_b16 a[248:249], v27 offset:49160
v_lshl_add_u32 v17, v40, 4, v21
v_mfma_f32_16x16x32_bf16 v[100:103], a[208:211], a[36:39], v[100:103]
buffer_load_dwordx4 v35, s[4:7], s43 offen offset:3072 lds
v_mfma_f32_16x16x32_bf16 v[100:103], a[212:215], a[52:55], v[100:103]
s_waitcnt lgkmcnt(4)
v_smfmac_f32_16x16x64_bf16 v[46:49], v[192:195], a[128:135], v205
v_smfmac_f32_16x16x64_bf16 v[50:53], v[192:195], a[136:143], v205
s_mov_b32 s15, 0x20000
ds_read_b64_tr_b16 a[250:251], v27 offset:50184
v_mfma_f32_16x16x32_bf16 v[104:107], a[208:211], a[40:43], v[104:107]
v_add_u32 v40, 0, v209
ds_read_b64_tr_b16 a[252:253], v27 offset:57352
v_mfma_f32_16x16x32_bf16 v[104:107], a[212:215], a[56:59], v[104:107]
ds_read_b64_tr_b16 a[254:255], v27 offset:58376
s_add_u32 s43, s43, 40960
v_mfma_f32_16x16x32_bf16 v[108:111], a[208:211], a[44:47], v[108:111]
s_add_u32 m0, s47, 4096
v_mfma_f32_16x16x32_bf16 v[108:111], a[212:215], a[60:63], v[108:111]
buffer_load_dwordx4 v32, s[4:7], s43 offen offset:0 lds
v_mfma_f32_16x16x32_bf16 v[112:115], a[216:219], a[32:35], v[112:115]
v_lshlrev_b32 v40, 1, v40
s_add_u32 s93, s64, s92
s_addc_u32 s94, s65, 0
v_mfma_f32_16x16x32_bf16 v[112:115], a[220:223], a[48:51], v[112:115]
s_waitcnt vmcnt(18)
s_barrier
v_mfma_f32_16x16x32_bf16 v[116:119], a[216:219], a[36:39], v[116:119]
v_xor_b32 v40, v40, v59
ds_read_b64_tr_b16 a[192:193], v24 offset:0
v_mfma_f32_16x16x32_bf16 v[116:119], a[220:223], a[52:55], v[116:119]
ds_read_b64_tr_b16 a[194:195], v24 offset:1024
v_mfma_f32_16x16x32_bf16 v[120:123], a[216:219], a[40:43], v[120:123]
buffer_load_dwordx4 v33, s[4:7], s43 offen offset:1024 lds
v_mfma_f32_16x16x32_bf16 v[120:123], a[220:223], a[56:59], v[120:123]
s_sub_u32 s16, s93, 32768
s_subb_u32 s17, s94, 0
v_lshl_add_u32 v18, v40, 4, v21
v_mfma_f32_16x16x32_bf16 v[124:127], a[216:219], a[44:47], v[124:127]
ds_read_b64_tr_b16 a[196:197], v24 offset:8192
ds_read_b64_tr_b16 a[198:199], v24 offset:9216
v_mfma_f32_16x16x32_bf16 v[124:127], a[220:223], a[60:63], v[124:127]
v_add_u32 v40, 4, v209
v_mfma_f32_16x16x32_bf16 v[128:131], a[224:227], a[32:35], v[128:131]
buffer_load_dwordx4 v34, s[4:7], s43 offen offset:2048 lds
v_mfma_f32_16x16x32_bf16 v[128:131], a[228:231], a[48:51], v[128:131]
ds_read_b64_tr_b16 a[200:201], v24 offset:8
s_mov_b32 s18, 557056
v_mfma_f32_16x16x32_bf16 v[132:135], a[224:227], a[36:39], v[132:135]
v_lshlrev_b32 v40, 1, v40
ds_read_b64_tr_b16 a[202:203], v24 offset:1032
v_mfma_f32_16x16x32_bf16 v[132:135], a[228:231], a[52:55], v[132:135]
v_mfma_f32_16x16x32_bf16 v[136:139], a[224:227], a[40:43], v[136:139]
ds_read_b64_tr_b16 a[204:205], v24 offset:8200
v_mfma_f32_16x16x32_bf16 v[136:139], a[228:231], a[56:59], v[136:139]
buffer_load_dwordx4 v35, s[4:7], s43 offen offset:3072 lds
v_mfma_f32_16x16x32_bf16 v[140:143], a[224:227], a[44:47], v[140:143]
v_xor_b32 v40, v40, v59
s_mov_b32 s19, 0x20000
v_mfma_f32_16x16x32_bf16 v[140:143], a[228:231], a[60:63], v[140:143]
ds_read_b64_tr_b16 a[206:207], v24 offset:9224
v_lshl_add_u32 v19, v40, 4, v21
v_mfma_f32_16x16x32_bf16 v[144:147], a[232:235], a[32:35], v[144:147]
ds_read_b64_tr_b16 a[208:209], v25 offset:0
v_mfma_f32_16x16x32_bf16 v[144:147], a[236:239], a[48:51], v[144:147]
v_mfma_f32_16x16x32_bf16 v[148:151], a[232:235], a[36:39], v[148:151]
ds_read_b64_tr_b16 a[210:211], v25 offset:1024
v_mov_b32 v60, v43
v_mfma_f32_16x16x32_bf16 v[148:151], a[236:239], a[52:55], v[148:151]
s_and_b32 s92, s86, 1
v_mfma_f32_16x16x32_bf16 v[152:155], a[232:235], a[40:43], v[152:155]
ds_read_b64_tr_b16 a[212:213], v25 offset:8192
s_bfe_u32 s42, s70, 0x40018
v_mfma_f32_16x16x32_bf16 v[152:155], a[236:239], a[56:59], v[152:155]
s_mul_i32 s42, s42, 524288
s_mov_b32 m0, s54
v_mfma_f32_16x16x32_bf16 v[156:159], a[232:235], a[44:47], v[156:159]
v_add_u32 v210, 0, v208
ds_read_b64_tr_b16 a[214:215], v25 offset:9216
v_mfma_f32_16x16x32_bf16 v[156:159], a[236:239], a[60:63], v[156:159]
ds_read_b128 a[0:3], v41 offset:32768
s_waitcnt lgkmcnt(13)
v_mfma_f32_16x16x32_bf16 v[160:163], a[240:243], a[32:35], v[160:163]
buffer_load_dwordx4 v28, s[8:11], s42 offen offset:0 lds
v_mfma_f32_16x16x32_bf16 v[160:163], a[244:247], a[48:51], v[160:163]
ds_read_b128 a[4:7], v41 offset:34816
ds_read_b64_tr_b16 a[216:217], v25 offset:8
v_mfma_f32_16x16x32_bf16 v[164:167], a[240:243], a[36:39], v[164:167]
v_mul_u32_u24 v211, 6554, v210
s_lshl_b32 s92, s92, 2
v_mfma_f32_16x16x32_bf16 v[164:167], a[244:247], a[52:55], v[164:167]
ds_read_b128 a[8:11], v41 offset:36864
ds_read_b64_tr_b16 a[218:219], v25 offset:1032
v_mfma_f32_16x16x32_bf16 v[168:171], a[240:243], a[40:43], v[168:171]
ds_read_b128 a[12:15], v41 offset:38912
v_mfma_f32_16x16x32_bf16 v[168:171], a[244:247], a[56:59], v[168:171]
buffer_load_dwordx4 v29, s[8:11], s42 offen offset:1024 lds
v_mfma_f32_16x16x32_bf16 v[172:175], a[240:243], a[44:47], v[172:175]
v_lshrrev_b32 v211, 16, v211
ds_read_b64_tr_b16 a[220:221], v25 offset:8200
v_mfma_f32_16x16x32_bf16 v[172:175], a[244:247], a[60:63], v[172:175]
ds_read_b128 a[16:19], v42 offset:32768
s_and_b32 s93, s87, 3
v_mfma_f32_16x16x32_bf16 v[176:179], a[248:251], a[32:35], v[176:179]
ds_read_b64_tr_b16 a[222:223], v25 offset:9224
ds_read_b128 a[20:23], v42 offset:34816
v_mfma_f32_16x16x32_bf16 v[176:179], a[252:255], a[48:51], v[176:179]
v_mul_u32_u24 v212, 10, v211
v_mfma_f32_16x16x32_bf16 v[180:183], a[248:251], a[36:39], v[180:183]
buffer_load_dwordx4 v30, s[8:11], s42 offen offset:2048 lds
v_mfma_f32_16x16x32_bf16 v[180:183], a[252:255], a[52:55], v[180:183]
ds_read_b128 a[24:27], v42 offset:36864
ds_read_b64_tr_b16 a[224:225], v26 offset:0
v_mfma_f32_16x16x32_bf16 v[184:187], a[248:251], a[40:43], v[184:187]
ds_read_b128 a[28:31], v42 offset:38912
v_sub_u32 v212, v210, v212
v_mfma_f32_16x16x32_bf16 v[184:187], a[252:255], a[56:59], v[184:187]
ds_read_b64_tr_b16 a[226:227], v26 offset:1024
s_add_u32 s91, s92, s93
v_mfma_f32_16x16x32_bf16 v[188:191], a[248:251], a[44:47], v[188:191]
buffer_load_dwordx4 v31, s[8:11], s42 offen offset:3072 lds
v_mfma_f32_16x16x32_bf16 v[188:191], a[252:255], a[60:63], v[188:191]
ds_read_b64_tr_b16 a[228:229], v26 offset:8192
v_mul_u32_u24 v211, 1280, v211
ds_read_b64_tr_b16 a[230:231], v26 offset:9216
s_waitcnt lgkmcnt(3)
v_mfma_f32_16x16x32_bf16 v[64:67], a[192:195], a[0:3], v[64:67]
ds_read_b64_tr_b16 a[128:129], v204 offset:0
ds_read_b64_tr_b16 a[232:233], v26 offset:8
v_mfma_f32_16x16x32_bf16 v[64:67], a[196:199], a[16:19], v[64:67]
v_lshl_add_u32 v211, v212, 4, v211
v_mfma_f32_16x16x32_bf16 v[68:71], a[192:195], a[4:7], v[68:71]
s_lshr_b32 s92, s86, 1
ds_read_b64_tr_b16 a[130:131], v204 offset:1024
v_mfma_f32_16x16x32_bf16 v[68:71], a[196:199], a[20:23], v[68:71]
ds_read_b64_tr_b16 a[234:235], v26 offset:1032
s_bfe_u32 s43, s70, 0x4001c
v_mfma_f32_16x16x32_bf16 v[72:75], a[192:195], a[8:11], v[72:75]
s_mul_i32 s43, s43, 128
s_add_u32 m0, s47, 32768
v_mfma_f32_16x16x32_bf16 v[72:75], a[196:199], a[24:27], v[72:75]
buffer_load_dwordx4 v32, s[4:7], s43 offen offset:0 lds
v_mfma_f32_16x16x32_bf16 v[76:79], a[192:195], a[12:15], v[76:79]
ds_read_b64_tr_b16 a[132:133], v204 offset:8192
ds_read_b64_tr_b16 a[236:237], v26 offset:8200
v_mfma_f32_16x16x32_bf16 v[76:79], a[196:199], a[28:31], v[76:79]
v_subrev_u32 v36, 0, v211
ds_read_b64_tr_b16 a[134:135], v204 offset:9216
v_mfma_f32_16x16x32_bf16 v[80:83], a[200:203], a[0:3], v[80:83]
ds_read_b64_tr_b16 a[136:137], v204 offset:8
ds_read_b64_tr_b16 a[238:239], v26 offset:9224
v_mfma_f32_16x16x32_bf16 v[80:83], a[204:207], a[16:19], v[80:83]
s_mul_i32 s92, s92, 7
ds_read_b64_tr_b16 a[138:139], v204 offset:1032
v_mfma_f32_16x16x32_bf16 v[84:87], a[200:203], a[4:7], v[84:87]
buffer_load_dwordx4 v33, s[4:7], s43 offen offset:1024 lds
v_mfma_f32_16x16x32_bf16 v[84:87], a[204:207], a[20:23], v[84:87]
v_add_u32 v210, 64, v208
ds_read_b64_tr_b16 a[240:241], v27 offset:0
v_mfma_f32_16x16x32_bf16 v[88:91], a[200:203], a[8:11], v[88:91]
ds_read_b64_tr_b16 a[140:141], v204 offset:8200
ds_read_b64_tr_b16 a[142:143], v204 offset:9224
v_mfma_f32_16x16x32_bf16 v[88:91], a[204:207], a[24:27], v[88:91]
ds_read_b64_tr_b16 a[242:243], v27 offset:1024
v_mul_u32_u24 v211, 6554, v210
v_mfma_f32_16x16x32_bf16 v[92:95], a[200:203], a[12:15], v[92:95]
s_lshr_b32 s93, s87, 2
ds_read_b64_tr_b16 a[244:245], v27 offset:8192
v_mfma_f32_16x16x32_bf16 v[92:95], a[204:207], a[28:31], v[92:95]
buffer_load_dwordx4 v34, s[4:7], s43 offen offset:2048 lds
v_mfma_f32_16x16x32_bf16 v[96:99], a[208:211], a[0:3], v[96:99]
v_lshrrev_b32 v211, 16, v211
ds_read_b64_tr_b16 a[246:247], v27 offset:9216
v_mfma_f32_16x16x32_bf16 v[96:99], a[212:215], a[16:19], v[96:99]
ds_read_b64_tr_b16 a[248:249], v27 offset:8
v_mul_u32_u24 v212, 10, v211
v_mfma_f32_16x16x32_bf16 v[100:103], a[208:211], a[4:7], v[100:103]
buffer_load_dwordx4 v35, s[4:7], s43 offen offset:3072 lds
v_mfma_f32_16x16x32_bf16 v[100:103], a[212:215], a[20:23], v[100:103]
s_waitcnt lgkmcnt(4)
v_smfmac_f32_16x16x64_bf16 v[46:49], v[192:195], a[128:135], v205
v_smfmac_f32_16x16x64_bf16 v[50:53], v[192:195], a[136:143], v205
s_add_u32 s90, s92, s93
ds_read_b64_tr_b16 a[250:251], v27 offset:1032
v_mfma_f32_16x16x32_bf16 v[104:107], a[208:211], a[8:11], v[104:107]
v_sub_u32 v212, v210, v212
ds_read_b64_tr_b16 a[252:253], v27 offset:8200
v_mfma_f32_16x16x32_bf16 v[104:107], a[212:215], a[24:27], v[104:107]
ds_read_b64_tr_b16 a[254:255], v27 offset:9224
s_add_u32 s43, s43, 40960
v_mfma_f32_16x16x32_bf16 v[108:111], a[208:211], a[12:15], v[108:111]
s_add_u32 m0, s47, 36864
v_mfma_f32_16x16x32_bf16 v[108:111], a[212:215], a[28:31], v[108:111]
buffer_load_dwordx4 v32, s[4:7], s43 offen offset:0 lds
v_mfma_f32_16x16x32_bf16 v[112:115], a[216:219], a[0:3], v[112:115]
v_mul_u32_u24 v211, 1280, v211
s_cmp_ge_u32 s93, 7
s_cselect_b32 s90, 27, s90
v_mfma_f32_16x16x32_bf16 v[112:115], a[220:223], a[16:19], v[112:115]
s_waitcnt vmcnt(17)
s_barrier
v_mfma_f32_16x16x32_bf16 v[116:119], a[216:219], a[4:7], v[116:119]
v_lshl_add_u32 v211, v212, 4, v211
ds_read_b64_tr_b16 a[192:193], v24 offset:16384
v_mfma_f32_16x16x32_bf16 v[116:119], a[220:223], a[20:23], v[116:119]
ds_read_b64_tr_b16 a[194:195], v24 offset:17408
v_mfma_f32_16x16x32_bf16 v[120:123], a[216:219], a[8:11], v[120:123]
buffer_load_dwordx4 v33, s[4:7], s43 offen offset:1024 lds
v_mfma_f32_16x16x32_bf16 v[120:123], a[220:223], a[24:27], v[120:123]
s_cmp_ge_u32 s90, 27
s_cselect_b32 s3, 1, 0
v_subrev_u32 v37, 1024, v211
v_mfma_f32_16x16x32_bf16 v[124:127], a[216:219], a[12:15], v[124:127]
ds_read_b64_tr_b16 a[196:197], v24 offset:24576
ds_read_b64_tr_b16 a[198:199], v24 offset:25600
v_mfma_f32_16x16x32_bf16 v[124:127], a[220:223], a[28:31], v[124:127]
v_add_u32 v210, 128, v208
v_mfma_f32_16x16x32_bf16 v[128:131], a[224:227], a[0:3], v[128:131]
buffer_load_dwordx4 v34, s[4:7], s43 offen offset:2048 lds
v_mfma_f32_16x16x32_bf16 v[128:131], a[228:231], a[16:19], v[128:131]
ds_read_b64_tr_b16 a[200:201], v24 offset:16392
s_min_u32 s90, s90, 26
v_mfma_f32_16x16x32_bf16 v[132:135], a[224:227], a[4:7], v[132:135]
v_mul_u32_u24 v211, 6554, v210
ds_read_b64_tr_b16 a[202:203], v24 offset:17416
v_mfma_f32_16x16x32_bf16 v[132:135], a[228:231], a[20:23], v[132:135]
v_mfma_f32_16x16x32_bf16 v[136:139], a[224:227], a[8:11], v[136:139]
ds_read_b64_tr_b16 a[204:205], v24 offset:24584
v_mfma_f32_16x16x32_bf16 v[136:139], a[228:231], a[24:27], v[136:139]
buffer_load_dwordx4 v35, s[4:7], s43 offen offset:3072 lds
v_mfma_f32_16x16x32_bf16 v[140:143], a[224:227], a[12:15], v[140:143]
v_lshrrev_b32 v211, 16, v211
s_mov_b32 s44, 0
v_mfma_f32_16x16x32_bf16 v[140:143], a[228:231], a[28:31], v[140:143]
ds_read_b64_tr_b16 a[206:207], v24 offset:25608
v_mul_u32_u24 v212, 10, v211
v_mfma_f32_16x16x32_bf16 v[144:147], a[232:235], a[0:3], v[144:147]
ds_read_b64_tr_b16 a[208:209], v25 offset:16384
v_mfma_f32_16x16x32_bf16 v[144:147], a[236:239], a[16:19], v[144:147]
v_mfma_f32_16x16x32_bf16 v[148:151], a[232:235], a[4:7], v[148:151]
ds_read_b64_tr_b16 a[210:211], v25 offset:17408
v_sub_u32 v212, v210, v212
v_mfma_f32_16x16x32_bf16 v[148:151], a[236:239], a[20:23], v[148:151]
s_and_b32 s92, s2, 1
v_mfma_f32_16x16x32_bf16 v[152:155], a[232:235], a[8:11], v[152:155]
ds_read_b64_tr_b16 a[212:213], v25 offset:24576
s_bfe_u32 s42, s70, 0x4001c
v_mfma_f32_16x16x32_bf16 v[152:155], a[236:239], a[24:27], v[152:155]
s_mul_i32 s42, s42, 524288
s_mov_b32 m0, s55
v_mfma_f32_16x16x32_bf16 v[156:159], a[232:235], a[12:15], v[156:159]
v_mul_u32_u24 v211, 1280, v211
ds_read_b64_tr_b16 a[214:215], v25 offset:25600
v_mfma_f32_16x16x32_bf16 v[156:159], a[236:239], a[28:31], v[156:159]
ds_read_b128 a[32:35], v61 offset:0
s_waitcnt lgkmcnt(13)
v_mfma_f32_16x16x32_bf16 v[160:163], a[240:243], a[0:3], v[160:163]
buffer_load_dwordx4 v28, s[8:11], s42 offen offset:0 lds
v_mfma_f32_16x16x32_bf16 v[160:163], a[244:247], a[16:19], v[160:163]
ds_read_b128 a[36:39], v61 offset:2048
ds_read_b64_tr_b16 a[216:217], v25 offset:16392
v_mfma_f32_16x16x32_bf16 v[164:167], a[240:243], a[4:7], v[164:167]
v_lshl_add_u32 v211, v212, 4, v211
s_lshl_b32 s92, s92, 2
v_mfma_f32_16x16x32_bf16 v[164:167], a[244:247], a[20:23], v[164:167]
ds_read_b128 a[40:43], v61 offset:4096
ds_read_b64_tr_b16 a[218:219], v25 offset:17416
v_mfma_f32_16x16x32_bf16 v[168:171], a[240:243], a[8:11], v[168:171]
ds_read_b128 a[44:47], v61 offset:6144
v_mfma_f32_16x16x32_bf16 v[168:171], a[244:247], a[24:27], v[168:171]
buffer_load_dwordx4 v29, s[8:11], s42 offen offset:1024 lds
v_mfma_f32_16x16x32_bf16 v[172:175], a[240:243], a[12:15], v[172:175]
v_subrev_u32 v38, 2048, v211
ds_read_b64_tr_b16 a[220:221], v25 offset:24584
v_mfma_f32_16x16x32_bf16 v[172:175], a[244:247], a[28:31], v[172:175]
ds_read_b128 a[48:51], v62 offset:0
s_add_u32 s92, s92, s40
v_mfma_f32_16x16x32_bf16 v[176:179], a[248:251], a[0:3], v[176:179]
ds_read_b64_tr_b16 a[222:223], v25 offset:25608
ds_read_b128 a[52:55], v62 offset:2048
v_mfma_f32_16x16x32_bf16 v[176:179], a[252:255], a[16:19], v[176:179]
v_add_u32 v210, 192, v208
v_mfma_f32_16x16x32_bf16 v[180:183], a[248:251], a[4:7], v[180:183]
buffer_load_dwordx4 v30, s[8:11], s42 offen offset:2048 lds
v_mfma_f32_16x16x32_bf16 v[180:183], a[252:255], a[20:23], v[180:183]
ds_read_b128 a[56:59], v62 offset:4096
ds_read_b64_tr_b16 a[224:225], v26 offset:16384
v_mfma_f32_16x16x32_bf16 v[184:187], a[248:251], a[8:11], v[184:187]
ds_read_b128 a[60:63], v62 offset:6144
v_mul_u32_u24 v211, 6554, v210
v_mfma_f32_16x16x32_bf16 v[184:187], a[252:255], a[24:27], v[184:187]
ds_read_b64_tr_b16 a[226:227], v26 offset:17408
s_lshr_b32 s93, s2, 1
v_mfma_f32_16x16x32_bf16 v[188:191], a[248:251], a[12:15], v[188:191]
buffer_load_dwordx4 v31, s[8:11], s42 offen offset:3072 lds
v_mfma_f32_16x16x32_bf16 v[188:191], a[252:255], a[28:31], v[188:191]
ds_read_b64_tr_b16 a[228:229], v26 offset:24576
v_lshrrev_b32 v211, 16, v211
ds_read_b64_tr_b16 a[230:231], v26 offset:25600
s_waitcnt lgkmcnt(3)
v_mfma_f32_16x16x32_bf16 v[64:67], a[192:195], a[32:35], v[64:67]
ds_read_b64_tr_b16 a[128:129], v204 offset:16384
ds_read_b64_tr_b16 a[232:233], v26 offset:16392
v_mfma_f32_16x16x32_bf16 v[64:67], a[196:199], a[48:51], v[64:67]
v_mul_u32_u24 v212, 10, v211
v_mfma_f32_16x16x32_bf16 v[68:71], a[192:195], a[36:39], v[68:71]
s_mul_i32 s94, s92, 160
ds_read_b64_tr_b16 a[130:131], v204 offset:17408
v_mfma_f32_16x16x32_bf16 v[68:71], a[196:199], a[52:55], v[68:71]
ds_read_b64_tr_b16 a[234:235], v26 offset:17416
s_bfe_u32 s43, s71, 0x40000
v_mfma_f32_16x16x32_bf16 v[72:75], a[192:195], a[40:43], v[72:75]
s_mul_i32 s43, s43, 128
s_add_u32 m0, s47, 131072
v_mfma_f32_16x16x32_bf16 v[72:75], a[196:199], a[56:59], v[72:75]
buffer_load_dwordx4 v32, s[4:7], s43 offen offset:0 lds
v_mfma_f32_16x16x32_bf16 v[76:79], a[192:195], a[44:47], v[76:79]
ds_read_b64_tr_b16 a[132:133], v204 offset:24576
v_sub_u32 v212, v210, v212
v_mfma_f32_16x16x32_bf16 v[76:79], a[196:199], a[60:63], v[76:79]
ds_read_b64_tr_b16 a[236:237], v26 offset:24584
ds_read_b64_tr_b16 a[134:135], v204 offset:25600
v_mfma_f32_16x16x32_bf16 v[80:83], a[200:203], a[32:35], v[80:83]
s_mul_i32 s95, s93, 40960
ds_read_b64_tr_b16 a[136:137], v204 offset:16392
v_mfma_f32_16x16x32_bf16 v[80:83], a[204:207], a[48:51], v[80:83]
ds_read_b64_tr_b16 a[238:239], v26 offset:25608
v_mul_u32_u24 v211, 1280, v211
v_mfma_f32_16x16x32_bf16 v[84:87], a[200:203], a[36:39], v[84:87]
ds_read_b64_tr_b16 a[138:139], v204 offset:17416
v_mfma_f32_16x16x32_bf16 v[84:87], a[204:207], a[52:55], v[84:87]
buffer_load_dwordx4 v33, s[4:7], s43 offen offset:1024 lds
v_mfma_f32_16x16x32_bf16 v[88:91], a[200:203], a[40:43], v[88:91]
ds_read_b64_tr_b16 a[240:241], v27 offset:16384
ds_read_b64_tr_b16 a[140:141], v204 offset:24584
v_mfma_f32_16x16x32_bf16 v[88:91], a[204:207], a[56:59], v[88:91]
v_lshl_add_u32 v211, v212, 4, v211
ds_read_b64_tr_b16 a[142:143], v204 offset:25608
v_mfma_f32_16x16x32_bf16 v[92:95], a[200:203], a[44:47], v[92:95]
ds_read_b64_tr_b16 a[242:243], v27 offset:17408
s_add_u32 s94, s94, s95
v_mfma_f32_16x16x32_bf16 v[92:95], a[204:207], a[60:63], v[92:95]
ds_read_b64_tr_b16 a[244:245], v27 offset:24576
v_mfma_f32_16x16x32_bf16 v[96:99], a[208:211], a[32:35], v[96:99]
buffer_load_dwordx4 v34, s[4:7], s43 offen offset:2048 lds
v_mfma_f32_16x16x32_bf16 v[96:99], a[212:215], a[48:51], v[96:99]
v_subrev_u32 v39, 3072, v211
ds_read_b64_tr_b16 a[246:247], v27 offset:25600
v_mfma_f32_16x16x32_bf16 v[100:103], a[208:211], a[36:39], v[100:103]
v_add_u32 v210, 256, v208
s_add_u32 s24, s68, s94
s_addc_u32 s25, s69, 0
v_mfma_f32_16x16x32_bf16 v[100:103], a[212:215], a[52:55], v[100:103]
s_waitcnt lgkmcnt(3)
v_smfmac_f32_16x16x64_bf16 v[46:49], v[192:195], a[128:135], v205
v_smfmac_f32_16x16x64_bf16 v[50:53], v[192:195], a[136:143], v205
ds_read_b64_tr_b16 a[248:249], v27 offset:16392
v_mfma_f32_16x16x32_bf16 v[104:107], a[208:211], a[40:43], v[104:107]
buffer_load_dwordx4 v35, s[4:7], s43 offen offset:3072 lds
v_mfma_f32_16x16x32_bf16 v[104:107], a[212:215], a[56:59], v[104:107]
ds_read_b64_tr_b16 a[250:251], v27 offset:17416
v_mul_u32_u24 v211, 6554, v210
v_mfma_f32_16x16x32_bf16 v[108:111], a[208:211], a[44:47], v[108:111]
ds_read_b64_tr_b16 a[252:253], v27 offset:24584
s_mov_b32 s26, 39840
v_mfma_f32_16x16x32_bf16 v[108:111], a[212:215], a[60:63], v[108:111]
v_lshrrev_b32 v211, 16, v211
ds_read_b64_tr_b16 a[254:255], v27 offset:25608
v_mfma_f32_16x16x32_bf16 v[112:115], a[216:219], a[32:35], v[112:115]
s_add_u32 s43, s43, 40960
s_add_u32 m0, s47, 135168
v_mfma_f32_16x16x32_bf16 v[112:115], a[220:223], a[48:51], v[112:115]
buffer_load_dwordx4 v32, s[4:7], s43 offen offset:0 lds
v_mfma_f32_16x16x32_bf16 v[116:119], a[216:219], a[36:39], v[116:119]
v_mul_u32_u24 v212, 10, v211
s_waitcnt vmcnt(17)
v_mfma_f32_16x16x32_bf16 v[116:119], a[220:223], a[52:55], v[116:119]
s_barrier
s_mov_b32 s27, 0x20000
v_mfma_f32_16x16x32_bf16 v[120:123], a[216:219], a[40:43], v[120:123]
ds_read_b64_tr_b16 a[192:193], v24 offset:32768
ds_read_b64_tr_b16 a[194:195], v24 offset:33792
v_mfma_f32_16x16x32_bf16 v[120:123], a[220:223], a[56:59], v[120:123]
buffer_load_dwordx4 v33, s[4:7], s43 offen offset:1024 lds
v_mfma_f32_16x16x32_bf16 v[124:127], a[216:219], a[44:47], v[124:127]
v_sub_u32 v212, v210, v212
ds_read_b64_tr_b16 a[196:197], v24 offset:40960
v_mfma_f32_16x16x32_bf16 v[124:127], a[220:223], a[60:63], v[124:127]
v_mul_u32_u24 v211, 1280, v211
s_lshl_b32 s92, s92, 7
v_mfma_f32_16x16x32_bf16 v[128:131], a[224:227], a[32:35], v[128:131]
ds_read_b64_tr_b16 a[198:199], v24 offset:41984
v_mfma_f32_16x16x32_bf16 v[128:131], a[228:231], a[48:51], v[128:131]
buffer_load_dwordx4 v34, s[4:7], s43 offen offset:2048 lds
v_mfma_f32_16x16x32_bf16 v[132:135], a[224:227], a[36:39], v[132:135]
ds_read_b64_tr_b16 a[200:201], v24 offset:32776
v_lshl_add_u32 v211, v212, 4, v211
v_mfma_f32_16x16x32_bf16 v[132:135], a[228:231], a[52:55], v[132:135]
ds_read_b64_tr_b16 a[202:203], v24 offset:33800
v_subrev_u32 v40, 0, v211
v_mfma_f32_16x16x32_bf16 v[136:139], a[224:227], a[40:43], v[136:139]
s_add_u32 s92, s92, s93
ds_read_b64_tr_b16 a[204:205], v24 offset:40968
v_mfma_f32_16x16x32_bf16 v[136:139], a[228:231], a[56:59], v[136:139]
buffer_load_dwordx4 v35, s[4:7], s43 offen offset:3072 lds
v_mfma_f32_16x16x32_bf16 v[140:143], a[224:227], a[44:47], v[140:143]
v_lshrrev_b32 v210, 3, v59
ds_read_b64_tr_b16 a[206:207], v24 offset:41992
v_mfma_f32_16x16x32_bf16 v[140:143], a[228:231], a[60:63], v[140:143]
s_mul_i32 s92, s92, 5120
v_mfma_f32_16x16x32_bf16 v[144:147], a[232:235], a[32:35], v[144:147]
ds_read_b64_tr_b16 a[208:209], v25 offset:32768
v_lshlrev_b32 v210, 7, v210
v_mfma_f32_16x16x32_bf16 v[144:147], a[236:239], a[48:51], v[144:147]
v_mfma_f32_16x16x32_bf16 v[148:151], a[232:235], a[36:39], v[148:151]
ds_read_b64_tr_b16 a[210:211], v25 offset:33792
v_mfma_f32_16x16x32_bf16 v[148:151], a[236:239], a[52:55], v[148:151]
v_and_b32 v211, 7, v59
v_mfma_f32_16x16x32_bf16 v[152:155], a[232:235], a[40:43], v[152:155]
ds_read_b64_tr_b16 a[212:213], v25 offset:40960
s_bfe_u32 s42, s71, 0x40000
v_mfma_f32_16x16x32_bf16 v[152:155], a[236:239], a[56:59], v[152:155]
s_mul_i32 s42, s42, 524288
s_mov_b32 m0, s52
v_mfma_f32_16x16x32_bf16 v[156:159], a[232:235], a[44:47], v[156:159]
s_add_u32 s92, s92, 37748736
ds_read_b64_tr_b16 a[214:215], v25 offset:41984
v_mfma_f32_16x16x32_bf16 v[156:159], a[236:239], a[60:63], v[156:159]
ds_read_b128 a[0:3], v41 offset:0
s_waitcnt lgkmcnt(13)
v_mfma_f32_16x16x32_bf16 v[160:163], a[240:243], a[32:35], v[160:163]
v_lshl_add_u32 v45, v211, 3, v210
v_mfma_f32_16x16x32_bf16 v[160:163], a[244:247], a[48:51], v[160:163]
buffer_load_dwordx4 v28, s[8:11], s42 offen offset:0 lds
v_mfma_f32_16x16x32_bf16 v[164:167], a[240:243], a[36:39], v[164:167]
ds_read_b128 a[4:7], v41 offset:2048
ds_read_b64_tr_b16 a[216:217], v25 offset:32776
v_mfma_f32_16x16x32_bf16 v[164:167], a[244:247], a[52:55], v[164:167]
ds_read_b128 a[8:11], v41 offset:4096
v_mov_b32 v20, v192
v_mfma_f32_16x16x32_bf16 v[168:171], a[240:243], a[40:43], v[168:171]
s_add_u32 s32, s84, s92
s_addc_u32 s33, s85, 0
ds_read_b64_tr_b16 a[218:219], v25 offset:33800
v_mfma_f32_16x16x32_bf16 v[168:171], a[244:247], a[56:59], v[168:171]
ds_read_b128 a[12:15], v41 offset:6144
v_mfma_f32_16x16x32_bf16 v[172:175], a[240:243], a[44:47], v[172:175]
buffer_load_dwordx4 v29, s[8:11], s42 offen offset:1024 lds
v_mfma_f32_16x16x32_bf16 v[172:175], a[244:247], a[60:63], v[172:175]
ds_read_b64_tr_b16 a[220:221], v25 offset:40968
ds_read_b128 a[16:19], v42 offset:0
v_mfma_f32_16x16x32_bf16 v[176:179], a[248:251], a[32:35], v[176:179]
v_mov_b32 v21, v192
ds_read_b64_tr_b16 a[222:223], v25 offset:41992
v_mfma_f32_16x16x32_bf16 v[176:179], a[252:255], a[48:51], v[176:179]
ds_read_b128 a[20:23], v42 offset:2048
s_mov_b32 s34, 5120
v_mfma_f32_16x16x32_bf16 v[180:183], a[248:251], a[36:39], v[180:183]
buffer_load_dwordx4 v30, s[8:11], s42 offen offset:2048 lds
v_mfma_f32_16x16x32_bf16 v[180:183], a[252:255], a[52:55], v[180:183]
ds_read_b128 a[24:27], v42 offset:4096
v_mov_b32 v22, v192
v_mfma_f32_16x16x32_bf16 v[184:187], a[248:251], a[40:43], v[184:187]
ds_read_b64_tr_b16 a[224:225], v26 offset:32768
ds_read_b128 a[28:31], v42 offset:6144
v_mfma_f32_16x16x32_bf16 v[184:187], a[252:255], a[56:59], v[184:187]
ds_read_b64_tr_b16 a[226:227], v26 offset:33792
v_mov_b32 v23, v192
v_mfma_f32_16x16x32_bf16 v[188:191], a[248:251], a[44:47], v[188:191]
buffer_load_dwordx4 v31, s[8:11], s42 offen offset:3072 lds
v_mfma_f32_16x16x32_bf16 v[188:191], a[252:255], a[60:63], v[188:191]
s_mov_b32 s35, 0x20000
ds_read_b64_tr_b16 a[228:229], v26 offset:40960
v_add_u32 v63, 4096, v1
ds_read_b64_tr_b16 a[230:231], v26 offset:41984
s_waitcnt lgkmcnt(3)
v_mfma_f32_16x16x32_bf16 v[64:67], a[192:195], a[0:3], v[64:67]
ds_read_b64_tr_b16 a[128:129], v204 offset:32768
ds_read_b64_tr_b16 a[232:233], v26 offset:32776
v_mfma_f32_16x16x32_bf16 v[64:67], a[196:199], a[16:19], v[64:67]
ds_read_b64_tr_b16 a[130:131], v204 offset:33792
v_mfma_f32_16x16x32_bf16 v[68:71], a[192:195], a[4:7], v[68:71]
ds_read_b64_tr_b16 a[234:235], v26 offset:33800
s_bfe_u32 s43, s71, 0x40004
v_mfma_f32_16x16x32_bf16 v[68:71], a[196:199], a[20:23], v[68:71]
s_mul_i32 s43, s43, 128
s_add_u32 m0, s47, 0
v_mfma_f32_16x16x32_bf16 v[72:75], a[192:195], a[8:11], v[72:75]
buffer_load_dwordx4 v32, s[4:7], s43 offen offset:0 lds
v_mfma_f32_16x16x32_bf16 v[72:75], a[196:199], a[24:27], v[72:75]
ds_read_b64_tr_b16 a[132:133], v204 offset:40960
ds_read_b64_tr_b16 a[236:237], v26 offset:40968
v_mfma_f32_16x16x32_bf16 v[76:79], a[192:195], a[12:15], v[76:79]
ds_read_b64_tr_b16 a[134:135], v204 offset:41984
ds_read_b64_tr_b16 a[136:137], v204 offset:32776
v_mfma_f32_16x16x32_bf16 v[76:79], a[196:199], a[28:31], v[76:79]
ds_read_b64_tr_b16 a[238:239], v26 offset:41992
ds_read_b64_tr_b16 a[138:139], v204 offset:33800
v_mfma_f32_16x16x32_bf16 v[80:83], a[200:203], a[0:3], v[80:83]
buffer_load_dwordx4 v33, s[4:7], s43 offen offset:1024 lds
v_mfma_f32_16x16x32_bf16 v[80:83], a[204:207], a[16:19], v[80:83]
ds_read_b64_tr_b16 a[240:241], v27 offset:32768
ds_read_b64_tr_b16 a[140:141], v204 offset:40968
v_mfma_f32_16x16x32_bf16 v[84:87], a[200:203], a[4:7], v[84:87]
ds_read_b64_tr_b16 a[142:143], v204 offset:41992
ds_read_b64_tr_b16 a[242:243], v27 offset:33792
v_mfma_f32_16x16x32_bf16 v[84:87], a[204:207], a[20:23], v[84:87]
ds_read_b64_tr_b16 a[244:245], v27 offset:40960
v_mfma_f32_16x16x32_bf16 v[88:91], a[200:203], a[8:11], v[88:91]
buffer_load_dwordx4 v34, s[4:7], s43 offen offset:2048 lds
v_mfma_f32_16x16x32_bf16 v[88:91], a[204:207], a[24:27], v[88:91]
s_lshl_b32 s92, s89, 7
ds_read_b64_tr_b16 a[246:247], v27 offset:41984
v_mfma_f32_16x16x32_bf16 v[92:95], a[200:203], a[12:15], v[92:95]
s_add_u32 s92, s92, 1024
v_mfma_f32_16x16x32_bf16 v[92:95], a[204:207], a[28:31], v[92:95]
ds_read_b64_tr_b16 a[248:249], v27 offset:32776
v_lshrrev_b32 v54, 4, v1
v_mfma_f32_16x16x32_bf16 v[96:99], a[208:211], a[0:3], v[96:99]
buffer_load_dwordx4 v35, s[4:7], s43 offen offset:3072 lds
v_mfma_f32_16x16x32_bf16 v[96:99], a[212:215], a[16:19], v[96:99]
ds_read_b64_tr_b16 a[250:251], v27 offset:33800
v_and_b32 v54, 31, v54
v_mfma_f32_16x16x32_bf16 v[100:103], a[208:211], a[4:7], v[100:103]
v_mfma_f32_16x16x32_bf16 v[100:103], a[212:215], a[20:23], v[100:103]
s_waitcnt lgkmcnt(5)
v_smfmac_f32_16x16x64_bf16 v[46:49], v[192:195], a[128:135], v205
v_smfmac_f32_16x16x64_bf16 v[50:53], v[192:195], a[136:143], v205
ds_read_b64_tr_b16 a[252:253], v27 offset:40968
v_lshl_add_u32 v54, v54, 2, s92
v_mfma_f32_16x16x32_bf16 v[104:107], a[208:211], a[8:11], v[104:107]
v_mfma_f32_16x16x32_bf16 v[104:107], a[212:215], a[24:27], v[104:107]
ds_read_b64_tr_b16 a[254:255], v27 offset:41992
s_add_u32 s43, s43, 40960
v_mfma_f32_16x16x32_bf16 v[108:111], a[208:211], a[12:15], v[108:111]
s_add_u32 m0, s47, 4096
v_mfma_f32_16x16x32_bf16 v[108:111], a[212:215], a[28:31], v[108:111]
buffer_load_dwordx4 v32, s[4:7], s43 offen offset:0 lds
v_mfma_f32_16x16x32_bf16 v[112:115], a[216:219], a[0:3], v[112:115]
buffer_load_dword v55, v54, s[56:59], 0 offen sc1
v_mfma_f32_16x16x32_bf16 v[112:115], a[220:223], a[16:19], v[112:115]
s_waitcnt vmcnt(18)
s_barrier
v_mfma_f32_16x16x32_bf16 v[116:119], a[216:219], a[4:7], v[116:119]
ds_read_b64_tr_b16 a[192:193], v24 offset:49152
ds_read_b64_tr_b16 a[194:195], v24 offset:50176
v_mfma_f32_16x16x32_bf16 v[116:119], a[220:223], a[20:23], v[116:119]
buffer_load_dwordx4 v33, s[4:7], s43 offen offset:1024 lds
v_mfma_f32_16x16x32_bf16 v[120:123], a[216:219], a[8:11], v[120:123]
ds_read_b64_tr_b16 a[196:197], v24 offset:57344
v_mfma_f32_16x16x32_bf16 v[120:123], a[220:223], a[24:27], v[120:123]
v_mfma_f32_16x16x32_bf16 v[124:127], a[216:219], a[12:15], v[124:127]
ds_read_b64_tr_b16 a[198:199], v24 offset:58368
v_mfma_f32_16x16x32_bf16 v[124:127], a[220:223], a[28:31], v[124:127]
buffer_load_dwordx4 v34, s[4:7], s43 offen offset:2048 lds
v_mfma_f32_16x16x32_bf16 v[128:131], a[224:227], a[0:3], v[128:131]
ds_read_b64_tr_b16 a[200:201], v24 offset:49160
v_mfma_f32_16x16x32_bf16 v[128:131], a[228:231], a[16:19], v[128:131]
v_mfma_f32_16x16x32_bf16 v[132:135], a[224:227], a[4:7], v[132:135]
ds_read_b64_tr_b16 a[202:203], v24 offset:50184
v_mfma_f32_16x16x32_bf16 v[132:135], a[228:231], a[20:23], v[132:135]
v_mfma_f32_16x16x32_bf16 v[136:139], a[224:227], a[8:11], v[136:139]
ds_read_b64_tr_b16 a[204:205], v24 offset:57352
v_mfma_f32_16x16x32_bf16 v[136:139], a[228:231], a[24:27], v[136:139]
buffer_load_dwordx4 v35, s[4:7], s43 offen offset:3072 lds
v_mfma_f32_16x16x32_bf16 v[140:143], a[224:227], a[12:15], v[140:143]
ds_read_b64_tr_b16 a[206:207], v24 offset:58376
v_mfma_f32_16x16x32_bf16 v[140:143], a[228:231], a[28:31], v[140:143]
v_mfma_f32_16x16x32_bf16 v[144:147], a[232:235], a[0:3], v[144:147]
ds_read_b64_tr_b16 a[208:209], v25 offset:49152
v_mfma_f32_16x16x32_bf16 v[144:147], a[236:239], a[16:19], v[144:147]
v_mfma_f32_16x16x32_bf16 v[148:151], a[232:235], a[4:7], v[148:151]
ds_read_b64_tr_b16 a[210:211], v25 offset:50176
v_mfma_f32_16x16x32_bf16 v[148:151], a[236:239], a[20:23], v[148:151]
v_mfma_f32_16x16x32_bf16 v[152:155], a[232:235], a[8:11], v[152:155]
ds_read_b64_tr_b16 a[212:213], v25 offset:57344
s_bfe_u32 s42, s71, 0x40004
v_mfma_f32_16x16x32_bf16 v[152:155], a[236:239], a[24:27], v[152:155]
s_mul_i32 s42, s42, 524288
s_mov_b32 m0, s53
v_mfma_f32_16x16x32_bf16 v[156:159], a[232:235], a[12:15], v[156:159]
ds_read_b64_tr_b16 a[214:215], v25 offset:58368
v_mfma_f32_16x16x32_bf16 v[156:159], a[236:239], a[28:31], v[156:159]
ds_read_b128 a[32:35], v41 offset:32768
s_waitcnt lgkmcnt(13)
v_mfma_f32_16x16x32_bf16 v[160:163], a[240:243], a[0:3], v[160:163]
buffer_load_dwordx4 v28, s[8:11], s42 offen offset:0 lds
v_mfma_f32_16x16x32_bf16 v[160:163], a[244:247], a[16:19], v[160:163]
ds_read_b128 a[36:39], v41 offset:34816
ds_read_b64_tr_b16 a[216:217], v25 offset:49160
v_mfma_f32_16x16x32_bf16 v[164:167], a[240:243], a[4:7], v[164:167]
ds_read_b128 a[40:43], v41 offset:36864
ds_read_b64_tr_b16 a[218:219], v25 offset:50184
v_mfma_f32_16x16x32_bf16 v[164:167], a[244:247], a[20:23], v[164:167]
ds_read_b128 a[44:47], v41 offset:38912
v_mfma_f32_16x16x32_bf16 v[168:171], a[240:243], a[8:11], v[168:171]
buffer_load_dwordx4 v29, s[8:11], s42 offen offset:1024 lds
v_mfma_f32_16x16x32_bf16 v[168:171], a[244:247], a[24:27], v[168:171]
ds_read_b64_tr_b16 a[220:221], v25 offset:57352
ds_read_b128 a[48:51], v42 offset:32768
v_mfma_f32_16x16x32_bf16 v[172:175], a[240:243], a[12:15], v[172:175]
ds_read_b64_tr_b16 a[222:223], v25 offset:58376
ds_read_b128 a[52:55], v42 offset:34816
v_mfma_f32_16x16x32_bf16 v[172:175], a[244:247], a[28:31], v[172:175]
buffer_load_dwordx4 v30, s[8:11], s42 offen offset:2048 lds
v_mfma_f32_16x16x32_bf16 v[176:179], a[248:251], a[0:3], v[176:179]
ds_read_b128 a[56:59], v42 offset:36864
ds_read_b64_tr_b16 a[224:225], v26 offset:49152
v_mfma_f32_16x16x32_bf16 v[176:179], a[252:255], a[16:19], v[176:179]
ds_read_b128 a[60:63], v42 offset:38912
v_mfma_f32_16x16x32_bf16 v[180:183], a[248:251], a[4:7], v[180:183]
ds_read_b64_tr_b16 a[226:227], v26 offset:50176
v_mfma_f32_16x16x32_bf16 v[180:183], a[252:255], a[20:23], v[180:183]
buffer_load_dwordx4 v31, s[8:11], s42 offen offset:3072 lds
v_mfma_f32_16x16x32_bf16 v[184:187], a[248:251], a[8:11], v[184:187]
ds_read_b64_tr_b16 a[228:229], v26 offset:57344
v_mfma_f32_16x16x32_bf16 v[184:187], a[252:255], a[24:27], v[184:187]
v_mfma_f32_16x16x32_bf16 v[188:191], a[248:251], a[12:15], v[188:191]
ds_read_b64_tr_b16 a[230:231], v26 offset:58368
v_mfma_f32_16x16x32_bf16 v[188:191], a[252:255], a[28:31], v[188:191]
s_waitcnt lgkmcnt(3)
v_mfma_f32_16x16x32_bf16 v[64:67], a[192:195], a[32:35], v[64:67]
ds_read_b64_tr_b16 a[128:129], v204 offset:49152
ds_read_b64_tr_b16 a[232:233], v26 offset:49160
v_mfma_f32_16x16x32_bf16 v[64:67], a[196:199], a[48:51], v[64:67]
s_mul_i32 s46, s40, 5120
ds_read_b64_tr_b16 a[130:131], v204 offset:50176
v_mfma_f32_16x16x32_bf16 v[68:71], a[192:195], a[36:39], v[68:71]
ds_read_b64_tr_b16 a[234:235], v26 offset:50184
ds_read_b64_tr_b16 a[132:133], v204 offset:57344
v_mfma_f32_16x16x32_bf16 v[68:71], a[196:199], a[52:55], v[68:71]
s_add_u32 s71, s46, 81920
ds_read_b64_tr_b16 a[236:237], v26 offset:57352
v_mfma_f32_16x16x32_bf16 v[72:75], a[192:195], a[40:43], v[72:75]
ds_read_b64_tr_b16 a[134:135], v204 offset:58368
v_mfma_f32_16x16x32_bf16 v[72:75], a[196:199], a[56:59], v[72:75]
ds_read_b64_tr_b16 a[136:137], v204 offset:49160
ds_read_b64_tr_b16 a[238:239], v26 offset:58376
v_mfma_f32_16x16x32_bf16 v[76:79], a[192:195], a[44:47], v[76:79]
s_add_u32 s63, s91, s90
ds_read_b64_tr_b16 a[138:139], v204 offset:50184
v_mfma_f32_16x16x32_bf16 v[76:79], a[196:199], a[60:63], v[76:79]
ds_read_b64_tr_b16 a[240:241], v27 offset:49152
v_mfma_f32_16x16x32_bf16 v[80:83], a[200:203], a[32:35], v[80:83]
ds_read_b64_tr_b16 a[140:141], v204 offset:57352
s_and_b32 s63, s63, 3
v_mfma_f32_16x16x32_bf16 v[80:83], a[204:207], a[48:51], v[80:83]
ds_read_b64_tr_b16 a[142:143], v204 offset:58376
ds_read_b64_tr_b16 a[242:243], v27 offset:50176
v_mfma_f32_16x16x32_bf16 v[84:87], a[200:203], a[36:39], v[84:87]
v_mfma_f32_16x16x32_bf16 v[84:87], a[204:207], a[52:55], v[84:87]
ds_read_b64_tr_b16 a[244:245], v27 offset:57344
s_mov_b32 s64, 0x65832140
v_mfma_f32_16x16x32_bf16 v[88:91], a[200:203], a[40:43], v[88:91]
v_mfma_f32_16x16x32_bf16 v[88:91], a[204:207], a[56:59], v[88:91]
ds_read_b64_tr_b16 a[246:247], v27 offset:58368
s_mov_b32 s65, 0xfedba9c7
v_mfma_f32_16x16x32_bf16 v[92:95], a[200:203], a[44:47], v[92:95]
v_mfma_f32_16x16x32_bf16 v[92:95], a[204:207], a[60:63], v[92:95]
ds_read_b64_tr_b16 a[248:249], v27 offset:49160
v_mfma_f32_16x16x32_bf16 v[96:99], a[208:211], a[32:35], v[96:99]
s_cmp_eq_u32 s63, 1
s_cselect_b32 s64, 0x69432501, s64
s_cselect_b32 s65, 0xfecbad87, s65
v_mfma_f32_16x16x32_bf16 v[96:99], a[212:215], a[48:51], v[96:99]
ds_read_b64_tr_b16 a[250:251], v27 offset:50184
v_mfma_f32_16x16x32_bf16 v[100:103], a[208:211], a[36:39], v[100:103]
v_mfma_f32_16x16x32_bf16 v[100:103], a[212:215], a[52:55], v[100:103]
s_waitcnt lgkmcnt(5)
v_smfmac_f32_16x16x64_bf16 v[46:49], v[192:195], a[128:135], v205
v_smfmac_f32_16x16x64_bf16 v[50:53], v[192:195], a[136:143], v205
ds_read_b64_tr_b16 a[252:253], v27 offset:57352
v_mfma_f32_16x16x32_bf16 v[104:107], a[208:211], a[40:43], v[104:107]
s_cmp_eq_u32 s63, 2
s_cselect_b32 s64, 0xa5436102, s64
s_cselect_b32 s65, 0xfdcbe987, s65
v_mfma_f32_16x16x32_bf16 v[104:107], a[212:215], a[56:59], v[104:107]
ds_read_b64_tr_b16 a[254:255], v27 offset:58376
v_mfma_f32_16x16x32_bf16 v[108:111], a[208:211], a[44:47], v[108:111]
s_cmp_eq_u32 s63, 3
s_cselect_b32 s64, 0x65472103, s64
s_cselect_b32 s65, 0xedcfa98b, s65
v_mfma_f32_16x16x32_bf16 v[108:111], a[212:215], a[60:63], v[108:111]
v_mfma_f32_16x16x32_bf16 v[112:115], a[216:219], a[32:35], v[112:115]
s_waitcnt vmcnt(13)
s_barrier
v_mfma_f32_16x16x32_bf16 v[112:115], a[220:223], a[48:51], v[112:115]
ds_read_b64_tr_b16 a[192:193], v24 offset:0
v_mfma_f32_16x16x32_bf16 v[116:119], a[216:219], a[36:39], v[116:119]
ds_read_b64_tr_b16 a[194:195], v24 offset:1024
s_mov_b32 s42, 0
v_mfma_f32_16x16x32_bf16 v[116:119], a[220:223], a[52:55], v[116:119]
s_mov_b32 m0, s50
s_lshl_b32 s92, s89, 2
v_mfma_f32_16x16x32_bf16 v[120:123], a[216:219], a[40:43], v[120:123]
ds_read_b64_tr_b16 a[196:197], v24 offset:8192
v_mfma_f32_16x16x32_bf16 v[120:123], a[220:223], a[56:59], v[120:123]
s_add_u32 s92, s92, s40
v_mfma_f32_16x16x32_bf16 v[124:127], a[216:219], a[44:47], v[124:127]
ds_read_b64_tr_b16 a[198:199], v24 offset:9216
v_mfma_f32_16x16x32_bf16 v[124:127], a[220:223], a[60:63], v[124:127]
v_mfma_f32_16x16x32_bf16 v[128:131], a[224:227], a[32:35], v[128:131]
ds_read_b64_tr_b16 a[200:201], v24 offset:8
v_mfma_f32_16x16x32_bf16 v[128:131], a[228:231], a[48:51], v[128:131]
buffer_load_dwordx4 v14, s[12:15], s42 offen offset:0 lds
v_mfma_f32_16x16x32_bf16 v[132:135], a[224:227], a[36:39], v[132:135]
s_lshl_b32 s92, s92, 10
ds_read_b64_tr_b16 a[202:203], v24 offset:1032
v_mfma_f32_16x16x32_bf16 v[132:135], a[228:231], a[52:55], v[132:135]
v_mfma_f32_16x16x32_bf16 v[136:139], a[224:227], a[40:43], v[136:139]
ds_read_b64_tr_b16 a[204:205], v24 offset:8200
s_add_u32 s92, s92, 0
v_mfma_f32_16x16x32_bf16 v[136:139], a[228:231], a[56:59], v[136:139]
v_mfma_f32_16x16x32_bf16 v[140:143], a[224:227], a[44:47], v[140:143]
ds_read_b64_tr_b16 a[206:207], v24 offset:9224
v_mfma_f32_16x16x32_bf16 v[140:143], a[228:231], a[60:63], v[140:143]
v_mfma_f32_16x16x32_bf16 v[144:147], a[232:235], a[32:35], v[144:147]
ds_read_b64_tr_b16 a[208:209], v25 offset:0
s_add_u32 s20, s84, s92
s_addc_u32 s21, s85, 0
v_mfma_f32_16x16x32_bf16 v[144:147], a[236:239], a[48:51], v[144:147]
buffer_load_dwordx4 v15, s[12:15], s42 offen offset:1024 lds
v_mfma_f32_16x16x32_bf16 v[148:151], a[232:235], a[36:39], v[148:151]
ds_read_b64_tr_b16 a[210:211], v25 offset:1024
v_mfma_f32_16x16x32_bf16 v[148:151], a[236:239], a[52:55], v[148:151]
s_mov_b32 s22, 1024
v_mfma_f32_16x16x32_bf16 v[152:155], a[232:235], a[40:43], v[152:155]
ds_read_b64_tr_b16 a[212:213], v25 offset:8192
v_mfma_f32_16x16x32_bf16 v[152:155], a[236:239], a[56:59], v[152:155]
v_mfma_f32_16x16x32_bf16 v[156:159], a[232:235], a[44:47], v[156:159]
ds_read_b64_tr_b16 a[214:215], v25 offset:9216
v_mfma_f32_16x16x32_bf16 v[156:159], a[236:239], a[60:63], v[156:159]
ds_read_b128 a[0:3], v61 offset:0
ds_read_b128 a[4:7], v61 offset:2048
s_waitcnt lgkmcnt(14)
v_mfma_f32_16x16x32_bf16 v[160:163], a[240:243], a[32:35], v[160:163]
s_mov_b32 s23, 0x20000
ds_read_b64_tr_b16 a[216:217], v25 offset:8
v_mfma_f32_16x16x32_bf16 v[160:163], a[244:247], a[48:51], v[160:163]
buffer_load_dwordx4 v16, s[12:15], s42 offen offset:2048 lds
v_mfma_f32_16x16x32_bf16 v[164:167], a[240:243], a[36:39], v[164:167]
ds_read_b128 a[8:11], v61 offset:4096
ds_read_b64_tr_b16 a[218:219], v25 offset:1032
v_mfma_f32_16x16x32_bf16 v[164:167], a[244:247], a[52:55], v[164:167]
ds_read_b128 a[12:15], v61 offset:6144
v_mfma_f32_16x16x32_bf16 v[168:171], a[240:243], a[40:43], v[168:171]
ds_read_b64_tr_b16 a[220:221], v25 offset:8200
ds_read_b128 a[16:19], v62 offset:0
v_mfma_f32_16x16x32_bf16 v[168:171], a[244:247], a[56:59], v[168:171]
v_mfma_f32_16x16x32_bf16 v[172:175], a[240:243], a[44:47], v[172:175]
ds_read_b64_tr_b16 a[222:223], v25 offset:9224
ds_read_b128 a[20:23], v62 offset:2048
v_mfma_f32_16x16x32_bf16 v[172:175], a[244:247], a[60:63], v[172:175]
ds_read_b128 a[24:27], v62 offset:4096
v_mfma_f32_16x16x32_bf16 v[176:179], a[248:251], a[32:35], v[176:179]
ds_read_b64_tr_b16 a[224:225], v26 offset:0
v_mfma_f32_16x16x32_bf16 v[176:179], a[252:255], a[48:51], v[176:179]
buffer_load_dwordx4 v17, s[12:15], s42 offen offset:3072 lds
v_mfma_f32_16x16x32_bf16 v[180:183], a[248:251], a[36:39], v[180:183]
ds_read_b128 a[28:31], v62 offset:6144
ds_read_b64_tr_b16 a[226:227], v26 offset:1024
v_mfma_f32_16x16x32_bf16 v[180:183], a[252:255], a[52:55], v[180:183]
s_waitcnt vmcnt(11)
v_cmp_ne_u32 vcc, s82, v55
s_nop 3
s_cbranch_vccnz L_spin_x
L_ok_x:
v_mfma_f32_16x16x32_bf16 v[184:187], a[248:251], a[40:43], v[184:187]
ds_read_b64_tr_b16 a[228:229], v26 offset:8192
v_mfma_f32_16x16x32_bf16 v[184:187], a[252:255], a[56:59], v[184:187]
v_mfma_f32_16x16x32_bf16 v[188:191], a[248:251], a[44:47], v[188:191]
ds_read_b64_tr_b16 a[230:231], v26 offset:9216
v_mfma_f32_16x16x32_bf16 v[188:191], a[252:255], a[60:63], v[188:191]
s_waitcnt lgkmcnt(3)
v_mfma_f32_16x16x32_bf16 v[64:67], a[192:195], a[0:3], v[64:67]
ds_read_b64_tr_b16 a[128:129], v204 offset:0
ds_read_b64_tr_b16 a[232:233], v26 offset:8
v_mfma_f32_16x16x32_bf16 v[64:67], a[196:199], a[16:19], v[64:67]
buffer_load_dwordx2 v[196:197], v45, s[20:23], 0 offen offset:0 sc1
v_mfma_f32_16x16x32_bf16 v[68:71], a[192:195], a[4:7], v[68:71]
ds_read_b64_tr_b16 a[130:131], v204 offset:1024
ds_read_b64_tr_b16 a[234:235], v26 offset:1032
v_mfma_f32_16x16x32_bf16 v[68:71], a[196:199], a[20:23], v[68:71]
buffer_load_dwordx2 v[198:199], v45, s[20:23], 0 offen offset:256 sc1
v_mfma_f32_16x16x32_bf16 v[72:75], a[192:195], a[8:11], v[72:75]
ds_read_b64_tr_b16 a[132:133], v204 offset:8192
v_mfma_f32_16x16x32_bf16 v[72:75], a[196:199], a[24:27], v[72:75]
buffer_load_dwordx2 v[200:201], v45, s[20:23], 0 offen offset:512 sc1
v_mfma_f32_16x16x32_bf16 v[76:79], a[192:195], a[12:15], v[76:79]
s_add_u32 s95, s47, 138240
v_mov_b32 v43, s95
v_mfma_f32_16x16x32_bf16 v[76:79], a[196:199], a[28:31], v[76:79]
v_mov_b32 v56, 0
v_mov_b32 v57, 0
v_mfma_f32_16x16x32_bf16 v[80:83], a[200:203], a[0:3], v[80:83]
v_mov_b32 v58, 0
v_mov_b32 v59, 0
v_mfma_f32_16x16x32_bf16 v[80:83], a[204:207], a[16:19], v[80:83]
ds_read_b64_tr_b16 a[236:237], v26 offset:8200
buffer_load_dwordx2 v[202:203], v45, s[20:23], 0 offen offset:768 sc1
v_mfma_f32_16x16x32_bf16 v[84:87], a[200:203], a[4:7], v[84:87]
ds_read_b64_tr_b16 a[134:135], v204 offset:9216
s_lshl_b32 s92, s89, 2
v_mfma_f32_16x16x32_bf16 v[84:87], a[204:207], a[20:23], v[84:87]
ds_read_b64_tr_b16 a[136:137], v204 offset:8
ds_read_b64_tr_b16 a[238:239], v26 offset:9224
v_mfma_f32_16x16x32_bf16 v[88:91], a[200:203], a[8:11], v[88:91]
ds_read_b64_tr_b16 a[138:139], v204 offset:1032
s_add_u32 s92, s92, s40
v_mfma_f32_16x16x32_bf16 v[88:91], a[204:207], a[24:27], v[88:91]
ds_read_b64_tr_b16 a[240:241], v27 offset:0
ds_read_b64_tr_b16 a[140:141], v204 offset:8200
v_mfma_f32_16x16x32_bf16 v[92:95], a[200:203], a[12:15], v[92:95]
s_mov_b32 s42, 16384
s_mov_b32 m0, s51
s_lshl_b32 s92, s92, 19
ds_write_b128 v43, v[56:59]
v_mfma_f32_16x16x32_bf16 v[92:95], a[204:207], a[28:31], v[92:95]
ds_read_b64_tr_b16 a[142:143], v204 offset:9224
ds_read_b64_tr_b16 a[242:243], v27 offset:1024
v_mfma_f32_16x16x32_bf16 v[96:99], a[208:211], a[0:3], v[96:99]
s_lshl_b32 s93, s88, 14
ds_read_b64_tr_b16 a[244:245], v27 offset:8192
v_mfma_f32_16x16x32_bf16 v[96:99], a[212:215], a[16:19], v[96:99]
s_add_u32 s92, s92, s93
ds_read_b64_tr_b16 a[246:247], v27 offset:9216
v_mfma_f32_16x16x32_bf16 v[100:103], a[208:211], a[4:7], v[100:103]
buffer_load_dwordx4 v14, s[12:15], s42 offen offset:0 lds
v_mfma_f32_16x16x32_bf16 v[100:103], a[212:215], a[20:23], v[100:103]
s_waitcnt lgkmcnt(3)
v_smfmac_f32_16x16x64_bf16 v[46:49], v[192:195], a[128:135], v205
v_smfmac_f32_16x16x64_bf16 v[50:53], v[192:195], a[136:143], v205
s_add_u32 s92, s92, 8388608
ds_read_b64_tr_b16 a[248:249], v27 offset:8
v_mfma_f32_16x16x32_bf16 v[104:107], a[208:211], a[8:11], v[104:107]
s_add_u32 s20, s84, s92
s_addc_u32 s21, s85, 0
ds_read_b128 a[64:67], v43
v_mfma_f32_16x16x32_bf16 v[104:107], a[212:215], a[24:27], v[104:107]
ds_read_b64_tr_b16 a[250:251], v27 offset:1032
ds_read_b64_tr_b16 a[252:253], v27 offset:8200
v_mfma_f32_16x16x32_bf16 v[108:111], a[208:211], a[12:15], v[108:111]
buffer_load_dwordx4 v15, s[12:15], s42 offen offset:1024 lds
v_mfma_f32_16x16x32_bf16 v[108:111], a[212:215], a[28:31], v[108:111]
s_mov_b32 s22, 16384
ds_read_b128 a[68:71], v43
v_mfma_f32_16x16x32_bf16 v[112:115], a[216:219], a[0:3], v[112:115]
ds_read_b64_tr_b16 a[254:255], v27 offset:9224
s_mov_b32 s23, 0x20000
v_mfma_f32_16x16x32_bf16 v[112:115], a[220:223], a[16:19], v[112:115]
ds_read_b128 a[72:75], v43
s_lshl_b32 s92, s2, 2
v_mfma_f32_16x16x32_bf16 v[116:119], a[216:219], a[4:7], v[116:119]
s_waitcnt vmcnt(10)
s_barrier
v_mfma_f32_16x16x32_bf16 v[116:119], a[220:223], a[20:23], v[116:119]
buffer_load_dwordx4 v16, s[12:15], s42 offen offset:2048 lds
v_mfma_f32_16x16x32_bf16 v[120:123], a[216:219], a[8:11], v[120:123]
ds_read_b64_tr_b16 a[192:193], v24 offset:16384
s_add_u32 s92, s92, s40
v_mfma_f32_16x16x32_bf16 v[120:123], a[220:223], a[24:27], v[120:123]
ds_read_b128 a[76:79], v43
ds_read_b64_tr_b16 a[194:195], v24 offset:17408
v_mfma_f32_16x16x32_bf16 v[124:127], a[216:219], a[12:15], v[124:127]
s_mul_i32 s92, s92, 6912
ds_read_b64_tr_b16 a[196:197], v24 offset:24576
v_mfma_f32_16x16x32_bf16 v[124:127], a[220:223], a[28:31], v[124:127]
ds_read_b128 a[80:83], v43
s_add_u32 s8, s76, s92
s_addc_u32 s9, s77, 0
v_mfma_f32_16x16x32_bf16 v[128:131], a[224:227], a[0:3], v[128:131]
ds_read_b64_tr_b16 a[198:199], v24 offset:25600
v_mfma_f32_16x16x32_bf16 v[128:131], a[228:231], a[16:19], v[128:131]
buffer_load_dwordx4 v17, s[12:15], s42 offen offset:3072 lds
v_mfma_f32_16x16x32_bf16 v[132:135], a[224:227], a[4:7], v[132:135]
s_mov_b32 s10, 6912
ds_read_b128 a[84:87], v43
v_mfma_f32_16x16x32_bf16 v[132:135], a[228:231], a[20:23], v[132:135]
ds_read_b64_tr_b16 a[200:201], v24 offset:16392
ds_read_b64_tr_b16 a[202:203], v24 offset:17416
v_mfma_f32_16x16x32_bf16 v[136:139], a[224:227], a[8:11], v[136:139]
s_mov_b32 s11, 0x20000
ds_read_b128 a[88:91], v43
v_mfma_f32_16x16x32_bf16 v[136:139], a[228:231], a[24:27], v[136:139]
ds_read_b64_tr_b16 a[204:205], v24 offset:24584
s_mov_b32 s43, 32768
v_mfma_f32_16x16x32_bf16 v[140:143], a[224:227], a[12:15], v[140:143]
s_mov_b32 m0, s54
s_add_u32 s4, s72, s92
s_addc_u32 s5, s73, 0
v_mfma_f32_16x16x32_bf16 v[140:143], a[228:231], a[28:31], v[140:143]
ds_read_b128 a[92:95], v43
ds_read_b64_tr_b16 a[206:207], v24 offset:25608
v_mfma_f32_16x16x32_bf16 v[144:147], a[232:235], a[0:3], v[144:147]
s_mov_b32 s6, 6912
ds_read_b64_tr_b16 a[208:209], v25 offset:16384
v_mfma_f32_16x16x32_bf16 v[144:147], a[236:239], a[16:19], v[144:147]
s_mov_b32 s7, 0x20000
ds_read_b128 a[96:99], v43
v_mfma_f32_16x16x32_bf16 v[148:151], a[232:235], a[4:7], v[148:151]
buffer_load_dwordx4 v18, s[16:19], s43 offen offset:0 lds
v_mfma_f32_16x16x32_bf16 v[148:151], a[236:239], a[20:23], v[148:151]
ds_read_b64_tr_b16 a[210:211], v25 offset:17408
s_lshl_b32 s92, s90, 7
v_mfma_f32_16x16x32_bf16 v[152:155], a[232:235], a[8:11], v[152:155]
ds_read_b128 a[100:103], v43
ds_read_b64_tr_b16 a[212:213], v25 offset:24576
v_mfma_f32_16x16x32_bf16 v[152:155], a[236:239], a[24:27], v[152:155]
s_add_u32 s36, s74, s92
s_addc_u32 s37, s75, 0
v_mfma_f32_16x16x32_bf16 v[156:159], a[232:235], a[12:15], v[156:159]
ds_read_b64_tr_b16 a[214:215], v25 offset:25600
v_mfma_f32_16x16x32_bf16 v[156:159], a[236:239], a[28:31], v[156:159]
ds_read_b128 a[32:35], v41 offset:0
s_mov_b32 s38, 128
s_waitcnt lgkmcnt(15)
v_mfma_f32_16x16x32_bf16 v[160:163], a[240:243], a[0:3], v[160:163]
ds_read_b128 a[104:107], v43
ds_read_b128 a[36:39], v41 offset:2048
v_mfma_f32_16x16x32_bf16 v[160:163], a[244:247], a[16:19], v[160:163]
buffer_load_dwordx4 v19, s[16:19], s43 offen offset:1024 lds
v_mfma_f32_16x16x32_bf16 v[164:167], a[240:243], a[4:7], v[164:167]
ds_read_b64_tr_b16 a[216:217], v25 offset:16392
ds_read_b128 a[40:43], v41 offset:4096
v_mfma_f32_16x16x32_bf16 v[164:167], a[244:247], a[20:23], v[164:167]
s_mov_b32 s39, 0x20000
ds_read_b128 a[108:111], v43
v_mfma_f32_16x16x32_bf16 v[168:171], a[240:243], a[8:11], v[168:171]
ds_read_b64_tr_b16 a[218:219], v25 offset:17416
ds_read_b128 a[44:47], v41 offset:6144
v_mfma_f32_16x16x32_bf16 v[168:171], a[244:247], a[24:27], v[168:171]
s_mul_i32 s92, s91, 327680
ds_read_b64_tr_b16 a[220:221], v25 offset:24584
v_mfma_f32_16x16x32_bf16 v[172:175], a[240:243], a[12:15], v[172:175]
ds_read_b128 a[48:51], v42 offset:0
v_mfma_f32_16x16x32_bf16 v[172:175], a[244:247], a[28:31], v[172:175]
buffer_load_dwordx4 v18, s[16:19], s43 offen offset:2048 lds
v_mfma_f32_16x16x32_bf16 v[176:179], a[248:251], a[0:3], v[176:179]
ds_read_b128 a[112:115], v43
s_add_u32 s92, s92, 4194304
v_mfma_f32_16x16x32_bf16 v[176:179], a[252:255], a[16:19], v[176:179]
ds_read_b64_tr_b16 a[222:223], v25 offset:25608
ds_read_b128 a[52:55], v42 offset:2048
v_mfma_f32_16x16x32_bf16 v[180:183], a[248:251], a[4:7], v[180:183]
ds_read_b128 a[56:59], v42 offset:4096
s_add_u32 s28, s84, s92
s_addc_u32 s29, s85, 0
v_mfma_f32_16x16x32_bf16 v[180:183], a[252:255], a[20:23], v[180:183]
ds_read_b128 a[116:119], v43
ds_read_b64_tr_b16 a[224:225], v26 offset:16384
v_mfma_f32_16x16x32_bf16 v[184:187], a[248:251], a[8:11], v[184:187]
ds_read_b128 a[60:63], v42 offset:6144
s_mov_b32 s30, 327680
v_mfma_f32_16x16x32_bf16 v[184:187], a[252:255], a[24:27], v[184:187]
ds_read_b64_tr_b16 a[226:227], v26 offset:17408
v_mfma_f32_16x16x32_bf16 v[188:191], a[248:251], a[12:15], v[188:191]
buffer_load_dwordx4 v19, s[16:19], s43 offen offset:3072 lds
v_mfma_f32_16x16x32_bf16 v[188:191], a[252:255], a[28:31], v[188:191]
ds_read_b128 a[120:123], v43
s_mov_b32 s31, 0x20000
ds_read_b64_tr_b16 a[228:229], v26 offset:24576
s_cmp_eq_u32 s3, 1
s_cselect_b32 s30, 0, 327680
ds_read_b128 a[124:127], v43
ds_read_b64_tr_b16 a[230:231], v26 offset:25600
s_waitcnt lgkmcnt(5)
v_mfma_f32_16x16x32_bf16 v[64:67], a[192:195], a[32:35], v[64:67]
ds_read_b64_tr_b16 a[128:129], v204 offset:16384
ds_read_b64_tr_b16 a[232:233], v26 offset:16392
v_mfma_f32_16x16x32_bf16 v[64:67], a[196:199], a[48:51], v[64:67]
ds_read_b128 a[0:3], v43
ds_read_b64_tr_b16 a[130:131], v204 offset:17408
v_mfma_f32_16x16x32_bf16 v[68:71], a[192:195], a[36:39], v[68:71]
ds_read_b64_tr_b16 a[234:235], v26 offset:17416
ds_read_b128 a[4:7], v43
v_mfma_f32_16x16x32_bf16 v[68:71], a[196:199], a[52:55], v[68:71]
ds_read_b64_tr_b16 a[132:133], v204 offset:24576
s_mov_b32 s43, 49152
v_mfma_f32_16x16x32_bf16 v[72:75], a[192:195], a[40:43], v[72:75]
s_mov_b32 m0, s55
ds_read_b64_tr_b16 a[236:237], v26 offset:24584
v_mfma_f32_16x16x32_bf16 v[72:75], a[196:199], a[56:59], v[72:75]
ds_read_b128 a[8:11], v43
ds_read_b64_tr_b16 a[134:135], v204 offset:25600
v_mfma_f32_16x16x32_bf16 v[76:79], a[192:195], a[44:47], v[76:79]
ds_read_b128 a[12:15], v43
ds_read_b64_tr_b16 a[136:137], v204 offset:16392
v_mfma_f32_16x16x32_bf16 v[76:79], a[196:199], a[60:63], v[76:79]
ds_read_b64_tr_b16 a[238:239], v26 offset:25608
ds_read_b64_tr_b16 a[138:139], v204 offset:17416
v_mfma_f32_16x16x32_bf16 v[80:83], a[200:203], a[32:35], v[80:83]
ds_read_b128 a[16:19], v43
ds_read_b64_tr_b16 a[240:241], v27 offset:16384
v_mfma_f32_16x16x32_bf16 v[80:83], a[204:207], a[48:51], v[80:83]
ds_read_b64_tr_b16 a[140:141], v204 offset:24584
v_mfma_f32_16x16x32_bf16 v[84:87], a[200:203], a[36:39], v[84:87]
buffer_load_dwordx4 v18, s[16:19], s43 offen offset:0 lds
v_mfma_f32_16x16x32_bf16 v[84:87], a[204:207], a[52:55], v[84:87]
ds_read_b128 a[20:23], v43
ds_read_b64_tr_b16 a[142:143], v204 offset:25608
v_mfma_f32_16x16x32_bf16 v[88:91], a[200:203], a[40:43], v[88:91]
ds_read_b64_tr_b16 a[242:243], v27 offset:17408
ds_read_b128 a[24:27], v43
v_mfma_f32_16x16x32_bf16 v[88:91], a[204:207], a[56:59], v[88:91]
ds_read_b64_tr_b16 a[244:245], v27 offset:24576
ds_read_b128 a[28:31], v43
v_mfma_f32_16x16x32_bf16 v[92:95], a[200:203], a[44:47], v[92:95]
s_lshl_b32 s92, s40, 13
s_add_u32 s92, s92, 136192
v_mfma_f32_16x16x32_bf16 v[92:95], a[204:207], a[60:63], v[92:95]
v_lshrrev_b32 v54, 2, v1
v_add_u32 v54, s92, v54
v_mfma_f32_16x16x32_bf16 v[96:99], a[208:211], a[32:35], v[96:99]
v_lshrrev_b32 v55, 8, v1
v_lshlrev_b32 v55, 4, v55
v_mfma_f32_16x16x32_bf16 v[96:99], a[212:215], a[48:51], v[96:99]
v_add_u32 v55, 136192, v55
v_mov_b32 v62, v205
v_mfma_f32_16x16x32_bf16 v[100:103], a[208:211], a[36:39], v[100:103]
ds_read_b64_tr_b16 a[246:247], v27 offset:25600
v_mfma_f32_16x16x32_bf16 v[100:103], a[212:215], a[52:55], v[100:103]
s_waitcnt lgkmcnt(5)
v_smfmac_f32_16x16x64_bf16 v[46:49], v[192:195], a[128:135], v205
v_smfmac_f32_16x16x64_bf16 v[50:53], v[192:195], a[136:143], v205
buffer_load_dwordx4 v19, s[16:19], s43 offen offset:1024 lds
v_mfma_f32_16x16x32_bf16 v[104:107], a[208:211], a[40:43], v[104:107]
ds_read_b64_tr_b16 a[248:249], v27 offset:16392
ds_read_b64_tr_b16 a[250:251], v27 offset:17416
v_mfma_f32_16x16x32_bf16 v[104:107], a[212:215], a[56:59], v[104:107]
ds_read_b64_tr_b16 a[252:253], v27 offset:24584
v_mfma_f32_16x16x32_bf16 v[108:111], a[208:211], a[44:47], v[108:111]
buffer_load_dwordx4 v18, s[16:19], s43 offen offset:2048 lds
v_mfma_f32_16x16x32_bf16 v[108:111], a[212:215], a[60:63], v[108:111]
ds_read_b64_tr_b16 a[254:255], v27 offset:25608
v_mfma_f32_16x16x32_bf16 v[112:115], a[216:219], a[32:35], v[112:115]
v_mfma_f32_16x16x32_bf16 v[112:115], a[220:223], a[48:51], v[112:115]
v_add_f32 v46, v46, v47
v_add_f32 v50, v50, v51
v_mfma_f32_16x16x32_bf16 v[116:119], a[216:219], a[36:39], v[116:119]
buffer_load_dwordx4 v19, s[16:19], s43 offen offset:3072 lds
v_mfma_f32_16x16x32_bf16 v[116:119], a[220:223], a[52:55], v[116:119]
ds_write_b32 v54, v46 offset:0
ds_write_b32 v54, v50 offset:1024
v_mfma_f32_16x16x32_bf16 v[120:123], a[216:219], a[40:43], v[120:123]
v_mfma_f32_16x16x32_bf16 v[120:123], a[220:223], a[56:59], v[120:123]
v_mfma_f32_16x16x32_bf16 v[124:127], a[216:219], a[44:47], v[124:127]
v_mfma_f32_16x16x32_bf16 v[124:127], a[220:223], a[60:63], v[124:127]
v_mfma_f32_16x16x32_bf16 v[128:131], a[224:227], a[32:35], v[128:131]
v_mfma_f32_16x16x32_bf16 v[128:131], a[228:231], a[48:51], v[128:131]
v_mfma_f32_16x16x32_bf16 v[132:135], a[224:227], a[36:39], v[132:135]
s_waitcnt lgkmcnt(0)
s_barrier
v_mfma_f32_16x16x32_bf16 v[132:135], a[228:231], a[52:55], v[132:135]
ds_read_b128 v[24:27], v55 offset:0
v_mfma_f32_16x16x32_bf16 v[136:139], a[224:227], a[40:43], v[136:139]
ds_read_b128 v[28:31], v55 offset:1024
v_mfma_f32_16x16x32_bf16 v[136:139], a[228:231], a[56:59], v[136:139]
ds_read_b128 v[32:35], v55 offset:8192
v_mfma_f32_16x16x32_bf16 v[140:143], a[224:227], a[44:47], v[140:143]
ds_read_b128 v[44:47], v55 offset:9216
s_mov_b32 s42, 32768
v_mfma_f32_16x16x32_bf16 v[140:143], a[228:231], a[60:63], v[140:143]
s_mov_b32 m0, s48
v_mfma_f32_16x16x32_bf16 v[144:147], a[232:235], a[32:35], v[144:147]
ds_read_b128 v[48:51], v55 offset:16384
v_mfma_f32_16x16x32_bf16 v[144:147], a[236:239], a[48:51], v[144:147]
ds_read_b128 v[56:59], v55 offset:24576
v_mfma_f32_16x16x32_bf16 v[148:151], a[232:235], a[36:39], v[148:151]
ds_read_b128 v[204:207], v55 offset:25600
v_mfma_f32_16x16x32_bf16 v[148:151], a[236:239], a[52:55], v[148:151]
ds_read_b128 v[52:55], v55 offset:17408
v_mfma_f32_16x16x32_bf16 v[152:155], a[232:235], a[40:43], v[152:155]
buffer_load_dwordx4 v14, s[12:15], s42 offen offset:0 lds
v_mfma_f32_16x16x32_bf16 v[152:155], a[236:239], a[56:59], v[152:155]
v_mfma_f32_16x16x32_bf16 v[156:159], a[232:235], a[44:47], v[156:159]
v_mfma_f32_16x16x32_bf16 v[156:159], a[236:239], a[60:63], v[156:159]
v_mfma_f32_16x16x32_bf16 v[160:163], a[240:243], a[32:35], v[160:163]
buffer_load_dwordx4 v15, s[12:15], s42 offen offset:1024 lds
v_mfma_f32_16x16x32_bf16 v[160:163], a[244:247], a[48:51], v[160:163]
v_mfma_f32_16x16x32_bf16 v[164:167], a[240:243], a[36:39], v[164:167]
v_mfma_f32_16x16x32_bf16 v[164:167], a[244:247], a[52:55], v[164:167]
v_mfma_f32_16x16x32_bf16 v[168:171], a[240:243], a[40:43], v[168:171]
v_mfma_f32_16x16x32_bf16 v[168:171], a[244:247], a[56:59], v[168:171]
buffer_load_dwordx4 v16, s[12:15], s42 offen offset:2048 lds
v_mfma_f32_16x16x32_bf16 v[172:175], a[240:243], a[44:47], v[172:175]
v_mfma_f32_16x16x32_bf16 v[172:175], a[244:247], a[60:63], v[172:175]
v_mfma_f32_16x16x32_bf16 v[176:179], a[248:251], a[32:35], v[176:179]
v_mfma_f32_16x16x32_bf16 v[176:179], a[252:255], a[48:51], v[176:179]
v_mfma_f32_16x16x32_bf16 v[180:183], a[248:251], a[36:39], v[180:183]
buffer_load_dwordx4 v17, s[12:15], s42 offen offset:3072 lds
v_mfma_f32_16x16x32_bf16 v[180:183], a[252:255], a[52:55], v[180:183]
v_mfma_f32_16x16x32_bf16 v[184:187], a[248:251], a[40:43], v[184:187]
v_mfma_f32_16x16x32_bf16 v[184:187], a[252:255], a[56:59], v[184:187]
v_mfma_f32_16x16x32_bf16 v[188:191], a[248:251], a[44:47], v[188:191]
v_mfma_f32_16x16x32_bf16 v[188:191], a[252:255], a[60:63], v[188:191]
ds_read_b128 a[32:35], v43
ds_read_b128 a[36:39], v43
ds_read_b128 a[40:43], v43
ds_read_b128 a[44:47], v43
ds_read_b128 a[48:51], v43
ds_read_b128 a[52:55], v43
ds_read_b128 a[56:59], v43
ds_read_b128 a[60:63], v43
s_waitcnt vmcnt(20)
s_barrier
ds_read_b128 a[128:131], v2 offset:32768
ds_read_b128 a[132:135], v3 offset:32768
ds_read_b128 a[136:139], v4 offset:32768
ds_read_b128 a[140:143], v5 offset:32768
ds_read_b128 a[144:147], v2 offset:36864
ds_read_b128 a[148:151], v3 offset:36864
ds_read_b128 a[152:155], v4 offset:36864
ds_read_b128 a[156:159], v5 offset:36864
ds_read_b128 a[160:163], v2 offset:40960
ds_read_b128 a[164:167], v3 offset:40960
ds_read_b128 a[168:171], v4 offset:40960
ds_read_b128 a[172:175], v5 offset:40960
ds_read_b128 a[176:179], v2 offset:45056
ds_read_b128 a[180:183], v3 offset:45056
ds_read_b128 a[184:187], v4 offset:45056
ds_read_b128 a[188:191], v5 offset:45056
s_waitcnt vmcnt(16) lgkmcnt(15)
v_pk_fma_f32 v[76:77], v[24:25], v[202:203], v[76:77] op_sel_hi:[1,0,1]
v_pk_fma_f32 v[78:79], v[26:27], v[202:203], v[78:79] op_sel_hi:[1,0,1]
v_pk_fma_f32 v[92:93], v[28:29], v[202:203], v[92:93] op_sel_hi:[1,0,1]
v_pk_fma_f32 v[94:95], v[30:31], v[202:203], v[94:95] op_sel_hi:[1,0,1]
v_pk_fma_f32 v[108:109], v[32:33], v[202:203], v[108:109] op_sel_hi:[1,0,1]
v_pk_fma_f32 v[110:111], v[34:35], v[202:203], v[110:111] op_sel_hi:[1,0,1]
v_pk_fma_f32 v[124:125], v[44:45], v[202:203], v[124:125] op_sel_hi:[1,0,1]
v_pk_fma_f32 v[126:127], v[46:47], v[202:203], v[126:127] op_sel_hi:[1,0,1]
v_pk_fma_f32 v[140:141], v[48:49], v[202:203], v[140:141] op_sel_hi:[1,0,1]
v_pk_fma_f32 v[142:143], v[50:51], v[202:203], v[142:143] op_sel_hi:[1,0,1]
v_pk_fma_f32 v[156:157], v[52:53], v[202:203], v[156:157] op_sel_hi:[1,0,1]
v_pk_fma_f32 v[158:159], v[54:55], v[202:203], v[158:159] op_sel_hi:[1,0,1]
v_pk_fma_f32 v[172:173], v[56:57], v[202:203], v[172:173] op_sel_hi:[1,0,1]
v_pk_fma_f32 v[174:175], v[58:59], v[202:203], v[174:175] op_sel_hi:[1,0,1]
v_pk_fma_f32 v[188:189], v[204:205], v[202:203], v[188:189] op_sel_hi:[1,0,1]
v_pk_fma_f32 v[190:191], v[206:207], v[202:203], v[190:191] op_sel_hi:[1,0,1]
v_pk_mul_f32 v[76:77], v[76:77], v[202:203] op_sel:[0,1] op_sel_hi:[1,1]
v_pk_mul_f32 v[78:79], v[78:79], v[202:203] op_sel:[0,1] op_sel_hi:[1,1]
v_pk_mul_f32 v[92:93], v[92:93], v[202:203] op_sel:[0,1] op_sel_hi:[1,1]
v_pk_mul_f32 v[94:95], v[94:95], v[202:203] op_sel:[0,1] op_sel_hi:[1,1]
v_pk_mul_f32 v[108:109], v[108:109], v[202:203] op_sel:[0,1] op_sel_hi:[1,1]
v_pk_mul_f32 v[110:111], v[110:111], v[202:203] op_sel:[0,1] op_sel_hi:[1,1]
v_pk_mul_f32 v[124:125], v[124:125], v[202:203] op_sel:[0,1] op_sel_hi:[1,1]
v_pk_mul_f32 v[126:127], v[126:127], v[202:203] op_sel:[0,1] op_sel_hi:[1,1]
v_pk_mul_f32 v[140:141], v[140:141], v[202:203] op_sel:[0,1] op_sel_hi:[1,1]
v_pk_mul_f32 v[142:143], v[142:143], v[202:203] op_sel:[0,1] op_sel_hi:[1,1]
v_pk_mul_f32 v[156:157], v[156:157], v[202:203] op_sel:[0,1] op_sel_hi:[1,1]
v_pk_mul_f32 v[158:159], v[158:159], v[202:203] op_sel:[0,1] op_sel_hi:[1,1]
v_pk_mul_f32 v[172:173], v[172:173], v[202:203] op_sel:[0,1] op_sel_hi:[1,1]
v_pk_mul_f32 v[174:175], v[174:175], v[202:203] op_sel:[0,1] op_sel_hi:[1,1]
v_pk_mul_f32 v[188:189], v[188:189], v[202:203] op_sel:[0,1] op_sel_hi:[1,1]
v_pk_mul_f32 v[190:191], v[190:191], v[202:203] op_sel:[0,1] op_sel_hi:[1,1]
v_cvt_pk_bf16_f32 v240, v76, v77
v_cvt_pk_bf16_f32 v241, v78, v79
v_cvt_pk_bf16_f32 v242, v92, v93
v_cvt_pk_bf16_f32 v243, v94, v95
v_cvt_pk_bf16_f32 v244, v108, v109
v_cvt_pk_bf16_f32 v245, v110, v111
v_cvt_pk_bf16_f32 v246, v124, v125
v_cvt_pk_bf16_f32 v247, v126, v127
v_cvt_pk_bf16_f32 v248, v140, v141
v_cvt_pk_bf16_f32 v249, v142, v143
v_cvt_pk_bf16_f32 v250, v156, v157
v_cvt_pk_bf16_f32 v251, v158, v159
v_cvt_pk_bf16_f32 v252, v172, v173
v_cvt_pk_bf16_f32 v253, v174, v175
v_cvt_pk_bf16_f32 v254, v188, v189
s_mov_b32 s42, 49152
s_mov_b32 m0, s49
v_cvt_pk_bf16_f32 v255, v190, v191
v_pk_fma_f32 v[72:73], v[24:25], v[200:201], v[72:73] op_sel_hi:[1,0,1]
v_pk_fma_f32 v[74:75], v[26:27], v[200:201], v[74:75] op_sel_hi:[1,0,1]
v_pk_fma_f32 v[88:89], v[28:29], v[200:201], v[88:89] op_sel_hi:[1,0,1]
v_pk_fma_f32 v[90:91], v[30:31], v[200:201], v[90:91] op_sel_hi:[1,0,1]
v_pk_fma_f32 v[104:105], v[32:33], v[200:201], v[104:105] op_sel_hi:[1,0,1]
v_pk_fma_f32 v[106:107], v[34:35], v[200:201], v[106:107] op_sel_hi:[1,0,1]
v_pk_fma_f32 v[120:121], v[44:45], v[200:201], v[120:121] op_sel_hi:[1,0,1]
v_pk_fma_f32 v[122:123], v[46:47], v[200:201], v[122:123] op_sel_hi:[1,0,1]
v_pk_fma_f32 v[136:137], v[48:49], v[200:201], v[136:137] op_sel_hi:[1,0,1]
v_pk_fma_f32 v[138:139], v[50:51], v[200:201], v[138:139] op_sel_hi:[1,0,1]
v_pk_fma_f32 v[152:153], v[52:53], v[200:201], v[152:153] op_sel_hi:[1,0,1]
v_pk_fma_f32 v[154:155], v[54:55], v[200:201], v[154:155] op_sel_hi:[1,0,1]
v_pk_fma_f32 v[168:169], v[56:57], v[200:201], v[168:169] op_sel_hi:[1,0,1]
v_pk_fma_f32 v[170:171], v[58:59], v[200:201], v[170:171] op_sel_hi:[1,0,1]
v_pk_fma_f32 v[184:185], v[204:205], v[200:201], v[184:185] op_sel_hi:[1,0,1]
v_pk_fma_f32 v[186:187], v[206:207], v[200:201], v[186:187] op_sel_hi:[1,0,1]
v_pk_mul_f32 v[72:73], v[72:73], v[200:201] op_sel:[0,1] op_sel_hi:[1,1]
v_pk_mul_f32 v[74:75], v[74:75], v[200:201] op_sel:[0,1] op_sel_hi:[1,1]
v_pk_mul_f32 v[88:89], v[88:89], v[200:201] op_sel:[0,1] op_sel_hi:[1,1]
v_pk_mul_f32 v[90:91], v[90:91], v[200:201] op_sel:[0,1] op_sel_hi:[1,1]
v_pk_mul_f32 v[104:105], v[104:105], v[200:201] op_sel:[0,1] op_sel_hi:[1,1]
v_pk_mul_f32 v[106:107], v[106:107], v[200:201] op_sel:[0,1] op_sel_hi:[1,1]
v_pk_mul_f32 v[120:121], v[120:121], v[200:201] op_sel:[0,1] op_sel_hi:[1,1]
buffer_load_dwordx4 v14, s[12:15], s42 offen offset:0 lds
v_pk_mul_f32 v[122:123], v[122:123], v[200:201] op_sel:[0,1] op_sel_hi:[1,1]
v_pk_mul_f32 v[136:137], v[136:137], v[200:201] op_sel:[0,1] op_sel_hi:[1,1]
v_pk_mul_f32 v[138:139], v[138:139], v[200:201] op_sel:[0,1] op_sel_hi:[1,1]
v_pk_mul_f32 v[152:153], v[152:153], v[200:201] op_sel:[0,1] op_sel_hi:[1,1]
v_pk_mul_f32 v[154:155], v[154:155], v[200:201] op_sel:[0,1] op_sel_hi:[1,1]
v_pk_mul_f32 v[168:169], v[168:169], v[200:201] op_sel:[0,1] op_sel_hi:[1,1]
v_pk_mul_f32 v[170:171], v[170:171], v[200:201] op_sel:[0,1] op_sel_hi:[1,1]
v_pk_mul_f32 v[184:185], v[184:185], v[200:201] op_sel:[0,1] op_sel_hi:[1,1]
v_pk_mul_f32 v[186:187], v[186:187], v[200:201] op_sel:[0,1] op_sel_hi:[1,1]
v_cvt_pk_bf16_f32 v224, v72, v73
v_cvt_pk_bf16_f32 v225, v74, v75
v_cvt_pk_bf16_f32 v226, v88, v89
v_cvt_pk_bf16_f32 v227, v90, v91
v_cvt_pk_bf16_f32 v228, v104, v105
v_cvt_pk_bf16_f32 v229, v106, v107
v_cvt_pk_bf16_f32 v230, v120, v121
v_cvt_pk_bf16_f32 v231, v122, v123
v_cvt_pk_bf16_f32 v232, v136, v137
v_cvt_pk_bf16_f32 v233, v138, v139
v_cvt_pk_bf16_f32 v234, v152, v153
v_cvt_pk_bf16_f32 v235, v154, v155
v_cvt_pk_bf16_f32 v236, v168, v169
v_cvt_pk_bf16_f32 v237, v170, v171
v_cvt_pk_bf16_f32 v238, v184, v185
buffer_load_dwordx4 v15, s[12:15], s42 offen offset:1024 lds
v_cvt_pk_bf16_f32 v239, v186, v187
v_pk_fma_f32 v[68:69], v[24:25], v[198:199], v[68:69] op_sel_hi:[1,0,1]
v_pk_fma_f32 v[70:71], v[26:27], v[198:199], v[70:71] op_sel_hi:[1,0,1]
v_pk_fma_f32 v[84:85], v[28:29], v[198:199], v[84:85] op_sel_hi:[1,0,1]
v_pk_fma_f32 v[86:87], v[30:31], v[198:199], v[86:87] op_sel_hi:[1,0,1]
v_pk_fma_f32 v[100:101], v[32:33], v[198:199], v[100:101] op_sel_hi:[1,0,1]
v_pk_fma_f32 v[102:103], v[34:35], v[198:199], v[102:103] op_sel_hi:[1,0,1]
v_pk_fma_f32 v[116:117], v[44:45], v[198:199], v[116:117] op_sel_hi:[1,0,1]
v_pk_fma_f32 v[118:119], v[46:47], v[198:199], v[118:119] op_sel_hi:[1,0,1]
v_pk_fma_f32 v[132:133], v[48:49], v[198:199], v[132:133] op_sel_hi:[1,0,1]
v_pk_fma_f32 v[134:135], v[50:51], v[198:199], v[134:135] op_sel_hi:[1,0,1]
v_pk_fma_f32 v[148:149], v[52:53], v[198:199], v[148:149] op_sel_hi:[1,0,1]
v_pk_fma_f32 v[150:151], v[54:55], v[198:199], v[150:151] op_sel_hi:[1,0,1]
v_pk_fma_f32 v[164:165], v[56:57], v[198:199], v[164:165] op_sel_hi:[1,0,1]
v_pk_fma_f32 v[166:167], v[58:59], v[198:199], v[166:167] op_sel_hi:[1,0,1]
v_pk_fma_f32 v[180:181], v[204:205], v[198:199], v[180:181] op_sel_hi:[1,0,1]
v_pk_fma_f32 v[182:183], v[206:207], v[198:199], v[182:183] op_sel_hi:[1,0,1]
v_pk_mul_f32 v[68:69], v[68:69], v[198:199] op_sel:[0,1] op_sel_hi:[1,1]
v_pk_mul_f32 v[70:71], v[70:71], v[198:199] op_sel:[0,1] op_sel_hi:[1,1]
v_pk_mul_f32 v[84:85], v[84:85], v[198:199] op_sel:[0,1] op_sel_hi:[1,1]
v_pk_mul_f32 v[86:87], v[86:87], v[198:199] op_sel:[0,1] op_sel_hi:[1,1]
v_pk_mul_f32 v[100:101], v[100:101], v[198:199] op_sel:[0,1] op_sel_hi:[1,1]
v_pk_mul_f32 v[102:103], v[102:103], v[198:199] op_sel:[0,1] op_sel_hi:[1,1]
v_pk_mul_f32 v[116:117], v[116:117], v[198:199] op_sel:[0,1] op_sel_hi:[1,1]
buffer_load_dwordx4 v16, s[12:15], s42 offen offset:2048 lds
v_pk_mul_f32 v[118:119], v[118:119], v[198:199] op_sel:[0,1] op_sel_hi:[1,1]
v_pk_mul_f32 v[132:133], v[132:133], v[198:199] op_sel:[0,1] op_sel_hi:[1,1]
v_pk_mul_f32 v[134:135], v[134:135], v[198:199] op_sel:[0,1] op_sel_hi:[1,1]
v_pk_mul_f32 v[148:149], v[148:149], v[198:199] op_sel:[0,1] op_sel_hi:[1,1]
v_pk_mul_f32 v[150:151], v[150:151], v[198:199] op_sel:[0,1] op_sel_hi:[1,1]
v_pk_mul_f32 v[164:165], v[164:165], v[198:199] op_sel:[0,1] op_sel_hi:[1,1]
v_pk_mul_f32 v[166:167], v[166:167], v[198:199] op_sel:[0,1] op_sel_hi:[1,1]
v_pk_mul_f32 v[180:181], v[180:181], v[198:199] op_sel:[0,1] op_sel_hi:[1,1]
v_pk_mul_f32 v[182:183], v[182:183], v[198:199] op_sel:[0,1] op_sel_hi:[1,1]
v_cvt_pk_bf16_f32 v208, v68, v69
v_cvt_pk_bf16_f32 v209, v70, v71
v_cvt_pk_bf16_f32 v210, v84, v85
v_cvt_pk_bf16_f32 v211, v86, v87
v_cvt_pk_bf16_f32 v212, v100, v101
v_cvt_pk_bf16_f32 v213, v102, v103
v_cvt_pk_bf16_f32 v214, v116, v117
v_cvt_pk_bf16_f32 v215, v118, v119
v_cvt_pk_bf16_f32 v216, v132, v133
v_cvt_pk_bf16_f32 v217, v134, v135
v_cvt_pk_bf16_f32 v218, v148, v149
v_cvt_pk_bf16_f32 v219, v150, v151
v_cvt_pk_bf16_f32 v220, v164, v165
v_cvt_pk_bf16_f32 v221, v166, v167
v_cvt_pk_bf16_f32 v222, v180, v181
buffer_load_dwordx4 v17, s[12:15], s42 offen offset:3072 lds
v_cvt_pk_bf16_f32 v223, v182, v183
v_pk_fma_f32 v[64:65], v[24:25], v[196:197], v[64:65] op_sel_hi:[1,0,1]
v_pk_fma_f32 v[66:67], v[26:27], v[196:197], v[66:67] op_sel_hi:[1,0,1]
v_pk_fma_f32 v[80:81], v[28:29], v[196:197], v[80:81] op_sel_hi:[1,0,1]
v_pk_fma_f32 v[82:83], v[30:31], v[196:197], v[82:83] op_sel_hi:[1,0,1]
v_pk_fma_f32 v[96:97], v[32:33], v[196:197], v[96:97] op_sel_hi:[1,0,1]
v_pk_fma_f32 v[98:99], v[34:35], v[196:197], v[98:99] op_sel_hi:[1,0,1]
v_pk_fma_f32 v[112:113], v[44:45], v[196:197], v[112:113] op_sel_hi:[1,0,1]
v_pk_fma_f32 v[114:115], v[46:47], v[196:197], v[114:115] op_sel_hi:[1,0,1]
v_pk_fma_f32 v[128:129], v[48:49], v[196:197], v[128:129] op_sel_hi:[1,0,1]
v_pk_fma_f32 v[130:131], v[50:51], v[196:197], v[130:131] op_sel_hi:[1,0,1]
v_pk_fma_f32 v[144:145], v[52:53], v[196:197], v[144:145] op_sel_hi:[1,0,1]
v_pk_fma_f32 v[146:147], v[54:55], v[196:197], v[146:147] op_sel_hi:[1,0,1]
v_pk_fma_f32 v[160:161], v[56:57], v[196:197], v[160:161] op_sel_hi:[1,0,1]
v_pk_fma_f32 v[162:163], v[58:59], v[196:197], v[162:163] op_sel_hi:[1,0,1]
v_pk_fma_f32 v[176:177], v[204:205], v[196:197], v[176:177] op_sel_hi:[1,0,1]
v_pk_fma_f32 v[178:179], v[206:207], v[196:197], v[178:179] op_sel_hi:[1,0,1]
v_pk_mul_f32 v[64:65], v[64:65], v[196:197] op_sel:[0,1] op_sel_hi:[1,1]
v_pk_mul_f32 v[66:67], v[66:67], v[196:197] op_sel:[0,1] op_sel_hi:[1,1]
v_pk_mul_f32 v[80:81], v[80:81], v[196:197] op_sel:[0,1] op_sel_hi:[1,1]
v_pk_mul_f32 v[82:83], v[82:83], v[196:197] op_sel:[0,1] op_sel_hi:[1,1]
v_pk_mul_f32 v[96:97], v[96:97], v[196:197] op_sel:[0,1] op_sel_hi:[1,1]
v_pk_mul_f32 v[98:99], v[98:99], v[196:197] op_sel:[0,1] op_sel_hi:[1,1]
v_pk_mul_f32 v[112:113], v[112:113], v[196:197] op_sel:[0,1] op_sel_hi:[1,1]
v_pk_mul_f32 v[114:115], v[114:115], v[196:197] op_sel:[0,1] op_sel_hi:[1,1]
v_pk_mul_f32 v[128:129], v[128:129], v[196:197] op_sel:[0,1] op_sel_hi:[1,1]
v_pk_mul_f32 v[130:131], v[130:131], v[196:197] op_sel:[0,1] op_sel_hi:[1,1]
v_pk_mul_f32 v[144:145], v[144:145], v[196:197] op_sel:[0,1] op_sel_hi:[1,1]
v_pk_mul_f32 v[146:147], v[146:147], v[196:197] op_sel:[0,1] op_sel_hi:[1,1]
v_pk_mul_f32 v[160:161], v[160:161], v[196:197] op_sel:[0,1] op_sel_hi:[1,1]
v_pk_mul_f32 v[162:163], v[162:163], v[196:197] op_sel:[0,1] op_sel_hi:[1,1]
v_pk_mul_f32 v[176:177], v[176:177], v[196:197] op_sel:[0,1] op_sel_hi:[1,1]
v_pk_mul_f32 v[178:179], v[178:179], v[196:197] op_sel:[0,1] op_sel_hi:[1,1]
v_cvt_pk_bf16_f32 v192, v64, v65
v_cvt_pk_bf16_f32 v193, v66, v67
v_cvt_pk_bf16_f32 v194, v80, v81
v_cvt_pk_bf16_f32 v195, v82, v83
v_cvt_pk_bf16_f32 v196, v96, v97
v_cvt_pk_bf16_f32 v197, v98, v99
v_cvt_pk_bf16_f32 v198, v112, v113
v_cvt_pk_bf16_f32 v199, v114, v115
v_cvt_pk_bf16_f32 v200, v128, v129
v_cvt_pk_bf16_f32 v201, v130, v131
v_cvt_pk_bf16_f32 v202, v144, v145
v_cvt_pk_bf16_f32 v203, v146, v147
v_cvt_pk_bf16_f32 v204, v160, v161
v_cvt_pk_bf16_f32 v205, v162, v163
v_cvt_pk_bf16_f32 v206, v176, v177
v_cvt_pk_bf16_f32 v207, v178, v179
v_mov_b32 v56, 0xff800000
v_mov_b32 v57, 0xff800000
v_mov_b32 v58, 0xff800000
v_mov_b32 v59, 0xff800000
s_waitcnt lgkmcnt(8)
v_mfma_f32_16x16x32_bf16 v[64:67], a[128:131], v[192:195], 0
v_add_u32 v164, 1024, v1
v_mfma_f32_16x16x32_bf16 v[64:67], a[132:135], v[196:199], v[64:67]
buffer_load_dwordx4 v[160:163], v164, s[56:59], 0 offen sc1
v_mfma_f32_16x16x32_bf16 v[64:67], a[136:139], v[200:203], v[64:67]
s_add_u32 m0, s47, 131072
v_mfma_f32_16x16x32_bf16 v[64:67], a[140:143], v[204:207], v[64:67]
buffer_load_dwordx4 v36, s[24:27], 0 offen offset:0 lds
v_mfma_f32_16x16x32_bf16 v[68:71], a[128:131], v[208:211], 0
v_mfma_f32_16x16x32_bf16 v[68:71], a[132:135], v[212:215], v[68:71]
buffer_load_dwordx4 v37, s[24:27], 0 offen offset:1024 lds
v_mfma_f32_16x16x32_bf16 v[68:71], a[136:139], v[216:219], v[68:71]
v_mov_b32 v55, 0
v_mov_b32 v54, 0
v_mfma_f32_16x16x32_bf16 v[68:71], a[140:143], v[220:223], v[68:71]
buffer_load_dwordx4 v38, s[24:27], 0 offen offset:2048 lds
v_mfma_f32_16x16x32_bf16 v[72:75], a[128:131], v[224:227], 0
v_mov_b32 v53, 0
v_mov_b32 v52, 0
v_mfma_f32_16x16x32_bf16 v[72:75], a[132:135], v[228:231], v[72:75]
v_mov_b32 v51, 0
v_mfma_f32_16x16x32_bf16 v[72:75], a[136:139], v[232:235], v[72:75]
buffer_load_dwordx4 v39, s[24:27], 0 offen offset:3072 lds
v_mfma_f32_16x16x32_bf16 v[72:75], a[140:143], v[236:239], v[72:75]
v_mov_b32 v50, 0
v_mov_b32 v49, 0
v_mfma_f32_16x16x32_bf16 v[76:79], a[128:131], v[240:243], 0
v_mov_b32 v48, 0
s_add_u32 m0, s47, 135168
v_mfma_f32_16x16x32_bf16 v[76:79], a[132:135], v[244:247], v[76:79]
buffer_load_dwordx4 v40, s[24:27], 0 offen lds
v_mfma_f32_16x16x32_bf16 v[76:79], a[136:139], v[248:251], v[76:79]
v_mov_b32 v47, 0
v_mov_b32 v46, 0
v_mfma_f32_16x16x32_bf16 v[76:79], a[140:143], v[252:255], v[76:79]
v_mov_b32 v45, 0
v_mov_b32 v44, 0
v_mov_b32 v43, 0
v_mov_b32 v42, 0
v_mov_b32 v41, 0
v_mov_b32 v40, 0
L_at_start:
v_mfma_f32_16x16x32_bf16 v[80:83], a[144:147], v[192:195], 0
v_mfma_f32_16x16x32_bf16 v[80:83], a[148:151], v[196:199], v[80:83]
v_mfma_f32_16x16x32_bf16 v[80:83], a[152:155], v[200:203], v[80:83]
v_max3_f32 v56, v56, v64, v65
v_max3_f32 v57, v57, v68, v69
v_max3_f32 v58, v58, v72, v73
v_mfma_f32_16x16x32_bf16 v[80:83], a[156:159], v[204:207], v[80:83]
v_max3_f32 v59, v59, v76, v77
v_max3_f32 v56, v56, v66, v67
v_mfma_f32_16x16x32_bf16 v[84:87], a[144:147], v[208:211], 0
v_max3_f32 v57, v57, v70, v71
v_max3_f32 v58, v58, v74, v75
v_mfma_f32_16x16x32_bf16 v[84:87], a[148:151], v[212:215], v[84:87]
v_max3_f32 v59, v59, v78, v79
v_mov_b32 v24, v56
v_mov_b32 v28, v57
v_mfma_f32_16x16x32_bf16 v[84:87], a[152:155], v[216:219], v[84:87]
v_mov_b32 v32, v58
v_mov_b32 v36, v59
v_mfma_f32_16x16x32_bf16 v[84:87], a[156:159], v[220:223], v[84:87]
v_permlane32_swap_b32 v56, v24
v_permlane32_swap_b32 v57, v28
v_mfma_f32_16x16x32_bf16 v[88:91], a[144:147], v[224:227], 0
v_permlane32_swap_b32 v58, v32
v_permlane32_swap_b32 v59, v36
v_mfma_f32_16x16x32_bf16 v[88:91], a[148:151], v[228:231], v[88:91]
v_max_f32 v56, v56, v24
v_max_f32 v57, v57, v28
v_max_f32 v58, v58, v32
v_mfma_f32_16x16x32_bf16 v[88:91], a[152:155], v[232:235], v[88:91]
v_max_f32 v59, v59, v36
v_mov_b32 v24, v56
v_mfma_f32_16x16x32_bf16 v[88:91], a[156:159], v[236:239], v[88:91]
v_mov_b32 v28, v57
v_mov_b32 v32, v58
v_mfma_f32_16x16x32_bf16 v[92:95], a[144:147], v[240:243], 0
v_mov_b32 v36, v59
v_permlane16_swap_b32 v56, v24
v_permlane16_swap_b32 v57, v28
v_mfma_f32_16x16x32_bf16 v[92:95], a[148:151], v[244:247], v[92:95]
v_permlane16_swap_b32 v58, v32
v_permlane16_swap_b32 v59, v36
v_mfma_f32_16x16x32_bf16 v[92:95], a[152:155], v[248:251], v[92:95]
v_max_f32 v56, v56, v24
v_max_f32 v57, v57, v28
v_mfma_f32_16x16x32_bf16 v[92:95], a[156:159], v[252:255], v[92:95]
v_max_f32 v58, v58, v32
v_max_f32 v59, v59, v36
v_sub_f32 v24, 0, v56
v_sub_f32 v25, 0, v56
v_sub_f32 v26, 0, v56
v_sub_f32 v27, 0, v56
s_mov_b32 s41, 65536
s_waitcnt lgkmcnt(0)
v_mfma_f32_16x16x32_bf16 v[96:99], a[160:163], v[192:195], v[24:27]
v_sub_f32 v28, 0, v57
v_sub_f32 v29, 0, v57
v_mfma_f32_16x16x32_bf16 v[96:99], a[164:167], v[196:199], v[96:99]
v_sub_f32 v30, 0, v57
v_sub_f32 v31, 0, v57
v_mfma_f32_16x16x32_bf16 v[96:99], a[168:171], v[200:203], v[96:99]
v_mfma_f32_16x16x32_bf16 v[96:99], a[172:175], v[204:207], v[96:99]
v_mfma_f32_16x16x32_bf16 v[100:103], a[160:163], v[208:211], v[28:31]
v_sub_f32 v32, 0, v58
v_sub_f32 v33, 0, v58
v_mfma_f32_16x16x32_bf16 v[100:103], a[164:167], v[212:215], v[100:103]
v_sub_f32 v34, 0, v58
v_sub_f32 v35, 0, v58
v_mfma_f32_16x16x32_bf16 v[100:103], a[168:171], v[216:219], v[100:103]
v_mfma_f32_16x16x32_bf16 v[100:103], a[172:175], v[220:223], v[100:103]
v_mfma_f32_16x16x32_bf16 v[104:107], a[160:163], v[224:227], v[32:35]
v_sub_f32 v36, 0, v59
v_sub_f32 v37, 0, v59
v_mfma_f32_16x16x32_bf16 v[104:107], a[164:167], v[228:231], v[104:107]
v_sub_f32 v38, 0, v59
v_sub_f32 v39, 0, v59
v_mfma_f32_16x16x32_bf16 v[104:107], a[168:171], v[232:235], v[104:107]
v_add_f32 v64, v24, v64
v_add_f32 v65, v24, v65
v_mfma_f32_16x16x32_bf16 v[104:107], a[172:175], v[236:239], v[104:107]
v_add_f32 v66, v24, v66
v_add_f32 v67, v24, v67
v_mfma_f32_16x16x32_bf16 v[108:111], a[160:163], v[240:243], v[36:39]
v_add_f32 v68, v28, v68
v_add_f32 v69, v28, v69
s_lshl_b32 s92, s90, 7
v_mfma_f32_16x16x32_bf16 v[108:111], a[164:167], v[244:247], v[108:111]
v_add_f32 v70, v28, v70
v_add_f32 v71, v28, v71
v_mfma_f32_16x16x32_bf16 v[108:111], a[168:171], v[248:251], v[108:111]
v_add_f32 v72, v32, v72
v_add_f32 v73, v32, v73
s_waitcnt vmcnt(18)
v_mfma_f32_16x16x32_bf16 v[108:111], a[172:175], v[252:255], v[108:111]
v_add_f32 v74, v32, v74
v_add_f32 v75, v32, v75
s_barrier
s_add_u32 s24, s72, s92
s_addc_u32 s25, s73, 0
v_mfma_f32_16x16x32_bf16 v[112:115], a[176:179], v[192:195], v[24:27]
v_add_f32 v76, v36, v76
v_add_f32 v77, v36, v77
ds_read_b128 a[128:131], v2 offset:49152
v_mfma_f32_16x16x32_bf16 v[112:115], a[180:183], v[196:199], v[112:115]
v_add_f32 v78, v36, v78
v_add_f32 v79, v36, v79
v_mfma_f32_16x16x32_bf16 v[112:115], a[184:187], v[200:203], v[112:115]
ds_read_b128 a[132:135], v3 offset:49152
v_mfma_f32_16x16x32_bf16 v[112:115], a[188:191], v[204:207], v[112:115]
ds_read_b128 a[136:139], v4 offset:49152
s_mov_b32 s26, 7074560
v_mfma_f32_16x16x32_bf16 v[116:119], a[176:179], v[208:211], v[28:31]
v_mfma_f32_16x16x32_bf16 v[116:119], a[180:183], v[212:215], v[116:119]
ds_read_b128 a[140:143], v5 offset:49152
v_mfma_f32_16x16x32_bf16 v[116:119], a[184:187], v[216:219], v[116:119]
ds_read_b128 a[144:147], v2 offset:53248
v_add_f32 v80, v24, v80
v_add_f32 v81, v24, v81
v_mfma_f32_16x16x32_bf16 v[116:119], a[188:191], v[220:223], v[116:119]
ds_read_b128 a[148:151], v3 offset:53248
v_add_f32 v82, v24, v82
v_add_f32 v83, v24, v83
s_mov_b32 s27, 0x20000
v_mfma_f32_16x16x32_bf16 v[120:123], a[176:179], v[224:227], v[32:35]
v_add_f32 v84, v28, v84
v_mfma_f32_16x16x32_bf16 v[120:123], a[180:183], v[228:231], v[120:123]
ds_read_b128 a[152:155], v4 offset:53248
v_add_f32 v85, v28, v85
v_add_f32 v86, v28, v86
v_mfma_f32_16x16x32_bf16 v[120:123], a[184:187], v[232:235], v[120:123]
ds_read_b128 a[156:159], v5 offset:53248
v_add_f32 v87, v28, v87
v_mfma_f32_16x16x32_bf16 v[120:123], a[188:191], v[236:239], v[120:123]
v_add_f32 v88, v32, v88
v_add_f32 v89, v32, v89
s_cmp_eq_u32 s3, 1
s_cselect_b32 s26, 0, 7074560
v_mfma_f32_16x16x32_bf16 v[124:127], a[176:179], v[240:243], v[36:39]
v_add_f32 v90, v32, v90
v_add_f32 v91, v32, v91
v_mfma_f32_16x16x32_bf16 v[124:127], a[180:183], v[244:247], v[124:127]
v_add_f32 v92, v36, v92
v_mfma_f32_16x16x32_bf16 v[124:127], a[184:187], v[248:251], v[124:127]
v_add_f32 v93, v36, v93
v_add_f32 v94, v36, v94
v_mfma_f32_16x16x32_bf16 v[124:127], a[188:191], v[252:255], v[124:127]
v_add_f32 v95, v36, v95
ds_read_b128 a[160:163], v2 offset:57344
ds_read_b128 a[164:167], v3 offset:57344
ds_read_b128 a[168:171], v4 offset:57344
ds_read_b128 a[172:175], v5 offset:57344
ds_read_b128 a[176:179], v2 offset:61440
v_exp_f32 v64, v64
v_exp_f32 v65, v65
s_nop 0
v_cvt_pk_bf16_f32 v128, v64, v65
v_exp_f32 v66, v66
v_exp_f32 v67, v67
s_nop 0
v_cvt_pk_bf16_f32 v129, v66, v67
v_exp_f32 v68, v68
v_exp_f32 v69, v69
s_nop 0
v_cvt_pk_bf16_f32 v136, v68, v69
v_exp_f32 v70, v70
v_exp_f32 v71, v71
s_nop 0
v_cvt_pk_bf16_f32 v137, v70, v71
v_exp_f32 v72, v72
v_exp_f32 v73, v73
s_nop 0
v_cvt_pk_bf16_f32 v144, v72, v73
v_exp_f32 v74, v74
v_exp_f32 v75, v75
s_nop 0
v_cvt_pk_bf16_f32 v145, v74, v75
v_exp_f32 v76, v76
v_exp_f32 v77, v77
s_nop 0
v_cvt_pk_bf16_f32 v152, v76, v77
v_exp_f32 v78, v78
v_exp_f32 v79, v79
s_nop 0
v_cvt_pk_bf16_f32 v153, v78, v79
v_exp_f32 v80, v80
v_exp_f32 v81, v81
s_nop 0
v_cvt_pk_bf16_f32 v130, v80, v81
v_exp_f32 v82, v82
v_exp_f32 v83, v83
s_nop 0
v_cvt_pk_bf16_f32 v131, v82, v83
v_exp_f32 v84, v84
v_exp_f32 v85, v85
s_nop 0
v_cvt_pk_bf16_f32 v138, v84, v85
v_exp_f32 v86, v86
v_exp_f32 v87, v87
s_nop 0
v_cvt_pk_bf16_f32 v139, v86, v87
v_exp_f32 v88, v88
v_exp_f32 v89, v89
s_nop 0
v_cvt_pk_bf16_f32 v146, v88, v89
v_exp_f32 v90, v90
v_exp_f32 v91, v91
s_nop 0
v_cvt_pk_bf16_f32 v147, v90, v91
v_exp_f32 v92, v92
v_exp_f32 v93, v93
s_nop 0
v_cvt_pk_bf16_f32 v154, v92, v93
v_exp_f32 v94, v94
v_exp_f32 v95, v95
v_exp_f32 v96, v96
v_exp_f32 v97, v97
v_cvt_pk_bf16_f32 v155, v94, v95
v_exp_f32 v98, v98
v_cvt_pk_bf16_f32 v132, v96, v97
v_exp_f32 v99, v99
v_exp_f32 v100, v100
v_exp_f32 v101, v101
v_cvt_pk_bf16_f32 v133, v98, v99
v_cvt_pk_bf16_f32 v140, v100, v101
v_exp_f32 v102, v102
v_exp_f32 v103, v103
v_exp_f32 v104, v104
v_exp_f32 v105, v105
v_cvt_pk_bf16_f32 v141, v102, v103
v_cvt_pk_bf16_f32 v148, v104, v105
v_exp_f32 v106, v106
v_exp_f32 v107, v107
s_nop 0
v_cvt_pk_bf16_f32 v149, v106, v107
v_exp_f32 v108, v108
v_exp_f32 v109, v109
s_nop 0
v_cvt_pk_bf16_f32 v156, v108, v109
v_exp_f32 v110, v110
v_exp_f32 v111, v111
s_mov_b32 m0, s50
s_nop 0
buffer_load_dwordx4 v14, s[12:15], s41 offen offset:0 lds
buffer_load_dwordx4 v15, s[12:15], s41 offen offset:1024 lds
buffer_load_dwordx4 v16, s[12:15], s41 offen offset:2048 lds
v_lshrrev_b32 v57, 7, v1
v_min_u32 v57, 1, v57
v_lshlrev_b32 v57, 31, v57
v_lshl_add_u32 v57, v1, 3, v57
s_cmp_lg_u32 s44, 0
s_cbranch_scc1 L_skip_h
v_add_u32 v166, s40, v1
v_min_u32 v166, 1, v166
v_lshlrev_b32 v166, 31, v166
v_mov_b32 v167, s82
s_waitcnt vmcnt(8)
v_xor_b32 v160, s82, v160
v_xor_b32 v161, s82, v161
v_xor_b32 v162, s82, v162
v_xor_b32 v163, s82, v163
v_or_b32 v160, v160, v161
v_or3_b32 v160, v160, v162, v163
v_cmp_ne_u32 vcc, 0, v160
s_nop 3
s_cbranch_vccnz L_spin_h
L_ok_h:
s_cmp_eq_u32 s2, 0
s_cselect_b32 s92, 0, 0x10000
buffer_store_dword v167, v166, s[56:59], s92 offen sc1
s_mov_b32 s45, 0
L_skip_h:
.p2align 6
L_at_loop:
s_waitcnt lgkmcnt(5)
v_mfma_f32_16x16x32_bf16 v[64:67], a[128:131], v[192:195], v[24:27]
v_cvt_pk_bf16_f32 v157, v110, v111
v_mfma_f32_16x16x32_bf16 v[64:67], a[132:135], v[196:199], v[64:67]
v_exp_f32 v112, v112
v_mfma_f32_16x16x32_bf16 v[64:67], a[136:139], v[200:203], v[64:67]
ds_read_b128 a[180:183], v3 offset:61440
v_mfma_f32_16x16x32_bf16 v[64:67], a[140:143], v[204:207], v[64:67]
v_exp_f32 v113, v113
v_mfma_f32_16x16x32_bf16 v[68:71], a[128:131], v[208:211], v[28:31]
ds_read_b128 a[184:187], v4 offset:61440
v_cvt_pk_bf16_f32 v134, v112, v113
v_mfma_f32_16x16x32_bf16 v[68:71], a[132:135], v[212:215], v[68:71]
v_exp_f32 v114, v114
v_mfma_f32_16x16x32_bf16 v[68:71], a[136:139], v[216:219], v[68:71]
buffer_load_dwordx4 v17, s[12:15], s41 offen offset:3072 lds
v_mfma_f32_16x16x32_bf16 v[68:71], a[140:143], v[220:223], v[68:71]
v_exp_f32 v115, v115
v_mfma_f32_16x16x32_bf16 v[72:75], a[128:131], v[224:227], v[32:35]
ds_read_b128 a[188:191], v5 offset:61440
v_cvt_pk_bf16_f32 v135, v114, v115
v_mfma_f32_16x16x32_bf16 v[72:75], a[132:135], v[228:231], v[72:75]
v_exp_f32 v116, v116
v_mfma_f32_16x16x32_bf16 v[72:75], a[136:139], v[232:235], v[72:75]
ds_read_b64_tr_b16 a[192:193], v6 offset:32768
v_mfma_f32_16x16x32_bf16 v[72:75], a[140:143], v[236:239], v[72:75]
v_exp_f32 v117, v117
v_mfma_f32_16x16x32_bf16 v[76:79], a[128:131], v[240:243], v[36:39]
ds_read_b64_tr_b16 a[194:195], v6 offset:36864
v_cvt_pk_bf16_f32 v142, v116, v117
v_mfma_f32_16x16x32_bf16 v[76:79], a[132:135], v[244:247], v[76:79]
v_exp_f32 v118, v118
v_mfma_f32_16x16x32_bf16 v[76:79], a[136:139], v[248:251], v[76:79]
s_mov_b32 m0, s52
v_mfma_f32_16x16x32_bf16 v[76:79], a[140:143], v[252:255], v[76:79]
v_exp_f32 v119, v119
v_mfma_f32_16x16x32_bf16 v[80:83], a[144:147], v[192:195], v[24:27]
ds_read_b64_tr_b16 a[196:197], v6 offset:40960
v_cvt_pk_bf16_f32 v143, v118, v119
v_mfma_f32_16x16x32_bf16 v[80:83], a[148:151], v[196:199], v[80:83]
v_exp_f32 v120, v120
v_mfma_f32_16x16x32_bf16 v[80:83], a[152:155], v[200:203], v[80:83]
buffer_load_dwordx4 v18, s[16:19], s41 offen offset:0 lds
v_mfma_f32_16x16x32_bf16 v[80:83], a[156:159], v[204:207], v[80:83]
ds_read_b64_tr_b16 a[198:199], v6 offset:45056
v_mfma_f32_16x16x32_bf16 v[84:87], a[144:147], v[208:211], v[28:31]
v_exp_f32 v121, v121
v_mfma_f32_16x16x32_bf16 v[84:87], a[148:151], v[212:215], v[84:87]
v_exp_f32 v122, v122
v_mfma_f32_16x16x32_bf16 v[84:87], a[152:155], v[216:219], v[84:87]
ds_read_b64_tr_b16 a[200:201], v7 offset:32768
v_cvt_pk_bf16_f32 v150, v120, v121
v_mfma_f32_16x16x32_bf16 v[84:87], a[156:159], v[220:223], v[84:87]
v_exp_f32 v123, v123
v_mfma_f32_16x16x32_bf16 v[88:91], a[144:147], v[224:227], v[32:35]
ds_read_b64_tr_b16 a[202:203], v7 offset:36864
v_cvt_pk_bf16_f32 v151, v122, v123
v_mfma_f32_16x16x32_bf16 v[88:91], a[148:151], v[228:231], v[88:91]
v_exp_f32 v124, v124
v_mfma_f32_16x16x32_bf16 v[88:91], a[152:155], v[232:235], v[88:91]
ds_read_b64_tr_b16 a[204:205], v7 offset:40960
v_mfma_f32_16x16x32_bf16 v[88:91], a[156:159], v[236:239], v[88:91]
v_exp_f32 v125, v125
v_mfma_f32_16x16x32_bf16 v[92:95], a[144:147], v[240:243], v[36:39]
ds_read_b64_tr_b16 a[206:207], v7 offset:45056
v_cvt_pk_bf16_f32 v158, v124, v125
v_mfma_f32_16x16x32_bf16 v[92:95], a[148:151], v[244:247], v[92:95]
v_exp_f32 v126, v126
v_mfma_f32_16x16x32_bf16 v[92:95], a[152:155], v[248:251], v[92:95]
buffer_load_dwordx4 v19, s[16:19], s41 offen offset:1024 lds
v_mfma_f32_16x16x32_bf16 v[92:95], a[156:159], v[252:255], v[92:95]
ds_read_b64_tr_b16 a[208:209], v8 offset:32768
s_waitcnt lgkmcnt(9)
v_mfma_f32_16x16x32_bf16 v[96:99], a[160:163], v[192:195], v[24:27]
v_exp_f32 v127, v127
v_mfma_f32_16x16x32_bf16 v[96:99], a[164:167], v[196:199], v[96:99]
ds_read_b64_tr_b16 a[210:211], v8 offset:36864
v_cvt_pk_bf16_f32 v159, v126, v127
v_mfma_f32_16x16x32_bf16 v[96:99], a[168:171], v[200:203], v[96:99]
v_exp_f32 v64, v64
v_mfma_f32_16x16x32_bf16 v[96:99], a[172:175], v[204:207], v[96:99]
v_mfma_f32_16x16x32_bf16 v[100:103], a[160:163], v[208:211], v[28:31]
v_exp_f32 v65, v65
v_mfma_f32_16x16x32_bf16 v[100:103], a[164:167], v[212:215], v[100:103]
ds_read_b64_tr_b16 a[212:213], v8 offset:40960
v_cvt_pk_bf16_f32 v160, v64, v65
v_mfma_f32_16x16x32_bf16 v[100:103], a[168:171], v[216:219], v[100:103]
v_exp_f32 v66, v66
v_mfma_f32_16x16x32_bf16 v[100:103], a[172:175], v[220:223], v[100:103]
ds_read_b64_tr_b16 a[214:215], v8 offset:45056
v_mfma_f32_16x16x32_bf16 v[104:107], a[160:163], v[224:227], v[32:35]
v_exp_f32 v67, v67
v_mfma_f32_16x16x32_bf16 v[104:107], a[164:167], v[228:231], v[104:107]
ds_read_b64_tr_b16 a[216:217], v9 offset:32768
v_cvt_pk_bf16_f32 v161, v66, v67
v_mfma_f32_16x16x32_bf16 v[104:107], a[168:171], v[232:235], v[104:107]
v_exp_f32 v68, v68
v_mfma_f32_16x16x32_bf16 v[104:107], a[172:175], v[236:239], v[104:107]
buffer_load_dwordx4 v18, s[16:19], s41 offen offset:2048 lds
v_mfma_f32_16x16x32_bf16 v[108:111], a[160:163], v[240:243], v[36:39]
v_exp_f32 v69, v69
v_mfma_f32_16x16x32_bf16 v[108:111], a[164:167], v[244:247], v[108:111]
ds_read_b64_tr_b16 a[218:219], v9 offset:36864
v_cvt_pk_bf16_f32 v168, v68, v69
v_mfma_f32_16x16x32_bf16 v[108:111], a[168:171], v[248:251], v[108:111]
v_exp_f32 v70, v70
v_mfma_f32_16x16x32_bf16 v[108:111], a[172:175], v[252:255], v[108:111]
ds_read_b64_tr_b16 a[220:221], v9 offset:40960
v_mfma_f32_16x16x32_bf16 v[112:115], a[176:179], v[192:195], v[24:27]
v_exp_f32 v71, v71
v_mfma_f32_16x16x32_bf16 v[112:115], a[180:183], v[196:199], v[112:115]
ds_read_b64_tr_b16 a[222:223], v9 offset:45056
v_cvt_pk_bf16_f32 v169, v70, v71
v_mfma_f32_16x16x32_bf16 v[112:115], a[184:187], v[200:203], v[112:115]
v_exp_f32 v72, v72
v_mfma_f32_16x16x32_bf16 v[112:115], a[188:191], v[204:207], v[112:115]
v_mfma_f32_16x16x32_bf16 v[116:119], a[176:179], v[208:211], v[28:31]
v_exp_f32 v73, v73
v_mfma_f32_16x16x32_bf16 v[116:119], a[180:183], v[212:215], v[116:119]
ds_read_b64_tr_b16 a[224:225], v10 offset:32768
v_cvt_pk_bf16_f32 v176, v72, v73
v_mfma_f32_16x16x32_bf16 v[116:119], a[184:187], v[216:219], v[116:119]
v_exp_f32 v74, v74
v_mfma_f32_16x16x32_bf16 v[116:119], a[188:191], v[220:223], v[116:119]
buffer_load_dwordx4 v19, s[16:19], s41 offen offset:3072 lds
v_mfma_f32_16x16x32_bf16 v[120:123], a[176:179], v[224:227], v[32:35]
v_exp_f32 v75, v75
v_mfma_f32_16x16x32_bf16 v[120:123], a[180:183], v[228:231], v[120:123]
ds_read_b64_tr_b16 a[226:227], v10 offset:36864
v_cvt_pk_bf16_f32 v177, v74, v75
v_mfma_f32_16x16x32_bf16 v[120:123], a[184:187], v[232:235], v[120:123]
v_exp_f32 v76, v76
v_mfma_f32_16x16x32_bf16 v[120:123], a[188:191], v[236:239], v[120:123]
ds_read_b64_tr_b16 a[228:229], v10 offset:40960
s_add_u32 s41, s41, 16384
v_mfma_f32_16x16x32_bf16 v[124:127], a[176:179], v[240:243], v[36:39]
v_exp_f32 v77, v77
v_mfma_f32_16x16x32_bf16 v[124:127], a[180:183], v[244:247], v[124:127]
ds_read_b64_tr_b16 a[230:231], v10 offset:45056
v_cvt_pk_bf16_f32 v184, v76, v77
v_mfma_f32_16x16x32_bf16 v[124:127], a[184:187], v[248:251], v[124:127]
v_exp_f32 v78, v78
v_mfma_f32_16x16x32_bf16 v[124:127], a[188:191], v[252:255], v[124:127]
ds_read_b64_tr_b16 a[232:233], v11 offset:32768
s_waitcnt lgkmcnt(5)
v_mfma_f32_16x16x32_bf16 a[0:3], a[192:195], v[128:131], a[0:3]
v_exp_f32 v79, v79
v_mfma_f32_16x16x32_bf16 a[0:3], a[196:199], v[132:135], a[0:3]
ds_read_b64_tr_b16 a[234:235], v11 offset:36864
v_cvt_pk_bf16_f32 v185, v78, v79
v_mfma_f32_16x16x32_bf16 a[4:7], a[192:195], v[136:139], a[4:7]
buffer_load_dword v61, v57, s[8:11], s45 offen offset:0
v_mfma_f32_16x16x32_bf16 a[4:7], a[196:199], v[140:143], a[4:7]
v_exp_f32 v80, v80
v_mfma_f32_16x16x32_bf16 a[8:11], a[192:195], v[144:147], a[8:11]
ds_read_b64_tr_b16 a[236:237], v11 offset:40960
v_mfma_f32_16x16x32_bf16 a[8:11], a[196:199], v[148:151], a[8:11]
v_exp_f32 v81, v81
v_mfma_f32_16x16x32_bf16 a[12:15], a[192:195], v[152:155], a[12:15]
v_cvt_pk_bf16_f32 v162, v80, v81
v_mfma_f32_16x16x32_bf16 a[12:15], a[196:199], v[156:159], a[12:15]
v_exp_f32 v82, v82
v_mfma_f32_16x16x32_bf16 a[16:19], a[200:203], v[128:131], a[16:19]
ds_read_b64_tr_b16 a[238:239], v11 offset:45056
v_mfma_f32_16x16x32_bf16 a[16:19], a[204:207], v[132:135], a[16:19]
v_exp_f32 v83, v83
v_mfma_f32_16x16x32_bf16 a[20:23], a[200:203], v[136:139], a[20:23]
ds_read_b64_tr_b16 a[240:241], v12 offset:32768
v_cvt_pk_bf16_f32 v163, v82, v83
v_mfma_f32_16x16x32_bf16 a[20:23], a[204:207], v[140:143], a[20:23]
v_exp_f32 v84, v84
v_mfma_f32_16x16x32_bf16 a[24:27], a[200:203], v[144:147], a[24:27]
ds_read_b64_tr_b16 a[242:243], v12 offset:36864
v_mfma_f32_16x16x32_bf16 a[24:27], a[204:207], v[148:151], a[24:27]
v_exp_f32 v85, v85
v_mfma_f32_16x16x32_bf16 a[28:31], a[200:203], v[152:155], a[28:31]
v_cvt_pk_bf16_f32 v170, v84, v85
v_mfma_f32_16x16x32_bf16 a[28:31], a[204:207], v[156:159], a[28:31]
v_exp_f32 v86, v86
v_smfmac_f32_16x16x64_bf16 v[40:43], v[20:23], v[128:135], v62
ds_read_b64_tr_b16 a[244:245], v12 offset:40960
v_mfma_f32_16x16x32_bf16 a[32:35], a[208:211], v[128:131], a[32:35]
v_exp_f32 v87, v87
v_mfma_f32_16x16x32_bf16 a[32:35], a[212:215], v[132:135], a[32:35]
ds_read_b64_tr_b16 a[246:247], v12 offset:45056
v_cvt_pk_bf16_f32 v171, v86, v87
v_mfma_f32_16x16x32_bf16 a[36:39], a[208:211], v[136:139], a[36:39]
v_exp_f32 v88, v88
v_mfma_f32_16x16x32_bf16 a[36:39], a[212:215], v[140:143], a[36:39]
ds_read_b64_tr_b16 a[248:249], v13 offset:32768
v_mfma_f32_16x16x32_bf16 a[40:43], a[208:211], v[144:147], a[40:43]
v_exp_f32 v89, v89
v_mfma_f32_16x16x32_bf16 a[40:43], a[212:215], v[148:151], a[40:43]
v_cvt_pk_bf16_f32 v178, v88, v89
v_mfma_f32_16x16x32_bf16 a[44:47], a[208:211], v[152:155], a[44:47]
v_exp_f32 v90, v90
v_mfma_f32_16x16x32_bf16 a[44:47], a[212:215], v[156:159], a[44:47]
ds_read_b64_tr_b16 a[250:251], v13 offset:36864
v_mfma_f32_16x16x32_bf16 a[48:51], a[216:219], v[128:131], a[48:51]
v_exp_f32 v91, v91
v_mfma_f32_16x16x32_bf16 a[48:51], a[220:223], v[132:135], a[48:51]
ds_read_b64_tr_b16 a[252:253], v13 offset:40960
v_cvt_pk_bf16_f32 v179, v90, v91
v_mfma_f32_16x16x32_bf16 a[52:55], a[216:219], v[136:139], a[52:55]
v_exp_f32 v92, v92
v_mfma_f32_16x16x32_bf16 a[52:55], a[220:223], v[140:143], a[52:55]
ds_read_b64_tr_b16 a[254:255], v13 offset:45056
v_mfma_f32_16x16x32_bf16 a[56:59], a[216:219], v[144:147], a[56:59]
v_exp_f32 v93, v93
v_mfma_f32_16x16x32_bf16 a[56:59], a[220:223], v[148:151], a[56:59]
v_cvt_pk_bf16_f32 v186, v92, v93
v_mfma_f32_16x16x32_bf16 a[60:63], a[216:219], v[152:155], a[60:63]
v_exp_f32 v94, v94
v_mfma_f32_16x16x32_bf16 a[60:63], a[220:223], v[156:159], a[60:63]
v_smfmac_f32_16x16x64_bf16 v[44:47], v[20:23], v[136:143], v62
s_waitcnt lgkmcnt(0)
v_mfma_f32_16x16x32_bf16 a[64:67], a[224:227], v[128:131], a[64:67]
s_waitcnt vmcnt(9)
s_barrier
v_mfma_f32_16x16x32_bf16 a[64:67], a[228:231], v[132:135], a[64:67]
v_exp_f32 v95, v95
v_mfma_f32_16x16x32_bf16 a[68:71], a[224:227], v[136:139], a[68:71]
s_mov_b32 m0, s51
ds_read_b128 a[128:131], v2 offset:0
v_mfma_f32_16x16x32_bf16 a[68:71], a[228:231], v[140:143], a[68:71]
v_exp_f32 v96, v96
v_mfma_f32_16x16x32_bf16 a[72:75], a[224:227], v[144:147], a[72:75]
buffer_load_dwordx4 v14, s[12:15], s41 offen offset:0 lds
v_mfma_f32_16x16x32_bf16 a[72:75], a[228:231], v[148:151], a[72:75]
v_exp_f32 v97, v97
v_mfma_f32_16x16x32_bf16 a[76:79], a[224:227], v[152:155], a[76:79]
ds_read_b128 a[132:135], v3 offset:0
v_cvt_pk_bf16_f32 v187, v94, v95
v_mfma_f32_16x16x32_bf16 a[76:79], a[228:231], v[156:159], a[76:79]
v_exp_f32 v98, v98
v_mfma_f32_16x16x32_bf16 a[80:83], a[232:235], v[128:131], a[80:83]
ds_read_b128 a[136:139], v4 offset:0
v_cvt_pk_bf16_f32 v164, v96, v97
v_mfma_f32_16x16x32_bf16 a[80:83], a[236:239], v[132:135], a[80:83]
v_exp_f32 v99, v99
v_mfma_f32_16x16x32_bf16 a[84:87], a[232:235], v[136:139], a[84:87]
v_exp_f32 v100, v100
v_mfma_f32_16x16x32_bf16 a[84:87], a[236:239], v[140:143], a[84:87]
ds_read_b128 a[140:143], v5 offset:0
ds_read_b128 a[144:147], v2 offset:4096
v_mfma_f32_16x16x32_bf16 a[88:91], a[232:235], v[144:147], a[88:91]
v_exp_f32 v101, v101
v_mfma_f32_16x16x32_bf16 a[88:91], a[236:239], v[148:151], a[88:91]
v_cvt_pk_bf16_f32 v165, v98, v99
v_cvt_pk_bf16_f32 v172, v100, v101
v_mfma_f32_16x16x32_bf16 a[92:95], a[232:235], v[152:155], a[92:95]
v_exp_f32 v102, v102
v_mfma_f32_16x16x32_bf16 a[92:95], a[236:239], v[156:159], a[92:95]
ds_read_b128 a[148:151], v3 offset:4096
v_smfmac_f32_16x16x64_bf16 v[48:51], v[20:23], v[144:151], v62
buffer_load_dwordx4 v15, s[12:15], s41 offen offset:1024 lds
v_mfma_f32_16x16x32_bf16 a[96:99], a[240:243], v[128:131], a[96:99]
v_exp_f32 v103, v103
v_mfma_f32_16x16x32_bf16 a[96:99], a[244:247], v[132:135], a[96:99]
v_exp_f32 v104, v104
v_mfma_f32_16x16x32_bf16 a[100:103], a[240:243], v[136:139], a[100:103]
ds_read_b128 a[152:155], v4 offset:4096
ds_read_b128 a[156:159], v5 offset:4096
v_mfma_f32_16x16x32_bf16 a[100:103], a[244:247], v[140:143], a[100:103]
v_exp_f32 v105, v105
v_mfma_f32_16x16x32_bf16 a[104:107], a[240:243], v[144:147], a[104:107]
v_cvt_pk_bf16_f32 v173, v102, v103
v_cvt_pk_bf16_f32 v180, v104, v105
v_mfma_f32_16x16x32_bf16 a[104:107], a[244:247], v[148:151], a[104:107]
v_exp_f32 v106, v106
v_mfma_f32_16x16x32_bf16 a[108:111], a[240:243], v[152:155], a[108:111]
ds_read_b128 a[160:163], v2 offset:8192
v_mfma_f32_16x16x32_bf16 a[108:111], a[244:247], v[156:159], a[108:111]
v_exp_f32 v107, v107
v_mfma_f32_16x16x32_bf16 a[112:115], a[248:251], v[128:131], a[112:115]
ds_read_b128 a[164:167], v3 offset:8192
v_cvt_pk_bf16_f32 v181, v106, v107
v_mfma_f32_16x16x32_bf16 a[112:115], a[252:255], v[132:135], a[112:115]
v_exp_f32 v108, v108
v_mfma_f32_16x16x32_bf16 a[116:119], a[248:251], v[136:139], a[116:119]
buffer_load_dwordx4 v16, s[12:15], s41 offen offset:2048 lds
v_mfma_f32_16x16x32_bf16 a[116:119], a[252:255], v[140:143], a[116:119]
v_exp_f32 v109, v109
v_mfma_f32_16x16x32_bf16 a[120:123], a[248:251], v[144:147], a[120:123]
ds_read_b128 a[168:171], v4 offset:8192
v_cvt_pk_bf16_f32 v188, v108, v109
v_mfma_f32_16x16x32_bf16 a[120:123], a[252:255], v[148:151], a[120:123]
v_exp_f32 v110, v110
v_mfma_f32_16x16x32_bf16 a[124:127], a[248:251], v[152:155], a[124:127]
ds_read_b128 a[172:175], v5 offset:8192
v_mfma_f32_16x16x32_bf16 a[124:127], a[252:255], v[156:159], a[124:127]
v_exp_f32 v111, v111
v_smfmac_f32_16x16x64_bf16 v[52:55], v[20:23], v[152:159], v62
ds_read_b128 a[176:179], v2 offset:12288
s_waitcnt lgkmcnt(5)
v_mfma_f32_16x16x32_bf16 v[64:67], a[128:131], v[192:195], v[24:27]
v_cvt_pk_bf16_f32 v189, v110, v111
v_mfma_f32_16x16x32_bf16 v[64:67], a[132:135], v[196:199], v[64:67]
v_exp_f32 v112, v112
v_mfma_f32_16x16x32_bf16 v[64:67], a[136:139], v[200:203], v[64:67]
ds_read_b128 a[180:183], v3 offset:12288
v_mfma_f32_16x16x32_bf16 v[64:67], a[140:143], v[204:207], v[64:67]
v_exp_f32 v113, v113
v_mfma_f32_16x16x32_bf16 v[68:71], a[128:131], v[208:211], v[28:31]
ds_read_b128 a[184:187], v4 offset:12288
v_cvt_pk_bf16_f32 v166, v112, v113
v_mfma_f32_16x16x32_bf16 v[68:71], a[132:135], v[212:215], v[68:71]
v_exp_f32 v114, v114
v_mfma_f32_16x16x32_bf16 v[68:71], a[136:139], v[216:219], v[68:71]
buffer_load_dwordx4 v17, s[12:15], s41 offen offset:3072 lds
v_mfma_f32_16x16x32_bf16 v[68:71], a[140:143], v[220:223], v[68:71]
v_exp_f32 v115, v115
v_mfma_f32_16x16x32_bf16 v[72:75], a[128:131], v[224:227], v[32:35]
ds_read_b128 a[188:191], v5 offset:12288
v_cvt_pk_bf16_f32 v167, v114, v115
v_mfma_f32_16x16x32_bf16 v[72:75], a[132:135], v[228:231], v[72:75]
v_exp_f32 v116, v116
v_mfma_f32_16x16x32_bf16 v[72:75], a[136:139], v[232:235], v[72:75]
ds_read_b64_tr_b16 a[192:193], v6 offset:49152
v_mfma_f32_16x16x32_bf16 v[72:75], a[140:143], v[236:239], v[72:75]
v_exp_f32 v117, v117
v_mfma_f32_16x16x32_bf16 v[76:79], a[128:131], v[240:243], v[36:39]
ds_read_b64_tr_b16 a[194:195], v6 offset:53248
v_cvt_pk_bf16_f32 v174, v116, v117
v_mfma_f32_16x16x32_bf16 v[76:79], a[132:135], v[244:247], v[76:79]
v_exp_f32 v118, v118
v_mfma_f32_16x16x32_bf16 v[76:79], a[136:139], v[248:251], v[76:79]
s_mov_b32 m0, s53
v_mfma_f32_16x16x32_bf16 v[76:79], a[140:143], v[252:255], v[76:79]
v_exp_f32 v119, v119
v_mfma_f32_16x16x32_bf16 v[80:83], a[144:147], v[192:195], v[24:27]
ds_read_b64_tr_b16 a[196:197], v6 offset:57344
v_cvt_pk_bf16_f32 v175, v118, v119
v_mfma_f32_16x16x32_bf16 v[80:83], a[148:151], v[196:199], v[80:83]
v_exp_f32 v120, v120
v_mfma_f32_16x16x32_bf16 v[80:83], a[152:155], v[200:203], v[80:83]
buffer_load_dwordx4 v18, s[16:19], s41 offen offset:0 lds
v_mfma_f32_16x16x32_bf16 v[80:83], a[156:159], v[204:207], v[80:83]
ds_read_b64_tr_b16 a[198:199], v6 offset:61440
v_mfma_f32_16x16x32_bf16 v[84:87], a[144:147], v[208:211], v[28:31]
v_exp_f32 v121, v121
v_mfma_f32_16x16x32_bf16 v[84:87], a[148:151], v[212:215], v[84:87]
v_exp_f32 v122, v122
v_mfma_f32_16x16x32_bf16 v[84:87], a[152:155], v[216:219], v[84:87]
ds_read_b64_tr_b16 a[200:201], v7 offset:49152
v_cvt_pk_bf16_f32 v182, v120, v121
v_mfma_f32_16x16x32_bf16 v[84:87], a[156:159], v[220:223], v[84:87]
v_exp_f32 v123, v123
v_mfma_f32_16x16x32_bf16 v[88:91], a[144:147], v[224:227], v[32:35]
ds_read_b64_tr_b16 a[202:203], v7 offset:53248
v_cvt_pk_bf16_f32 v183, v122, v123
v_mfma_f32_16x16x32_bf16 v[88:91], a[148:151], v[228:231], v[88:91]
v_exp_f32 v124, v124
v_mfma_f32_16x16x32_bf16 v[88:91], a[152:155], v[232:235], v[88:91]
ds_read_b64_tr_b16 a[204:205], v7 offset:57344
v_mfma_f32_16x16x32_bf16 v[88:91], a[156:159], v[236:239], v[88:91]
v_exp_f32 v125, v125
v_mfma_f32_16x16x32_bf16 v[92:95], a[144:147], v[240:243], v[36:39]
ds_read_b64_tr_b16 a[206:207], v7 offset:61440
v_cvt_pk_bf16_f32 v190, v124, v125
v_mfma_f32_16x16x32_bf16 v[92:95], a[148:151], v[244:247], v[92:95]
v_exp_f32 v126, v126
v_mfma_f32_16x16x32_bf16 v[92:95], a[152:155], v[248:251], v[92:95]
buffer_load_dwordx4 v19, s[16:19], s41 offen offset:1024 lds
v_mfma_f32_16x16x32_bf16 v[92:95], a[156:159], v[252:255], v[92:95]
ds_read_b64_tr_b16 a[208:209], v8 offset:49152
s_waitcnt lgkmcnt(9)
v_mfma_f32_16x16x32_bf16 v[96:99], a[160:163], v[192:195], v[24:27]
v_exp_f32 v127, v127
v_mfma_f32_16x16x32_bf16 v[96:99], a[164:167], v[196:199], v[96:99]
ds_read_b64_tr_b16 a[210:211], v8 offset:53248
v_cvt_pk_bf16_f32 v191, v126, v127
v_mfma_f32_16x16x32_bf16 v[96:99], a[168:171], v[200:203], v[96:99]
v_exp_f32 v64, v64
v_mfma_f32_16x16x32_bf16 v[96:99], a[172:175], v[204:207], v[96:99]
v_mfma_f32_16x16x32_bf16 v[100:103], a[160:163], v[208:211], v[28:31]
v_exp_f32 v65, v65
v_mfma_f32_16x16x32_bf16 v[100:103], a[164:167], v[212:215], v[100:103]
ds_read_b64_tr_b16 a[212:213], v8 offset:57344
v_cvt_pk_bf16_f32 v128, v64, v65
v_mfma_f32_16x16x32_bf16 v[100:103], a[168:171], v[216:219], v[100:103]
v_exp_f32 v66, v66
v_mfma_f32_16x16x32_bf16 v[100:103], a[172:175], v[220:223], v[100:103]
ds_read_b64_tr_b16 a[214:215], v8 offset:61440
v_mfma_f32_16x16x32_bf16 v[104:107], a[160:163], v[224:227], v[32:35]
v_exp_f32 v67, v67
v_mfma_f32_16x16x32_bf16 v[104:107], a[164:167], v[228:231], v[104:107]
ds_read_b64_tr_b16 a[216:217], v9 offset:49152
v_cvt_pk_bf16_f32 v129, v66, v67
v_mfma_f32_16x16x32_bf16 v[104:107], a[168:171], v[232:235], v[104:107]
v_exp_f32 v68, v68
v_mfma_f32_16x16x32_bf16 v[104:107], a[172:175], v[236:239], v[104:107]
buffer_load_dwordx4 v18, s[16:19], s41 offen offset:2048 lds
v_mfma_f32_16x16x32_bf16 v[108:111], a[160:163], v[240:243], v[36:39]
v_exp_f32 v69, v69
v_mfma_f32_16x16x32_bf16 v[108:111], a[164:167], v[244:247], v[108:111]
ds_read_b64_tr_b16 a[218:219], v9 offset:53248
v_cvt_pk_bf16_f32 v136, v68, v69
v_mfma_f32_16x16x32_bf16 v[108:111], a[168:171], v[248:251], v[108:111]
v_exp_f32 v70, v70
v_mfma_f32_16x16x32_bf16 v[108:111], a[172:175], v[252:255], v[108:111]
ds_read_b64_tr_b16 a[220:221], v9 offset:57344
v_mfma_f32_16x16x32_bf16 v[112:115], a[176:179], v[192:195], v[24:27]
v_exp_f32 v71, v71
v_mfma_f32_16x16x32_bf16 v[112:115], a[180:183], v[196:199], v[112:115]
ds_read_b64_tr_b16 a[222:223], v9 offset:61440
v_cvt_pk_bf16_f32 v137, v70, v71
v_mfma_f32_16x16x32_bf16 v[112:115], a[184:187], v[200:203], v[112:115]
v_exp_f32 v72, v72
v_mfma_f32_16x16x32_bf16 v[112:115], a[188:191], v[204:207], v[112:115]
v_mfma_f32_16x16x32_bf16 v[116:119], a[176:179], v[208:211], v[28:31]
v_exp_f32 v73, v73
v_mfma_f32_16x16x32_bf16 v[116:119], a[180:183], v[212:215], v[116:119]
ds_read_b64_tr_b16 a[224:225], v10 offset:49152
v_cvt_pk_bf16_f32 v144, v72, v73
v_mfma_f32_16x16x32_bf16 v[116:119], a[184:187], v[216:219], v[116:119]
v_exp_f32 v74, v74
v_mfma_f32_16x16x32_bf16 v[116:119], a[188:191], v[220:223], v[116:119]
buffer_load_dwordx4 v19, s[16:19], s41 offen offset:3072 lds
v_mfma_f32_16x16x32_bf16 v[120:123], a[176:179], v[224:227], v[32:35]
v_exp_f32 v75, v75
v_mfma_f32_16x16x32_bf16 v[120:123], a[180:183], v[228:231], v[120:123]
ds_read_b64_tr_b16 a[226:227], v10 offset:53248
v_cvt_pk_bf16_f32 v145, v74, v75
v_mfma_f32_16x16x32_bf16 v[120:123], a[184:187], v[232:235], v[120:123]
v_exp_f32 v76, v76
v_mfma_f32_16x16x32_bf16 v[120:123], a[188:191], v[236:239], v[120:123]
ds_read_b64_tr_b16 a[228:229], v10 offset:57344
s_add_u32 s41, s41, 16384
v_mfma_f32_16x16x32_bf16 v[124:127], a[176:179], v[240:243], v[36:39]
v_exp_f32 v77, v77
v_mfma_f32_16x16x32_bf16 v[124:127], a[180:183], v[244:247], v[124:127]
ds_read_b64_tr_b16 a[230:231], v10 offset:61440
v_cvt_pk_bf16_f32 v152, v76, v77
v_mfma_f32_16x16x32_bf16 v[124:127], a[184:187], v[248:251], v[124:127]
v_exp_f32 v78, v78
v_mfma_f32_16x16x32_bf16 v[124:127], a[188:191], v[252:255], v[124:127]
ds_read_b64_tr_b16 a[232:233], v11 offset:49152
s_waitcnt lgkmcnt(5)
v_mfma_f32_16x16x32_bf16 a[0:3], a[192:195], v[160:163], a[0:3]
v_exp_f32 v79, v79
v_mfma_f32_16x16x32_bf16 a[0:3], a[196:199], v[164:167], a[0:3]
ds_read_b64_tr_b16 a[234:235], v11 offset:53248
v_cvt_pk_bf16_f32 v153, v78, v79
v_mfma_f32_16x16x32_bf16 a[4:7], a[192:195], v[168:171], a[4:7]
buffer_load_dword v61, v57, s[4:7], s45 offen offset:0
v_mfma_f32_16x16x32_bf16 a[4:7], a[196:199], v[172:175], a[4:7]
v_exp_f32 v80, v80
v_mfma_f32_16x16x32_bf16 a[8:11], a[192:195], v[176:179], a[8:11]
ds_read_b64_tr_b16 a[236:237], v11 offset:57344
s_add_u32 s45, s45, 1024
v_mfma_f32_16x16x32_bf16 a[8:11], a[196:199], v[180:183], a[8:11]
v_exp_f32 v81, v81
v_mfma_f32_16x16x32_bf16 a[12:15], a[192:195], v[184:187], a[12:15]
v_cvt_pk_bf16_f32 v130, v80, v81
v_mfma_f32_16x16x32_bf16 a[12:15], a[196:199], v[188:191], a[12:15]
v_exp_f32 v82, v82
v_mfma_f32_16x16x32_bf16 a[16:19], a[200:203], v[160:163], a[16:19]
ds_read_b64_tr_b16 a[238:239], v11 offset:61440
v_mfma_f32_16x16x32_bf16 a[16:19], a[204:207], v[164:167], a[16:19]
v_exp_f32 v83, v83
v_mfma_f32_16x16x32_bf16 a[20:23], a[200:203], v[168:171], a[20:23]
ds_read_b64_tr_b16 a[240:241], v12 offset:49152
v_cvt_pk_bf16_f32 v131, v82, v83
v_mfma_f32_16x16x32_bf16 a[20:23], a[204:207], v[172:175], a[20:23]
v_exp_f32 v84, v84
v_mfma_f32_16x16x32_bf16 a[24:27], a[200:203], v[176:179], a[24:27]
ds_read_b64_tr_b16 a[242:243], v12 offset:53248
v_mfma_f32_16x16x32_bf16 a[24:27], a[204:207], v[180:183], a[24:27]
v_exp_f32 v85, v85
v_mfma_f32_16x16x32_bf16 a[28:31], a[200:203], v[184:187], a[28:31]
v_cvt_pk_bf16_f32 v138, v84, v85
v_mfma_f32_16x16x32_bf16 a[28:31], a[204:207], v[188:191], a[28:31]
v_exp_f32 v86, v86
v_smfmac_f32_16x16x64_bf16 v[40:43], v[20:23], v[160:167], v62
ds_read_b64_tr_b16 a[244:245], v12 offset:57344
v_mfma_f32_16x16x32_bf16 a[32:35], a[208:211], v[160:163], a[32:35]
v_exp_f32 v87, v87
v_mfma_f32_16x16x32_bf16 a[32:35], a[212:215], v[164:167], a[32:35]
ds_read_b64_tr_b16 a[246:247], v12 offset:61440
v_cvt_pk_bf16_f32 v139, v86, v87
v_mfma_f32_16x16x32_bf16 a[36:39], a[208:211], v[168:171], a[36:39]
v_exp_f32 v88, v88
v_mfma_f32_16x16x32_bf16 a[36:39], a[212:215], v[172:175], a[36:39]
ds_read_b64_tr_b16 a[248:249], v13 offset:49152
v_mfma_f32_16x16x32_bf16 a[40:43], a[208:211], v[176:179], a[40:43]
v_exp_f32 v89, v89
v_mfma_f32_16x16x32_bf16 a[40:43], a[212:215], v[180:183], a[40:43]
v_cvt_pk_bf16_f32 v146, v88, v89
v_mfma_f32_16x16x32_bf16 a[44:47], a[208:211], v[184:187], a[44:47]
v_exp_f32 v90, v90
v_mfma_f32_16x16x32_bf16 a[44:47], a[212:215], v[188:191], a[44:47]
ds_read_b64_tr_b16 a[250:251], v13 offset:53248
v_mfma_f32_16x16x32_bf16 a[48:51], a[216:219], v[160:163], a[48:51]
v_exp_f32 v91, v91
v_mfma_f32_16x16x32_bf16 a[48:51], a[220:223], v[164:167], a[48:51]
ds_read_b64_tr_b16 a[252:253], v13 offset:57344
v_cvt_pk_bf16_f32 v147, v90, v91
v_mfma_f32_16x16x32_bf16 a[52:55], a[216:219], v[168:171], a[52:55]
v_exp_f32 v92, v92
v_mfma_f32_16x16x32_bf16 a[52:55], a[220:223], v[172:175], a[52:55]
ds_read_b64_tr_b16 a[254:255], v13 offset:61440
v_mfma_f32_16x16x32_bf16 a[56:59], a[216:219], v[176:179], a[56:59]
v_exp_f32 v93, v93
v_mfma_f32_16x16x32_bf16 a[56:59], a[220:223], v[180:183], a[56:59]
v_cvt_pk_bf16_f32 v154, v92, v93
v_mfma_f32_16x16x32_bf16 a[60:63], a[216:219], v[184:187], a[60:63]
v_exp_f32 v94, v94
v_mfma_f32_16x16x32_bf16 a[60:63], a[220:223], v[188:191], a[60:63]
v_smfmac_f32_16x16x64_bf16 v[44:47], v[20:23], v[168:175], v62
s_waitcnt lgkmcnt(0)
v_mfma_f32_16x16x32_bf16 a[64:67], a[224:227], v[160:163], a[64:67]
s_waitcnt vmcnt(10)
s_barrier
v_mfma_f32_16x16x32_bf16 a[64:67], a[228:231], v[164:167], a[64:67]
v_exp_f32 v95, v95
v_mfma_f32_16x16x32_bf16 a[68:71], a[224:227], v[168:171], a[68:71]
s_mov_b32 m0, s48
ds_read_b128 a[128:131], v2 offset:16384
v_mfma_f32_16x16x32_bf16 a[68:71], a[228:231], v[172:175], a[68:71]
v_exp_f32 v96, v96
v_mfma_f32_16x16x32_bf16 a[72:75], a[224:227], v[176:179], a[72:75]
buffer_load_dwordx4 v14, s[12:15], s41 offen offset:0 lds
v_mfma_f32_16x16x32_bf16 a[72:75], a[228:231], v[180:183], a[72:75]
v_exp_f32 v97, v97
v_mfma_f32_16x16x32_bf16 a[76:79], a[224:227], v[184:187], a[76:79]
ds_read_b128 a[132:135], v3 offset:16384
v_cvt_pk_bf16_f32 v155, v94, v95
v_mfma_f32_16x16x32_bf16 a[76:79], a[228:231], v[188:191], a[76:79]
v_exp_f32 v98, v98
v_mfma_f32_16x16x32_bf16 a[80:83], a[232:235], v[160:163], a[80:83]
ds_read_b128 a[136:139], v4 offset:16384
v_cvt_pk_bf16_f32 v132, v96, v97
v_mfma_f32_16x16x32_bf16 a[80:83], a[236:239], v[164:167], a[80:83]
v_exp_f32 v99, v99
v_mfma_f32_16x16x32_bf16 a[84:87], a[232:235], v[168:171], a[84:87]
v_exp_f32 v100, v100
v_mfma_f32_16x16x32_bf16 a[84:87], a[236:239], v[172:175], a[84:87]
ds_read_b128 a[140:143], v5 offset:16384
ds_read_b128 a[144:147], v2 offset:20480
v_mfma_f32_16x16x32_bf16 a[88:91], a[232:235], v[176:179], a[88:91]
v_exp_f32 v101, v101
v_mfma_f32_16x16x32_bf16 a[88:91], a[236:239], v[180:183], a[88:91]
v_cvt_pk_bf16_f32 v133, v98, v99
v_cvt_pk_bf16_f32 v140, v100, v101
v_mfma_f32_16x16x32_bf16 a[92:95], a[232:235], v[184:187], a[92:95]
v_exp_f32 v102, v102
v_mfma_f32_16x16x32_bf16 a[92:95], a[236:239], v[188:191], a[92:95]
ds_read_b128 a[148:151], v3 offset:20480
v_smfmac_f32_16x16x64_bf16 v[48:51], v[20:23], v[176:183], v62
buffer_load_dwordx4 v15, s[12:15], s41 offen offset:1024 lds
v_mfma_f32_16x16x32_bf16 a[96:99], a[240:243], v[160:163], a[96:99]
v_exp_f32 v103, v103
v_mfma_f32_16x16x32_bf16 a[96:99], a[244:247], v[164:167], a[96:99]
v_exp_f32 v104, v104
v_mfma_f32_16x16x32_bf16 a[100:103], a[240:243], v[168:171], a[100:103]
ds_read_b128 a[152:155], v4 offset:20480
ds_read_b128 a[156:159], v5 offset:20480
v_mfma_f32_16x16x32_bf16 a[100:103], a[244:247], v[172:175], a[100:103]
v_exp_f32 v105, v105
v_mfma_f32_16x16x32_bf16 a[104:107], a[240:243], v[176:179], a[104:107]
v_cvt_pk_bf16_f32 v141, v102, v103
v_cvt_pk_bf16_f32 v148, v104, v105
v_mfma_f32_16x16x32_bf16 a[104:107], a[244:247], v[180:183], a[104:107]
v_exp_f32 v106, v106
v_mfma_f32_16x16x32_bf16 a[108:111], a[240:243], v[184:187], a[108:111]
ds_read_b128 a[160:163], v2 offset:24576
v_mfma_f32_16x16x32_bf16 a[108:111], a[244:247], v[188:191], a[108:111]
v_exp_f32 v107, v107
v_mfma_f32_16x16x32_bf16 a[112:115], a[248:251], v[160:163], a[112:115]
ds_read_b128 a[164:167], v3 offset:24576
v_cvt_pk_bf16_f32 v149, v106, v107
v_mfma_f32_16x16x32_bf16 a[112:115], a[252:255], v[164:167], a[112:115]
v_exp_f32 v108, v108
v_mfma_f32_16x16x32_bf16 a[116:119], a[248:251], v[168:171], a[116:119]
buffer_load_dwordx4 v16, s[12:15], s41 offen offset:2048 lds
v_mfma_f32_16x16x32_bf16 a[116:119], a[252:255], v[172:175], a[116:119]
v_exp_f32 v109, v109
v_mfma_f32_16x16x32_bf16 a[120:123], a[248:251], v[176:179], a[120:123]
ds_read_b128 a[168:171], v4 offset:24576
v_cvt_pk_bf16_f32 v156, v108, v109
v_mfma_f32_16x16x32_bf16 a[120:123], a[252:255], v[180:183], a[120:123]
v_exp_f32 v110, v110
v_mfma_f32_16x16x32_bf16 a[124:127], a[248:251], v[184:187], a[124:127]
ds_read_b128 a[172:175], v5 offset:24576
v_mfma_f32_16x16x32_bf16 a[124:127], a[252:255], v[188:191], a[124:127]
v_exp_f32 v111, v111
v_smfmac_f32_16x16x64_bf16 v[52:55], v[20:23], v[184:191], v62
ds_read_b128 a[176:179], v2 offset:28672
s_waitcnt lgkmcnt(5)
v_mfma_f32_16x16x32_bf16 v[64:67], a[128:131], v[192:195], v[24:27]
v_cvt_pk_bf16_f32 v157, v110, v111
v_mfma_f32_16x16x32_bf16 v[64:67], a[132:135], v[196:199], v[64:67]
v_exp_f32 v112, v112
v_mfma_f32_16x16x32_bf16 v[64:67], a[136:139], v[200:203], v[64:67]
ds_read_b128 a[180:183], v3 offset:28672
v_mfma_f32_16x16x32_bf16 v[64:67], a[140:143], v[204:207], v[64:67]
v_exp_f32 v113, v113
v_mfma_f32_16x16x32_bf16 v[68:71], a[128:131], v[208:211], v[28:31]
ds_read_b128 a[184:187], v4 offset:28672
v_cvt_pk_bf16_f32 v134, v112, v113
v_mfma_f32_16x16x32_bf16 v[68:71], a[132:135], v[212:215], v[68:71]
v_exp_f32 v114, v114
v_mfma_f32_16x16x32_bf16 v[68:71], a[136:139], v[216:219], v[68:71]
buffer_load_dwordx4 v17, s[12:15], s41 offen offset:3072 lds
v_mfma_f32_16x16x32_bf16 v[68:71], a[140:143], v[220:223], v[68:71]
v_exp_f32 v115, v115
v_mfma_f32_16x16x32_bf16 v[72:75], a[128:131], v[224:227], v[32:35]
ds_read_b128 a[188:191], v5 offset:28672
v_cvt_pk_bf16_f32 v135, v114, v115
v_mfma_f32_16x16x32_bf16 v[72:75], a[132:135], v[228:231], v[72:75]
v_exp_f32 v116, v116
v_mfma_f32_16x16x32_bf16 v[72:75], a[136:139], v[232:235], v[72:75]
ds_read_b64_tr_b16 a[192:193], v6 offset:0
v_mfma_f32_16x16x32_bf16 v[72:75], a[140:143], v[236:239], v[72:75]
v_exp_f32 v117, v117
v_mfma_f32_16x16x32_bf16 v[76:79], a[128:131], v[240:243], v[36:39]
ds_read_b64_tr_b16 a[194:195], v6 offset:4096
v_cvt_pk_bf16_f32 v142, v116, v117
v_mfma_f32_16x16x32_bf16 v[76:79], a[132:135], v[244:247], v[76:79]
v_exp_f32 v118, v118
v_mfma_f32_16x16x32_bf16 v[76:79], a[136:139], v[248:251], v[76:79]
s_mov_b32 m0, s54
v_mfma_f32_16x16x32_bf16 v[76:79], a[140:143], v[252:255], v[76:79]
v_exp_f32 v119, v119
v_mfma_f32_16x16x32_bf16 v[80:83], a[144:147], v[192:195], v[24:27]
ds_read_b64_tr_b16 a[196:197], v6 offset:8192
v_cvt_pk_bf16_f32 v143, v118, v119
v_mfma_f32_16x16x32_bf16 v[80:83], a[148:151], v[196:199], v[80:83]
v_exp_f32 v120, v120
v_mfma_f32_16x16x32_bf16 v[80:83], a[152:155], v[200:203], v[80:83]
buffer_load_dwordx4 v18, s[16:19], s41 offen offset:0 lds
v_mfma_f32_16x16x32_bf16 v[80:83], a[156:159], v[204:207], v[80:83]
ds_read_b64_tr_b16 a[198:199], v6 offset:12288
v_mfma_f32_16x16x32_bf16 v[84:87], a[144:147], v[208:211], v[28:31]
v_exp_f32 v121, v121
v_mfma_f32_16x16x32_bf16 v[84:87], a[148:151], v[212:215], v[84:87]
v_exp_f32 v122, v122
v_mfma_f32_16x16x32_bf16 v[84:87], a[152:155], v[216:219], v[84:87]
ds_read_b64_tr_b16 a[200:201], v7 offset:0
v_cvt_pk_bf16_f32 v150, v120, v121
v_mfma_f32_16x16x32_bf16 v[84:87], a[156:159], v[220:223], v[84:87]
v_exp_f32 v123, v123
v_mfma_f32_16x16x32_bf16 v[88:91], a[144:147], v[224:227], v[32:35]
ds_read_b64_tr_b16 a[202:203], v7 offset:4096
v_cvt_pk_bf16_f32 v151, v122, v123
v_mfma_f32_16x16x32_bf16 v[88:91], a[148:151], v[228:231], v[88:91]
v_exp_f32 v124, v124
v_mfma_f32_16x16x32_bf16 v[88:91], a[152:155], v[232:235], v[88:91]
ds_read_b64_tr_b16 a[204:205], v7 offset:8192
v_mfma_f32_16x16x32_bf16 v[88:91], a[156:159], v[236:239], v[88:91]
v_exp_f32 v125, v125
v_mfma_f32_16x16x32_bf16 v[92:95], a[144:147], v[240:243], v[36:39]
ds_read_b64_tr_b16 a[206:207], v7 offset:12288
v_cvt_pk_bf16_f32 v158, v124, v125
v_mfma_f32_16x16x32_bf16 v[92:95], a[148:151], v[244:247], v[92:95]
v_exp_f32 v126, v126
v_mfma_f32_16x16x32_bf16 v[92:95], a[152:155], v[248:251], v[92:95]
buffer_load_dwordx4 v19, s[16:19], s41 offen offset:1024 lds
v_mfma_f32_16x16x32_bf16 v[92:95], a[156:159], v[252:255], v[92:95]
ds_read_b64_tr_b16 a[208:209], v8 offset:0
s_waitcnt lgkmcnt(9)
v_mfma_f32_16x16x32_bf16 v[96:99], a[160:163], v[192:195], v[24:27]
v_exp_f32 v127, v127
v_mfma_f32_16x16x32_bf16 v[96:99], a[164:167], v[196:199], v[96:99]
ds_read_b64_tr_b16 a[210:211], v8 offset:4096
v_cvt_pk_bf16_f32 v159, v126, v127
v_mfma_f32_16x16x32_bf16 v[96:99], a[168:171], v[200:203], v[96:99]
v_exp_f32 v64, v64
v_mfma_f32_16x16x32_bf16 v[96:99], a[172:175], v[204:207], v[96:99]
v_mfma_f32_16x16x32_bf16 v[100:103], a[160:163], v[208:211], v[28:31]
v_exp_f32 v65, v65
v_mfma_f32_16x16x32_bf16 v[100:103], a[164:167], v[212:215], v[100:103]
ds_read_b64_tr_b16 a[212:213], v8 offset:8192
v_cvt_pk_bf16_f32 v160, v64, v65
v_mfma_f32_16x16x32_bf16 v[100:103], a[168:171], v[216:219], v[100:103]
v_exp_f32 v66, v66
v_mfma_f32_16x16x32_bf16 v[100:103], a[172:175], v[220:223], v[100:103]
ds_read_b64_tr_b16 a[214:215], v8 offset:12288
v_mfma_f32_16x16x32_bf16 v[104:107], a[160:163], v[224:227], v[32:35]
v_exp_f32 v67, v67
v_mfma_f32_16x16x32_bf16 v[104:107], a[164:167], v[228:231], v[104:107]
ds_read_b64_tr_b16 a[216:217], v9 offset:0
v_cvt_pk_bf16_f32 v161, v66, v67
v_mfma_f32_16x16x32_bf16 v[104:107], a[168:171], v[232:235], v[104:107]
v_exp_f32 v68, v68
v_mfma_f32_16x16x32_bf16 v[104:107], a[172:175], v[236:239], v[104:107]
buffer_load_dwordx4 v18, s[16:19], s41 offen offset:2048 lds
v_mfma_f32_16x16x32_bf16 v[108:111], a[160:163], v[240:243], v[36:39]
v_exp_f32 v69, v69
v_mfma_f32_16x16x32_bf16 v[108:111], a[164:167], v[244:247], v[108:111]
ds_read_b64_tr_b16 a[218:219], v9 offset:4096
v_cvt_pk_bf16_f32 v168, v68, v69
v_mfma_f32_16x16x32_bf16 v[108:111], a[168:171], v[248:251], v[108:111]
v_exp_f32 v70, v70
v_mfma_f32_16x16x32_bf16 v[108:111], a[172:175], v[252:255], v[108:111]
ds_read_b64_tr_b16 a[220:221], v9 offset:8192
v_mfma_f32_16x16x32_bf16 v[112:115], a[176:179], v[192:195], v[24:27]
v_exp_f32 v71, v71
v_mfma_f32_16x16x32_bf16 v[112:115], a[180:183], v[196:199], v[112:115]
ds_read_b64_tr_b16 a[222:223], v9 offset:12288
v_cvt_pk_bf16_f32 v169, v70, v71
v_mfma_f32_16x16x32_bf16 v[112:115], a[184:187], v[200:203], v[112:115]
v_exp_f32 v72, v72
v_mfma_f32_16x16x32_bf16 v[112:115], a[188:191], v[204:207], v[112:115]
v_mfma_f32_16x16x32_bf16 v[116:119], a[176:179], v[208:211], v[28:31]
v_exp_f32 v73, v73
v_mfma_f32_16x16x32_bf16 v[116:119], a[180:183], v[212:215], v[116:119]
ds_read_b64_tr_b16 a[224:225], v10 offset:0
v_cvt_pk_bf16_f32 v176, v72, v73
v_mfma_f32_16x16x32_bf16 v[116:119], a[184:187], v[216:219], v[116:119]
v_exp_f32 v74, v74
v_mfma_f32_16x16x32_bf16 v[116:119], a[188:191], v[220:223], v[116:119]
buffer_load_dwordx4 v19, s[16:19], s41 offen offset:3072 lds
v_mfma_f32_16x16x32_bf16 v[120:123], a[176:179], v[224:227], v[32:35]
v_exp_f32 v75, v75
v_mfma_f32_16x16x32_bf16 v[120:123], a[180:183], v[228:231], v[120:123]
ds_read_b64_tr_b16 a[226:227], v10 offset:4096
v_cvt_pk_bf16_f32 v177, v74, v75
v_mfma_f32_16x16x32_bf16 v[120:123], a[184:187], v[232:235], v[120:123]
v_exp_f32 v76, v76
v_mfma_f32_16x16x32_bf16 v[120:123], a[188:191], v[236:239], v[120:123]
ds_read_b64_tr_b16 a[228:229], v10 offset:8192
s_add_u32 s41, s41, 16384
v_mfma_f32_16x16x32_bf16 v[124:127], a[176:179], v[240:243], v[36:39]
v_exp_f32 v77, v77
v_mfma_f32_16x16x32_bf16 v[124:127], a[180:183], v[244:247], v[124:127]
ds_read_b64_tr_b16 a[230:231], v10 offset:12288
v_cvt_pk_bf16_f32 v184, v76, v77
v_mfma_f32_16x16x32_bf16 v[124:127], a[184:187], v[248:251], v[124:127]
v_exp_f32 v78, v78
v_mfma_f32_16x16x32_bf16 v[124:127], a[188:191], v[252:255], v[124:127]
ds_read_b64_tr_b16 a[232:233], v11 offset:0
s_waitcnt lgkmcnt(5)
v_mfma_f32_16x16x32_bf16 a[0:3], a[192:195], v[128:131], a[0:3]
v_exp_f32 v79, v79
v_mfma_f32_16x16x32_bf16 a[0:3], a[196:199], v[132:135], a[0:3]
ds_read_b64_tr_b16 a[234:235], v11 offset:4096
v_cvt_pk_bf16_f32 v185, v78, v79
v_mfma_f32_16x16x32_bf16 a[4:7], a[192:195], v[136:139], a[4:7]
v_mfma_f32_16x16x32_bf16 a[4:7], a[196:199], v[140:143], a[4:7]
v_exp_f32 v80, v80
v_mfma_f32_16x16x32_bf16 a[8:11], a[192:195], v[144:147], a[8:11]
ds_read_b64_tr_b16 a[236:237], v11 offset:8192
v_mfma_f32_16x16x32_bf16 a[8:11], a[196:199], v[148:151], a[8:11]
v_exp_f32 v81, v81
v_mfma_f32_16x16x32_bf16 a[12:15], a[192:195], v[152:155], a[12:15]
v_cvt_pk_bf16_f32 v162, v80, v81
v_mfma_f32_16x16x32_bf16 a[12:15], a[196:199], v[156:159], a[12:15]
v_exp_f32 v82, v82
v_mfma_f32_16x16x32_bf16 a[16:19], a[200:203], v[128:131], a[16:19]
ds_read_b64_tr_b16 a[238:239], v11 offset:12288
v_mfma_f32_16x16x32_bf16 a[16:19], a[204:207], v[132:135], a[16:19]
v_exp_f32 v83, v83
v_mfma_f32_16x16x32_bf16 a[20:23], a[200:203], v[136:139], a[20:23]
ds_read_b64_tr_b16 a[240:241], v12 offset:0
v_cvt_pk_bf16_f32 v163, v82, v83
v_mfma_f32_16x16x32_bf16 a[20:23], a[204:207], v[140:143], a[20:23]
v_exp_f32 v84, v84
v_mfma_f32_16x16x32_bf16 a[24:27], a[200:203], v[144:147], a[24:27]
ds_read_b64_tr_b16 a[242:243], v12 offset:4096
v_mfma_f32_16x16x32_bf16 a[24:27], a[204:207], v[148:151], a[24:27]
v_exp_f32 v85, v85
v_mfma_f32_16x16x32_bf16 a[28:31], a[200:203], v[152:155], a[28:31]
v_cvt_pk_bf16_f32 v170, v84, v85
v_mfma_f32_16x16x32_bf16 a[28:31], a[204:207], v[156:159], a[28:31]
v_exp_f32 v86, v86
v_smfmac_f32_16x16x64_bf16 v[40:43], v[20:23], v[128:135], v62
ds_read_b64_tr_b16 a[244:245], v12 offset:8192
v_mfma_f32_16x16x32_bf16 a[32:35], a[208:211], v[128:131], a[32:35]
v_exp_f32 v87, v87
v_mfma_f32_16x16x32_bf16 a[32:35], a[212:215], v[132:135], a[32:35]
ds_read_b64_tr_b16 a[246:247], v12 offset:12288
v_cvt_pk_bf16_f32 v171, v86, v87
v_mfma_f32_16x16x32_bf16 a[36:39], a[208:211], v[136:139], a[36:39]
v_exp_f32 v88, v88
v_mfma_f32_16x16x32_bf16 a[36:39], a[212:215], v[140:143], a[36:39]
ds_read_b64_tr_b16 a[248:249], v13 offset:0
v_mfma_f32_16x16x32_bf16 a[40:43], a[208:211], v[144:147], a[40:43]
v_exp_f32 v89, v89
v_mfma_f32_16x16x32_bf16 a[40:43], a[212:215], v[148:151], a[40:43]
v_cvt_pk_bf16_f32 v178, v88, v89
v_mfma_f32_16x16x32_bf16 a[44:47], a[208:211], v[152:155], a[44:47]
v_exp_f32 v90, v90
v_mfma_f32_16x16x32_bf16 a[44:47], a[212:215], v[156:159], a[44:47]
ds_read_b64_tr_b16 a[250:251], v13 offset:4096
v_mfma_f32_16x16x32_bf16 a[48:51], a[216:219], v[128:131], a[48:51]
v_exp_f32 v91, v91
v_mfma_f32_16x16x32_bf16 a[48:51], a[220:223], v[132:135], a[48:51]
ds_read_b64_tr_b16 a[252:253], v13 offset:8192
v_cvt_pk_bf16_f32 v179, v90, v91
v_mfma_f32_16x16x32_bf16 a[52:55], a[216:219], v[136:139], a[52:55]
v_exp_f32 v92, v92
v_mfma_f32_16x16x32_bf16 a[52:55], a[220:223], v[140:143], a[52:55]
ds_read_b64_tr_b16 a[254:255], v13 offset:12288
v_mfma_f32_16x16x32_bf16 a[56:59], a[216:219], v[144:147], a[56:59]
v_exp_f32 v93, v93
v_mfma_f32_16x16x32_bf16 a[56:59], a[220:223], v[148:151], a[56:59]
v_cvt_pk_bf16_f32 v186, v92, v93
v_mfma_f32_16x16x32_bf16 a[60:63], a[216:219], v[152:155], a[60:63]
v_exp_f32 v94, v94
v_mfma_f32_16x16x32_bf16 a[60:63], a[220:223], v[156:159], a[60:63]
v_smfmac_f32_16x16x64_bf16 v[44:47], v[20:23], v[136:143], v62
s_waitcnt lgkmcnt(0)
v_mfma_f32_16x16x32_bf16 a[64:67], a[224:227], v[128:131], a[64:67]
s_waitcnt vmcnt(9)
s_barrier
v_mfma_f32_16x16x32_bf16 a[64:67], a[228:231], v[132:135], a[64:67]
v_exp_f32 v95, v95
v_mfma_f32_16x16x32_bf16 a[68:71], a[224:227], v[136:139], a[68:71]
s_mov_b32 m0, s49
ds_read_b128 a[128:131], v2 offset:32768
v_mfma_f32_16x16x32_bf16 a[68:71], a[228:231], v[140:143], a[68:71]
v_exp_f32 v96, v96
v_mfma_f32_16x16x32_bf16 a[72:75], a[224:227], v[144:147], a[72:75]
buffer_load_dwordx4 v14, s[12:15], s41 offen offset:0 lds
v_mfma_f32_16x16x32_bf16 a[72:75], a[228:231], v[148:151], a[72:75]
v_exp_f32 v97, v97
v_mfma_f32_16x16x32_bf16 a[76:79], a[224:227], v[152:155], a[76:79]
ds_read_b128 a[132:135], v3 offset:32768
v_cvt_pk_bf16_f32 v187, v94, v95
v_mfma_f32_16x16x32_bf16 a[76:79], a[228:231], v[156:159], a[76:79]
v_exp_f32 v98, v98
v_mfma_f32_16x16x32_bf16 a[80:83], a[232:235], v[128:131], a[80:83]
ds_read_b128 a[136:139], v4 offset:32768
v_cvt_pk_bf16_f32 v164, v96, v97
v_mfma_f32_16x16x32_bf16 a[80:83], a[236:239], v[132:135], a[80:83]
v_exp_f32 v99, v99
v_mfma_f32_16x16x32_bf16 a[84:87], a[232:235], v[136:139], a[84:87]
v_exp_f32 v100, v100
v_mfma_f32_16x16x32_bf16 a[84:87], a[236:239], v[140:143], a[84:87]
ds_read_b128 a[140:143], v5 offset:32768
ds_read_b128 a[144:147], v2 offset:36864
v_mfma_f32_16x16x32_bf16 a[88:91], a[232:235], v[144:147], a[88:91]
v_exp_f32 v101, v101
v_mfma_f32_16x16x32_bf16 a[88:91], a[236:239], v[148:151], a[88:91]
v_cvt_pk_bf16_f32 v165, v98, v99
v_cvt_pk_bf16_f32 v172, v100, v101
v_mfma_f32_16x16x32_bf16 a[92:95], a[232:235], v[152:155], a[92:95]
v_exp_f32 v102, v102
v_mfma_f32_16x16x32_bf16 a[92:95], a[236:239], v[156:159], a[92:95]
ds_read_b128 a[148:151], v3 offset:36864
v_smfmac_f32_16x16x64_bf16 v[48:51], v[20:23], v[144:151], v62
buffer_load_dwordx4 v15, s[12:15], s41 offen offset:1024 lds
v_mfma_f32_16x16x32_bf16 a[96:99], a[240:243], v[128:131], a[96:99]
v_exp_f32 v103, v103
v_mfma_f32_16x16x32_bf16 a[96:99], a[244:247], v[132:135], a[96:99]
v_exp_f32 v104, v104
v_mfma_f32_16x16x32_bf16 a[100:103], a[240:243], v[136:139], a[100:103]
ds_read_b128 a[152:155], v4 offset:36864
ds_read_b128 a[156:159], v5 offset:36864
v_mfma_f32_16x16x32_bf16 a[100:103], a[244:247], v[140:143], a[100:103]
v_exp_f32 v105, v105
v_mfma_f32_16x16x32_bf16 a[104:107], a[240:243], v[144:147], a[104:107]
v_cvt_pk_bf16_f32 v173, v102, v103
v_cvt_pk_bf16_f32 v180, v104, v105
v_mfma_f32_16x16x32_bf16 a[104:107], a[244:247], v[148:151], a[104:107]
v_exp_f32 v106, v106
v_mfma_f32_16x16x32_bf16 a[108:111], a[240:243], v[152:155], a[108:111]
ds_read_b128 a[160:163], v2 offset:40960
v_mfma_f32_16x16x32_bf16 a[108:111], a[244:247], v[156:159], a[108:111]
v_exp_f32 v107, v107
v_mfma_f32_16x16x32_bf16 a[112:115], a[248:251], v[128:131], a[112:115]
ds_read_b128 a[164:167], v3 offset:40960
v_cvt_pk_bf16_f32 v181, v106, v107
v_mfma_f32_16x16x32_bf16 a[112:115], a[252:255], v[132:135], a[112:115]
v_exp_f32 v108, v108
v_mfma_f32_16x16x32_bf16 a[116:119], a[248:251], v[136:139], a[116:119]
buffer_load_dwordx4 v16, s[12:15], s41 offen offset:2048 lds
v_mfma_f32_16x16x32_bf16 a[116:119], a[252:255], v[140:143], a[116:119]
v_exp_f32 v109, v109
v_mfma_f32_16x16x32_bf16 a[120:123], a[248:251], v[144:147], a[120:123]
ds_read_b128 a[168:171], v4 offset:40960
v_cvt_pk_bf16_f32 v188, v108, v109
v_mfma_f32_16x16x32_bf16 a[120:123], a[252:255], v[148:151], a[120:123]
v_exp_f32 v110, v110
v_mfma_f32_16x16x32_bf16 a[124:127], a[248:251], v[152:155], a[124:127]
ds_read_b128 a[172:175], v5 offset:40960
v_mfma_f32_16x16x32_bf16 a[124:127], a[252:255], v[156:159], a[124:127]
v_exp_f32 v111, v111
v_smfmac_f32_16x16x64_bf16 v[52:55], v[20:23], v[152:159], v62
ds_read_b128 a[176:179], v2 offset:45056
s_waitcnt lgkmcnt(5)
v_mfma_f32_16x16x32_bf16 v[64:67], a[128:131], v[192:195], v[24:27]
v_cvt_pk_bf16_f32 v189, v110, v111
v_mfma_f32_16x16x32_bf16 v[64:67], a[132:135], v[196:199], v[64:67]
v_exp_f32 v112, v112
v_mfma_f32_16x16x32_bf16 v[64:67], a[136:139], v[200:203], v[64:67]
ds_read_b128 a[180:183], v3 offset:45056
v_mfma_f32_16x16x32_bf16 v[64:67], a[140:143], v[204:207], v[64:67]
v_exp_f32 v113, v113
v_mfma_f32_16x16x32_bf16 v[68:71], a[128:131], v[208:211], v[28:31]
ds_read_b128 a[184:187], v4 offset:45056
v_cvt_pk_bf16_f32 v166, v112, v113
v_mfma_f32_16x16x32_bf16 v[68:71], a[132:135], v[212:215], v[68:71]
v_exp_f32 v114, v114
v_mfma_f32_16x16x32_bf16 v[68:71], a[136:139], v[216:219], v[68:71]
buffer_load_dwordx4 v17, s[12:15], s41 offen offset:3072 lds
v_mfma_f32_16x16x32_bf16 v[68:71], a[140:143], v[220:223], v[68:71]
v_exp_f32 v115, v115
v_mfma_f32_16x16x32_bf16 v[72:75], a[128:131], v[224:227], v[32:35]
ds_read_b128 a[188:191], v5 offset:45056
v_cvt_pk_bf16_f32 v167, v114, v115
v_mfma_f32_16x16x32_bf16 v[72:75], a[132:135], v[228:231], v[72:75]
v_exp_f32 v116, v116
v_mfma_f32_16x16x32_bf16 v[72:75], a[136:139], v[232:235], v[72:75]
ds_read_b64_tr_b16 a[192:193], v6 offset:16384
v_mfma_f32_16x16x32_bf16 v[72:75], a[140:143], v[236:239], v[72:75]
v_exp_f32 v117, v117
v_mfma_f32_16x16x32_bf16 v[76:79], a[128:131], v[240:243], v[36:39]
ds_read_b64_tr_b16 a[194:195], v6 offset:20480
v_cvt_pk_bf16_f32 v174, v116, v117
v_mfma_f32_16x16x32_bf16 v[76:79], a[132:135], v[244:247], v[76:79]
v_exp_f32 v118, v118
v_mfma_f32_16x16x32_bf16 v[76:79], a[136:139], v[248:251], v[76:79]
s_mov_b32 m0, s55
v_mfma_f32_16x16x32_bf16 v[76:79], a[140:143], v[252:255], v[76:79]
v_exp_f32 v119, v119
v_mfma_f32_16x16x32_bf16 v[80:83], a[144:147], v[192:195], v[24:27]
ds_read_b64_tr_b16 a[196:197], v6 offset:24576
v_cvt_pk_bf16_f32 v175, v118, v119
v_mfma_f32_16x16x32_bf16 v[80:83], a[148:151], v[196:199], v[80:83]
v_exp_f32 v120, v120
v_mfma_f32_16x16x32_bf16 v[80:83], a[152:155], v[200:203], v[80:83]
buffer_load_dwordx4 v18, s[16:19], s41 offen offset:0 lds
v_mfma_f32_16x16x32_bf16 v[80:83], a[156:159], v[204:207], v[80:83]
ds_read_b64_tr_b16 a[198:199], v6 offset:28672
v_mfma_f32_16x16x32_bf16 v[84:87], a[144:147], v[208:211], v[28:31]
v_exp_f32 v121, v121
v_mfma_f32_16x16x32_bf16 v[84:87], a[148:151], v[212:215], v[84:87]
v_exp_f32 v122, v122
v_mfma_f32_16x16x32_bf16 v[84:87], a[152:155], v[216:219], v[84:87]
ds_read_b64_tr_b16 a[200:201], v7 offset:16384
v_cvt_pk_bf16_f32 v182, v120, v121
v_mfma_f32_16x16x32_bf16 v[84:87], a[156:159], v[220:223], v[84:87]
v_exp_f32 v123, v123
v_mfma_f32_16x16x32_bf16 v[88:91], a[144:147], v[224:227], v[32:35]
ds_read_b64_tr_b16 a[202:203], v7 offset:20480
v_cvt_pk_bf16_f32 v183, v122, v123
v_mfma_f32_16x16x32_bf16 v[88:91], a[148:151], v[228:231], v[88:91]
v_exp_f32 v124, v124
v_mfma_f32_16x16x32_bf16 v[88:91], a[152:155], v[232:235], v[88:91]
ds_read_b64_tr_b16 a[204:205], v7 offset:24576
v_mfma_f32_16x16x32_bf16 v[88:91], a[156:159], v[236:239], v[88:91]
v_exp_f32 v125, v125
v_mfma_f32_16x16x32_bf16 v[92:95], a[144:147], v[240:243], v[36:39]
ds_read_b64_tr_b16 a[206:207], v7 offset:28672
v_cvt_pk_bf16_f32 v190, v124, v125
v_mfma_f32_16x16x32_bf16 v[92:95], a[148:151], v[244:247], v[92:95]
v_exp_f32 v126, v126
v_mfma_f32_16x16x32_bf16 v[92:95], a[152:155], v[248:251], v[92:95]
buffer_load_dwordx4 v19, s[16:19], s41 offen offset:1024 lds
v_mfma_f32_16x16x32_bf16 v[92:95], a[156:159], v[252:255], v[92:95]
ds_read_b64_tr_b16 a[208:209], v8 offset:16384
s_waitcnt lgkmcnt(9)
v_mfma_f32_16x16x32_bf16 v[96:99], a[160:163], v[192:195], v[24:27]
v_exp_f32 v127, v127
v_mfma_f32_16x16x32_bf16 v[96:99], a[164:167], v[196:199], v[96:99]
ds_read_b64_tr_b16 a[210:211], v8 offset:20480
v_cvt_pk_bf16_f32 v191, v126, v127
v_mfma_f32_16x16x32_bf16 v[96:99], a[168:171], v[200:203], v[96:99]
v_exp_f32 v64, v64
v_mfma_f32_16x16x32_bf16 v[96:99], a[172:175], v[204:207], v[96:99]
v_mfma_f32_16x16x32_bf16 v[100:103], a[160:163], v[208:211], v[28:31]
v_exp_f32 v65, v65
v_mfma_f32_16x16x32_bf16 v[100:103], a[164:167], v[212:215], v[100:103]
ds_read_b64_tr_b16 a[212:213], v8 offset:24576
v_cvt_pk_bf16_f32 v128, v64, v65
v_mfma_f32_16x16x32_bf16 v[100:103], a[168:171], v[216:219], v[100:103]
v_exp_f32 v66, v66
v_mfma_f32_16x16x32_bf16 v[100:103], a[172:175], v[220:223], v[100:103]
ds_read_b64_tr_b16 a[214:215], v8 offset:28672
v_mfma_f32_16x16x32_bf16 v[104:107], a[160:163], v[224:227], v[32:35]
v_exp_f32 v67, v67
v_mfma_f32_16x16x32_bf16 v[104:107], a[164:167], v[228:231], v[104:107]
ds_read_b64_tr_b16 a[216:217], v9 offset:16384
v_cvt_pk_bf16_f32 v129, v66, v67
v_mfma_f32_16x16x32_bf16 v[104:107], a[168:171], v[232:235], v[104:107]
v_exp_f32 v68, v68
v_mfma_f32_16x16x32_bf16 v[104:107], a[172:175], v[236:239], v[104:107]
buffer_load_dwordx4 v18, s[16:19], s41 offen offset:2048 lds
v_mfma_f32_16x16x32_bf16 v[108:111], a[160:163], v[240:243], v[36:39]
v_exp_f32 v69, v69
v_mfma_f32_16x16x32_bf16 v[108:111], a[164:167], v[244:247], v[108:111]
ds_read_b64_tr_b16 a[218:219], v9 offset:20480
v_cvt_pk_bf16_f32 v136, v68, v69
v_mfma_f32_16x16x32_bf16 v[108:111], a[168:171], v[248:251], v[108:111]
v_exp_f32 v70, v70
v_mfma_f32_16x16x32_bf16 v[108:111], a[172:175], v[252:255], v[108:111]
ds_read_b64_tr_b16 a[220:221], v9 offset:24576
v_mfma_f32_16x16x32_bf16 v[112:115], a[176:179], v[192:195], v[24:27]
v_exp_f32 v71, v71
v_mfma_f32_16x16x32_bf16 v[112:115], a[180:183], v[196:199], v[112:115]
ds_read_b64_tr_b16 a[222:223], v9 offset:28672
v_cvt_pk_bf16_f32 v137, v70, v71
v_mfma_f32_16x16x32_bf16 v[112:115], a[184:187], v[200:203], v[112:115]
v_exp_f32 v72, v72
v_mfma_f32_16x16x32_bf16 v[112:115], a[188:191], v[204:207], v[112:115]
v_mfma_f32_16x16x32_bf16 v[116:119], a[176:179], v[208:211], v[28:31]
v_exp_f32 v73, v73
v_mfma_f32_16x16x32_bf16 v[116:119], a[180:183], v[212:215], v[116:119]
ds_read_b64_tr_b16 a[224:225], v10 offset:16384
v_cvt_pk_bf16_f32 v144, v72, v73
v_mfma_f32_16x16x32_bf16 v[116:119], a[184:187], v[216:219], v[116:119]
v_exp_f32 v74, v74
v_mfma_f32_16x16x32_bf16 v[116:119], a[188:191], v[220:223], v[116:119]
buffer_load_dwordx4 v19, s[16:19], s41 offen offset:3072 lds
v_mfma_f32_16x16x32_bf16 v[120:123], a[176:179], v[224:227], v[32:35]
v_exp_f32 v75, v75
v_mfma_f32_16x16x32_bf16 v[120:123], a[180:183], v[228:231], v[120:123]
ds_read_b64_tr_b16 a[226:227], v10 offset:20480
v_cvt_pk_bf16_f32 v145, v74, v75
v_mfma_f32_16x16x32_bf16 v[120:123], a[184:187], v[232:235], v[120:123]
v_exp_f32 v76, v76
v_mfma_f32_16x16x32_bf16 v[120:123], a[188:191], v[236:239], v[120:123]
ds_read_b64_tr_b16 a[228:229], v10 offset:24576
s_add_u32 s41, s41, 16384
v_mfma_f32_16x16x32_bf16 v[124:127], a[176:179], v[240:243], v[36:39]
v_exp_f32 v77, v77
v_mfma_f32_16x16x32_bf16 v[124:127], a[180:183], v[244:247], v[124:127]
ds_read_b64_tr_b16 a[230:231], v10 offset:28672
v_cvt_pk_bf16_f32 v152, v76, v77
v_mfma_f32_16x16x32_bf16 v[124:127], a[184:187], v[248:251], v[124:127]
v_exp_f32 v78, v78
v_mfma_f32_16x16x32_bf16 v[124:127], a[188:191], v[252:255], v[124:127]
ds_read_b64_tr_b16 a[232:233], v11 offset:16384
s_waitcnt lgkmcnt(5)
v_mfma_f32_16x16x32_bf16 a[0:3], a[192:195], v[160:163], a[0:3]
v_exp_f32 v79, v79
v_mfma_f32_16x16x32_bf16 a[0:3], a[196:199], v[164:167], a[0:3]
ds_read_b64_tr_b16 a[234:235], v11 offset:20480
v_cvt_pk_bf16_f32 v153, v78, v79
v_mfma_f32_16x16x32_bf16 a[4:7], a[192:195], v[168:171], a[4:7]
v_mfma_f32_16x16x32_bf16 a[4:7], a[196:199], v[172:175], a[4:7]
v_exp_f32 v80, v80
v_mfma_f32_16x16x32_bf16 a[8:11], a[192:195], v[176:179], a[8:11]
ds_read_b64_tr_b16 a[236:237], v11 offset:24576
v_mfma_f32_16x16x32_bf16 a[8:11], a[196:199], v[180:183], a[8:11]
v_exp_f32 v81, v81
v_mfma_f32_16x16x32_bf16 a[12:15], a[192:195], v[184:187], a[12:15]
v_cvt_pk_bf16_f32 v130, v80, v81
v_mfma_f32_16x16x32_bf16 a[12:15], a[196:199], v[188:191], a[12:15]
v_exp_f32 v82, v82
v_mfma_f32_16x16x32_bf16 a[16:19], a[200:203], v[160:163], a[16:19]
ds_read_b64_tr_b16 a[238:239], v11 offset:28672
v_mfma_f32_16x16x32_bf16 a[16:19], a[204:207], v[164:167], a[16:19]
v_exp_f32 v83, v83
v_mfma_f32_16x16x32_bf16 a[20:23], a[200:203], v[168:171], a[20:23]
ds_read_b64_tr_b16 a[240:241], v12 offset:16384
v_cvt_pk_bf16_f32 v131, v82, v83
v_mfma_f32_16x16x32_bf16 a[20:23], a[204:207], v[172:175], a[20:23]
v_exp_f32 v84, v84
v_mfma_f32_16x16x32_bf16 a[24:27], a[200:203], v[176:179], a[24:27]
ds_read_b64_tr_b16 a[242:243], v12 offset:20480
v_mfma_f32_16x16x32_bf16 a[24:27], a[204:207], v[180:183], a[24:27]
v_exp_f32 v85, v85
v_mfma_f32_16x16x32_bf16 a[28:31], a[200:203], v[184:187], a[28:31]
v_cvt_pk_bf16_f32 v138, v84, v85
v_mfma_f32_16x16x32_bf16 a[28:31], a[204:207], v[188:191], a[28:31]
v_exp_f32 v86, v86
v_smfmac_f32_16x16x64_bf16 v[40:43], v[20:23], v[160:167], v62
ds_read_b64_tr_b16 a[244:245], v12 offset:24576
v_mfma_f32_16x16x32_bf16 a[32:35], a[208:211], v[160:163], a[32:35]
v_exp_f32 v87, v87
v_mfma_f32_16x16x32_bf16 a[32:35], a[212:215], v[164:167], a[32:35]
ds_read_b64_tr_b16 a[246:247], v12 offset:28672
v_cvt_pk_bf16_f32 v139, v86, v87
v_mfma_f32_16x16x32_bf16 a[36:39], a[208:211], v[168:171], a[36:39]
v_exp_f32 v88, v88
v_mfma_f32_16x16x32_bf16 a[36:39], a[212:215], v[172:175], a[36:39]
ds_read_b64_tr_b16 a[248:249], v13 offset:16384
v_mfma_f32_16x16x32_bf16 a[40:43], a[208:211], v[176:179], a[40:43]
v_exp_f32 v89, v89
v_mfma_f32_16x16x32_bf16 a[40:43], a[212:215], v[180:183], a[40:43]
v_cvt_pk_bf16_f32 v146, v88, v89
v_mfma_f32_16x16x32_bf16 a[44:47], a[208:211], v[184:187], a[44:47]
v_exp_f32 v90, v90
v_mfma_f32_16x16x32_bf16 a[44:47], a[212:215], v[188:191], a[44:47]
ds_read_b64_tr_b16 a[250:251], v13 offset:20480
v_mfma_f32_16x16x32_bf16 a[48:51], a[216:219], v[160:163], a[48:51]
v_exp_f32 v91, v91
v_mfma_f32_16x16x32_bf16 a[48:51], a[220:223], v[164:167], a[48:51]
ds_read_b64_tr_b16 a[252:253], v13 offset:24576
v_cvt_pk_bf16_f32 v147, v90, v91
v_mfma_f32_16x16x32_bf16 a[52:55], a[216:219], v[168:171], a[52:55]
v_exp_f32 v92, v92
v_mfma_f32_16x16x32_bf16 a[52:55], a[220:223], v[172:175], a[52:55]
ds_read_b64_tr_b16 a[254:255], v13 offset:28672
v_mfma_f32_16x16x32_bf16 a[56:59], a[216:219], v[176:179], a[56:59]
v_exp_f32 v93, v93
v_mfma_f32_16x16x32_bf16 a[56:59], a[220:223], v[180:183], a[56:59]
v_cvt_pk_bf16_f32 v154, v92, v93
v_mfma_f32_16x16x32_bf16 a[60:63], a[216:219], v[184:187], a[60:63]
v_exp_f32 v94, v94
v_mfma_f32_16x16x32_bf16 a[60:63], a[220:223], v[188:191], a[60:63]
v_smfmac_f32_16x16x64_bf16 v[44:47], v[20:23], v[168:175], v62
s_waitcnt lgkmcnt(0)
v_mfma_f32_16x16x32_bf16 a[64:67], a[224:227], v[160:163], a[64:67]
s_waitcnt vmcnt(8)
s_barrier
v_mfma_f32_16x16x32_bf16 a[64:67], a[228:231], v[164:167], a[64:67]
v_exp_f32 v95, v95
v_mfma_f32_16x16x32_bf16 a[68:71], a[224:227], v[168:171], a[68:71]
s_mov_b32 m0, s50
ds_read_b128 a[128:131], v2 offset:49152
v_mfma_f32_16x16x32_bf16 a[68:71], a[228:231], v[172:175], a[68:71]
v_exp_f32 v96, v96
v_mfma_f32_16x16x32_bf16 a[72:75], a[224:227], v[176:179], a[72:75]
buffer_load_dwordx4 v14, s[12:15], s41 offen offset:0 lds
v_mfma_f32_16x16x32_bf16 a[72:75], a[228:231], v[180:183], a[72:75]
v_exp_f32 v97, v97
v_mfma_f32_16x16x32_bf16 a[76:79], a[224:227], v[184:187], a[76:79]
ds_read_b128 a[132:135], v3 offset:49152
v_cvt_pk_bf16_f32 v155, v94, v95
v_mfma_f32_16x16x32_bf16 a[76:79], a[228:231], v[188:191], a[76:79]
v_exp_f32 v98, v98
v_mfma_f32_16x16x32_bf16 a[80:83], a[232:235], v[160:163], a[80:83]
ds_read_b128 a[136:139], v4 offset:49152
v_cvt_pk_bf16_f32 v132, v96, v97
v_mfma_f32_16x16x32_bf16 a[80:83], a[236:239], v[164:167], a[80:83]
v_exp_f32 v99, v99
v_mfma_f32_16x16x32_bf16 a[84:87], a[232:235], v[168:171], a[84:87]
v_exp_f32 v100, v100
v_mfma_f32_16x16x32_bf16 a[84:87], a[236:239], v[172:175], a[84:87]
ds_read_b128 a[140:143], v5 offset:49152
ds_read_b128 a[144:147], v2 offset:53248
v_mfma_f32_16x16x32_bf16 a[88:91], a[232:235], v[176:179], a[88:91]
v_exp_f32 v101, v101
v_mfma_f32_16x16x32_bf16 a[88:91], a[236:239], v[180:183], a[88:91]
v_cvt_pk_bf16_f32 v133, v98, v99
v_cvt_pk_bf16_f32 v140, v100, v101
v_mfma_f32_16x16x32_bf16 a[92:95], a[232:235], v[184:187], a[92:95]
v_exp_f32 v102, v102
v_mfma_f32_16x16x32_bf16 a[92:95], a[236:239], v[188:191], a[92:95]
ds_read_b128 a[148:151], v3 offset:53248
v_smfmac_f32_16x16x64_bf16 v[48:51], v[20:23], v[176:183], v62
buffer_load_dwordx4 v15, s[12:15], s41 offen offset:1024 lds
v_mfma_f32_16x16x32_bf16 a[96:99], a[240:243], v[160:163], a[96:99]
v_exp_f32 v103, v103
v_mfma_f32_16x16x32_bf16 a[96:99], a[244:247], v[164:167], a[96:99]
v_exp_f32 v104, v104
v_mfma_f32_16x16x32_bf16 a[100:103], a[240:243], v[168:171], a[100:103]
ds_read_b128 a[152:155], v4 offset:53248
ds_read_b128 a[156:159], v5 offset:53248
v_mfma_f32_16x16x32_bf16 a[100:103], a[244:247], v[172:175], a[100:103]
v_exp_f32 v105, v105
v_mfma_f32_16x16x32_bf16 a[104:107], a[240:243], v[176:179], a[104:107]
v_cvt_pk_bf16_f32 v141, v102, v103
v_cvt_pk_bf16_f32 v148, v104, v105
v_mfma_f32_16x16x32_bf16 a[104:107], a[244:247], v[180:183], a[104:107]
v_exp_f32 v106, v106
v_mfma_f32_16x16x32_bf16 a[108:111], a[240:243], v[184:187], a[108:111]
ds_read_b128 a[160:163], v2 offset:57344
v_mfma_f32_16x16x32_bf16 a[108:111], a[244:247], v[188:191], a[108:111]
v_exp_f32 v107, v107
v_mfma_f32_16x16x32_bf16 a[112:115], a[248:251], v[160:163], a[112:115]
ds_read_b128 a[164:167], v3 offset:57344
v_cvt_pk_bf16_f32 v149, v106, v107
v_mfma_f32_16x16x32_bf16 a[112:115], a[252:255], v[164:167], a[112:115]
v_exp_f32 v108, v108
v_mfma_f32_16x16x32_bf16 a[116:119], a[248:251], v[168:171], a[116:119]
buffer_load_dwordx4 v16, s[12:15], s41 offen offset:2048 lds
v_mfma_f32_16x16x32_bf16 a[116:119], a[252:255], v[172:175], a[116:119]
v_exp_f32 v109, v109
v_mfma_f32_16x16x32_bf16 a[120:123], a[248:251], v[176:179], a[120:123]
ds_read_b128 a[168:171], v4 offset:57344
v_cvt_pk_bf16_f32 v156, v108, v109
v_mfma_f32_16x16x32_bf16 a[120:123], a[252:255], v[180:183], a[120:123]
v_exp_f32 v110, v110
v_mfma_f32_16x16x32_bf16 a[124:127], a[248:251], v[184:187], a[124:127]
ds_read_b128 a[172:175], v5 offset:57344
v_mfma_f32_16x16x32_bf16 a[124:127], a[252:255], v[188:191], a[124:127]
v_exp_f32 v111, v111
v_smfmac_f32_16x16x64_bf16 v[52:55], v[20:23], v[184:191], v62
ds_read_b128 a[176:179], v2 offset:61440
s_cmp_lt_u32 s41, 524288
s_cbranch_scc1 L_at_loop
s_waitcnt lgkmcnt(5)
v_mfma_f32_16x16x32_bf16 v[64:67], a[128:131], v[192:195], v[24:27]
v_cvt_pk_bf16_f32 v157, v110, v111
s_getpc_b64 s[92:93]
L_pc_a:
v_mfma_f32_16x16x32_bf16 v[64:67], a[132:135], v[196:199], v[64:67]
v_exp_f32 v112, v112
v_mfma_f32_16x16x32_bf16 v[64:67], a[136:139], v[200:203], v[64:67]
ds_read_b128 a[180:183], v3 offset:61440
s_lshr_b32 s94, s2, 3
v_mfma_f32_16x16x32_bf16 v[64:67], a[140:143], v[204:207], v[64:67]
v_exp_f32 v113, v113
v_mfma_f32_16x16x32_bf16 v[68:71], a[128:131], v[208:211], v[28:31]
ds_read_b128 a[184:187], v4 offset:61440
v_cvt_pk_bf16_f32 v134, v112, v113
v_mfma_f32_16x16x32_bf16 v[68:71], a[132:135], v[212:215], v[68:71]
v_exp_f32 v114, v114
v_mfma_f32_16x16x32_bf16 v[68:71], a[136:139], v[216:219], v[68:71]
buffer_load_dwordx4 v17, s[12:15], s41 offen offset:3072 lds
v_mfma_f32_16x16x32_bf16 v[68:71], a[140:143], v[220:223], v[68:71]
v_exp_f32 v115, v115
v_mfma_f32_16x16x32_bf16 v[72:75], a[128:131], v[224:227], v[32:35]
ds_read_b128 a[188:191], v5 offset:61440
v_cvt_pk_bf16_f32 v135, v114, v115
v_mfma_f32_16x16x32_bf16 v[72:75], a[132:135], v[228:231], v[72:75]
v_exp_f32 v116, v116
v_mfma_f32_16x16x32_bf16 v[72:75], a[136:139], v[232:235], v[72:75]
ds_read_b64_tr_b16 a[192:193], v6 offset:32768
s_lshl_b32 s94, s94, 2
v_mfma_f32_16x16x32_bf16 v[72:75], a[140:143], v[236:239], v[72:75]
v_exp_f32 v117, v117
v_mfma_f32_16x16x32_bf16 v[76:79], a[128:131], v[240:243], v[36:39]
ds_read_b64_tr_b16 a[194:195], v6 offset:36864
v_cvt_pk_bf16_f32 v142, v116, v117
v_mfma_f32_16x16x32_bf16 v[76:79], a[132:135], v[244:247], v[76:79]
v_exp_f32 v118, v118
s_add_u32 s94, s94, s40
v_mfma_f32_16x16x32_bf16 v[76:79], a[136:139], v[248:251], v[76:79]
s_mov_b32 m0, s52
s_lshl_b32 s94, s94, 9
v_mfma_f32_16x16x32_bf16 v[76:79], a[140:143], v[252:255], v[76:79]
v_exp_f32 v119, v119
v_and_b32 v58, 0x30, v1
v_mfma_f32_16x16x32_bf16 v[80:83], a[144:147], v[192:195], v[24:27]
ds_read_b64_tr_b16 a[196:197], v6 offset:40960
v_cvt_pk_bf16_f32 v143, v118, v119
v_lshl_add_u32 v58, v58, 3, s94
v_mfma_f32_16x16x32_bf16 v[80:83], a[148:151], v[196:199], v[80:83]
v_exp_f32 v120, v120
v_min_u32 v58, (L_end-L_pc_a-4), v58
v_mfma_f32_16x16x32_bf16 v[80:83], a[152:155], v[200:203], v[80:83]
buffer_load_dwordx4 v18, s[16:19], s41 offen offset:0 lds
v_mov_b32 v59, s93
v_mfma_f32_16x16x32_bf16 v[80:83], a[156:159], v[204:207], v[80:83]
ds_read_b64_tr_b16 a[198:199], v6 offset:45056
v_add_co_u32 v58, vcc, s92, v58
v_mfma_f32_16x16x32_bf16 v[84:87], a[144:147], v[208:211], v[28:31]
v_exp_f32 v121, v121
v_addc_co_u32 v59, vcc, 0, v59, vcc
v_mfma_f32_16x16x32_bf16 v[84:87], a[148:151], v[212:215], v[84:87]
v_exp_f32 v122, v122
global_load_dword v61, v[58:59], off
v_mfma_f32_16x16x32_bf16 v[84:87], a[152:155], v[216:219], v[84:87]
ds_read_b64_tr_b16 a[200:201], v7 offset:32768
v_cvt_pk_bf16_f32 v150, v120, v121
v_mfma_f32_16x16x32_bf16 v[84:87], a[156:159], v[220:223], v[84:87]
v_exp_f32 v123, v123
v_mfma_f32_16x16x32_bf16 v[88:91], a[144:147], v[224:227], v[32:35]
ds_read_b64_tr_b16 a[202:203], v7 offset:36864
v_cvt_pk_bf16_f32 v151, v122, v123
ds_read_b64_tr_b16 v[56:57], v60 offset:0
v_mfma_f32_16x16x32_bf16 v[88:91], a[148:151], v[228:231], v[88:91]
v_exp_f32 v124, v124
v_mfma_f32_16x16x32_bf16 v[88:91], a[152:155], v[232:235], v[88:91]
ds_read_b64_tr_b16 a[204:205], v7 offset:40960
ds_read_b64_tr_b16 v[58:59], v60 offset:2560
v_mfma_f32_16x16x32_bf16 v[88:91], a[156:159], v[236:239], v[88:91]
v_exp_f32 v125, v125
v_mfma_f32_16x16x32_bf16 v[92:95], a[144:147], v[240:243], v[36:39]
ds_read_b64_tr_b16 a[206:207], v7 offset:45056
v_cvt_pk_bf16_f32 v158, v124, v125
v_mfma_f32_16x16x32_bf16 v[92:95], a[148:151], v[244:247], v[92:95]
v_exp_f32 v126, v126
v_mfma_f32_16x16x32_bf16 v[92:95], a[152:155], v[248:251], v[92:95]
buffer_load_dwordx4 v19, s[16:19], s41 offen offset:1024 lds
v_mfma_f32_16x16x32_bf16 v[92:95], a[156:159], v[252:255], v[92:95]
ds_read_b64_tr_b16 a[208:209], v8 offset:32768
s_waitcnt lgkmcnt(11)
v_mfma_f32_16x16x32_bf16 v[96:99], a[160:163], v[192:195], v[24:27]
v_exp_f32 v127, v127
v_mfma_f32_16x16x32_bf16 v[96:99], a[164:167], v[196:199], v[96:99]
ds_read_b64_tr_b16 a[210:211], v8 offset:36864
v_cvt_pk_bf16_f32 v159, v126, v127
v_mfma_f32_16x16x32_bf16 v[96:99], a[168:171], v[200:203], v[96:99]
v_exp_f32 v64, v64
v_mfma_f32_16x16x32_bf16 v[96:99], a[172:175], v[204:207], v[96:99]
s_waitcnt lgkmcnt(3)
buffer_store_dwordx4 v[56:59], v1, s[32:35], 0 offen offset:0 sc1
v_mfma_f32_16x16x32_bf16 v[100:103], a[160:163], v[208:211], v[28:31]
v_exp_f32 v65, v65
v_mfma_f32_16x16x32_bf16 v[100:103], a[164:167], v[212:215], v[100:103]
ds_read_b64_tr_b16 a[212:213], v8 offset:40960
v_cvt_pk_bf16_f32 v160, v64, v65
v_mfma_f32_16x16x32_bf16 v[100:103], a[168:171], v[216:219], v[100:103]
v_exp_f32 v66, v66
ds_read_b64_tr_b16 v[56:57], v60 offset:32
v_mfma_f32_16x16x32_bf16 v[100:103], a[172:175], v[220:223], v[100:103]
ds_read_b64_tr_b16 a[214:215], v8 offset:45056
ds_read_b64_tr_b16 v[58:59], v60 offset:2592
v_mfma_f32_16x16x32_bf16 v[104:107], a[160:163], v[224:227], v[32:35]
v_exp_f32 v67, v67
v_mfma_f32_16x16x32_bf16 v[104:107], a[164:167], v[228:231], v[104:107]
ds_read_b64_tr_b16 a[216:217], v9 offset:32768
v_cvt_pk_bf16_f32 v161, v66, v67
v_mfma_f32_16x16x32_bf16 v[104:107], a[168:171], v[232:235], v[104:107]
v_exp_f32 v68, v68
v_mfma_f32_16x16x32_bf16 v[104:107], a[172:175], v[236:239], v[104:107]
buffer_load_dwordx4 v18, s[16:19], s41 offen offset:2048 lds
v_mfma_f32_16x16x32_bf16 v[108:111], a[160:163], v[240:243], v[36:39]
v_exp_f32 v69, v69
v_mfma_f32_16x16x32_bf16 v[108:111], a[164:167], v[244:247], v[108:111]
ds_read_b64_tr_b16 a[218:219], v9 offset:36864
v_cvt_pk_bf16_f32 v168, v68, v69
v_mfma_f32_16x16x32_bf16 v[108:111], a[168:171], v[248:251], v[108:111]
v_exp_f32 v70, v70
v_mfma_f32_16x16x32_bf16 v[108:111], a[172:175], v[252:255], v[108:111]
ds_read_b64_tr_b16 a[220:221], v9 offset:40960
v_mfma_f32_16x16x32_bf16 v[112:115], a[176:179], v[192:195], v[24:27]
v_exp_f32 v71, v71
v_mfma_f32_16x16x32_bf16 v[112:115], a[180:183], v[196:199], v[112:115]
ds_read_b64_tr_b16 a[222:223], v9 offset:45056
v_cvt_pk_bf16_f32 v169, v70, v71
s_waitcnt lgkmcnt(4)
buffer_store_dwordx4 v[56:59], v1, s[32:35], 0 offen offset:1024 sc1
v_mfma_f32_16x16x32_bf16 v[112:115], a[184:187], v[200:203], v[112:115]
v_exp_f32 v72, v72
v_mfma_f32_16x16x32_bf16 v[112:115], a[188:191], v[204:207], v[112:115]
ds_read_b64_tr_b16 v[56:57], v60 offset:64
ds_read_b64_tr_b16 v[58:59], v60 offset:2624
v_mfma_f32_16x16x32_bf16 v[116:119], a[176:179], v[208:211], v[28:31]
v_exp_f32 v73, v73
v_mfma_f32_16x16x32_bf16 v[116:119], a[180:183], v[212:215], v[116:119]
ds_read_b64_tr_b16 a[224:225], v10 offset:32768
v_cvt_pk_bf16_f32 v176, v72, v73
v_mfma_f32_16x16x32_bf16 v[116:119], a[184:187], v[216:219], v[116:119]
v_exp_f32 v74, v74
v_mfma_f32_16x16x32_bf16 v[116:119], a[188:191], v[220:223], v[116:119]
buffer_load_dwordx4 v19, s[16:19], s41 offen offset:3072 lds
v_mfma_f32_16x16x32_bf16 v[120:123], a[176:179], v[224:227], v[32:35]
v_exp_f32 v75, v75
v_mfma_f32_16x16x32_bf16 v[120:123], a[180:183], v[228:231], v[120:123]
ds_read_b64_tr_b16 a[226:227], v10 offset:36864
v_cvt_pk_bf16_f32 v177, v74, v75
v_mfma_f32_16x16x32_bf16 v[120:123], a[184:187], v[232:235], v[120:123]
v_exp_f32 v76, v76
v_mfma_f32_16x16x32_bf16 v[120:123], a[188:191], v[236:239], v[120:123]
ds_read_b64_tr_b16 a[228:229], v10 offset:40960
s_add_u32 s41, s41, 16384
v_mfma_f32_16x16x32_bf16 v[124:127], a[176:179], v[240:243], v[36:39]
v_exp_f32 v77, v77
v_mfma_f32_16x16x32_bf16 v[124:127], a[180:183], v[244:247], v[124:127]
ds_read_b64_tr_b16 a[230:231], v10 offset:45056
v_cvt_pk_bf16_f32 v184, v76, v77
v_mfma_f32_16x16x32_bf16 v[124:127], a[184:187], v[248:251], v[124:127]
v_exp_f32 v78, v78
v_mfma_f32_16x16x32_bf16 v[124:127], a[188:191], v[252:255], v[124:127]
ds_read_b64_tr_b16 a[232:233], v11 offset:32768
s_waitcnt lgkmcnt(5)
buffer_store_dwordx4 v[56:59], v1, s[32:35], 0 offen offset:2048 sc1
v_mfma_f32_16x16x32_bf16 a[0:3], a[192:195], v[128:131], a[0:3]
v_exp_f32 v79, v79
v_mfma_f32_16x16x32_bf16 a[0:3], a[196:199], v[132:135], a[0:3]
ds_read_b64_tr_b16 a[234:235], v11 offset:36864
v_cvt_pk_bf16_f32 v185, v78, v79
v_mfma_f32_16x16x32_bf16 a[4:7], a[192:195], v[136:139], a[4:7]
ds_read_b64_tr_b16 v[56:57], v60 offset:96
ds_read_b64_tr_b16 v[58:59], v60 offset:2656
v_mfma_f32_16x16x32_bf16 a[4:7], a[196:199], v[140:143], a[4:7]
v_exp_f32 v80, v80
v_mfma_f32_16x16x32_bf16 a[8:11], a[192:195], v[144:147], a[8:11]
ds_read_b64_tr_b16 a[236:237], v11 offset:40960
v_mfma_f32_16x16x32_bf16 a[8:11], a[196:199], v[148:151], a[8:11]
v_exp_f32 v81, v81
v_mfma_f32_16x16x32_bf16 a[12:15], a[192:195], v[152:155], a[12:15]
v_cvt_pk_bf16_f32 v162, v80, v81
v_mfma_f32_16x16x32_bf16 a[12:15], a[196:199], v[156:159], a[12:15]
v_exp_f32 v82, v82
v_mfma_f32_16x16x32_bf16 a[16:19], a[200:203], v[128:131], a[16:19]
ds_read_b64_tr_b16 a[238:239], v11 offset:45056
v_mfma_f32_16x16x32_bf16 a[16:19], a[204:207], v[132:135], a[16:19]
v_exp_f32 v83, v83
v_mfma_f32_16x16x32_bf16 a[20:23], a[200:203], v[136:139], a[20:23]
ds_read_b64_tr_b16 a[240:241], v12 offset:32768
v_cvt_pk_bf16_f32 v163, v82, v83
v_mfma_f32_16x16x32_bf16 a[20:23], a[204:207], v[140:143], a[20:23]
v_exp_f32 v84, v84
v_mfma_f32_16x16x32_bf16 a[24:27], a[200:203], v[144:147], a[24:27]
ds_read_b64_tr_b16 a[242:243], v12 offset:36864
v_mfma_f32_16x16x32_bf16 a[24:27], a[204:207], v[148:151], a[24:27]
v_exp_f32 v85, v85
s_waitcnt lgkmcnt(4)
buffer_store_dwordx4 v[56:59], v1, s[32:35], 0 offen offset:3072 sc1
v_mfma_f32_16x16x32_bf16 a[28:31], a[200:203], v[152:155], a[28:31]
v_cvt_pk_bf16_f32 v170, v84, v85
ds_read_b64_tr_b16 v[56:57], v60 offset:128
v_mfma_f32_16x16x32_bf16 a[28:31], a[204:207], v[156:159], a[28:31]
v_exp_f32 v86, v86
v_smfmac_f32_16x16x64_bf16 v[40:43], v[20:23], v[128:135], v62
ds_read_b64_tr_b16 a[244:245], v12 offset:40960
ds_read_b64_tr_b16 v[58:59], v60 offset:2688
v_mfma_f32_16x16x32_bf16 a[32:35], a[208:211], v[128:131], a[32:35]
v_exp_f32 v87, v87
v_mfma_f32_16x16x32_bf16 a[32:35], a[212:215], v[132:135], a[32:35]
ds_read_b64_tr_b16 a[246:247], v12 offset:45056
v_cvt_pk_bf16_f32 v171, v86, v87
v_mfma_f32_16x16x32_bf16 a[36:39], a[208:211], v[136:139], a[36:39]
v_exp_f32 v88, v88
v_mfma_f32_16x16x32_bf16 a[36:39], a[212:215], v[140:143], a[36:39]
ds_read_b64_tr_b16 a[248:249], v13 offset:32768
v_mfma_f32_16x16x32_bf16 a[40:43], a[208:211], v[144:147], a[40:43]
v_exp_f32 v89, v89
v_mfma_f32_16x16x32_bf16 a[40:43], a[212:215], v[148:151], a[40:43]
v_cvt_pk_bf16_f32 v178, v88, v89
v_mfma_f32_16x16x32_bf16 a[44:47], a[208:211], v[152:155], a[44:47]
v_exp_f32 v90, v90
v_mfma_f32_16x16x32_bf16 a[44:47], a[212:215], v[156:159], a[44:47]
ds_read_b64_tr_b16 a[250:251], v13 offset:36864
v_mfma_f32_16x16x32_bf16 a[48:51], a[216:219], v[128:131], a[48:51]
v_exp_f32 v91, v91
v_mfma_f32_16x16x32_bf16 a[48:51], a[220:223], v[132:135], a[48:51]
ds_read_b64_tr_b16 a[252:253], v13 offset:40960
v_cvt_pk_bf16_f32 v179, v90, v91
v_mfma_f32_16x16x32_bf16 a[52:55], a[216:219], v[136:139], a[52:55]
v_exp_f32 v92, v92
v_mfma_f32_16x16x32_bf16 a[52:55], a[220:223], v[140:143], a[52:55]
ds_read_b64_tr_b16 a[254:255], v13 offset:45056
s_waitcnt lgkmcnt(5)
buffer_store_dwordx4 v[56:59], v63, s[32:35], 0 offen offset:0 sc1
v_mfma_f32_16x16x32_bf16 a[56:59], a[216:219], v[144:147], a[56:59]
v_exp_f32 v93, v93
v_mfma_f32_16x16x32_bf16 a[56:59], a[220:223], v[148:151], a[56:59]
v_cvt_pk_bf16_f32 v186, v92, v93
v_lshrrev_b32 v60, 7, v1
v_mfma_f32_16x16x32_bf16 a[60:63], a[216:219], v[152:155], a[60:63]
v_exp_f32 v94, v94
v_mfma_f32_16x16x32_bf16 a[60:63], a[220:223], v[156:159], a[60:63]
v_mul_u32_u24 v60, 3456, v60
s_waitcnt vmcnt(8)
v_bfe_u32 v61, v1, 4, 3
v_smfmac_f32_16x16x64_bf16 v[44:47], v[20:23], v[136:143], v62
v_bfe_u32 v59, v1, 8, 1
v_lshlrev_b32 v59, 1, v59
s_waitcnt lgkmcnt(0)
v_mfma_f32_16x16x32_bf16 a[64:67], a[224:227], v[128:131], a[64:67]
s_barrier
v_mfma_f32_16x16x32_bf16 a[64:67], a[228:231], v[132:135], a[64:67]
v_exp_f32 v95, v95
v_mfma_f32_16x16x32_bf16 a[68:71], a[224:227], v[136:139], a[68:71]
ds_read_b128 a[128:131], v2 offset:0
v_xor_b32 v61, v59, v61
v_mfma_f32_16x16x32_bf16 a[68:71], a[228:231], v[140:143], a[68:71]
v_exp_f32 v96, v96
v_mfma_f32_16x16x32_bf16 a[72:75], a[224:227], v[144:147], a[72:75]
v_xor_b32 v56, 0, v61
v_mfma_f32_16x16x32_bf16 a[72:75], a[228:231], v[148:151], a[72:75]
v_exp_f32 v97, v97
v_mfma_f32_16x16x32_bf16 a[76:79], a[224:227], v[152:155], a[76:79]
ds_read_b128 a[132:135], v3 offset:0
v_cvt_pk_bf16_f32 v187, v94, v95
v_mfma_f32_16x16x32_bf16 a[76:79], a[228:231], v[156:159], a[76:79]
v_exp_f32 v98, v98
v_mfma_f32_16x16x32_bf16 a[80:83], a[232:235], v[128:131], a[80:83]
ds_read_b128 a[136:139], v4 offset:0
v_cvt_pk_bf16_f32 v164, v96, v97
v_mfma_f32_16x16x32_bf16 a[80:83], a[236:239], v[132:135], a[80:83]
v_exp_f32 v99, v99
v_mfma_f32_16x16x32_bf16 a[84:87], a[232:235], v[136:139], a[84:87]
v_exp_f32 v100, v100
v_mfma_f32_16x16x32_bf16 a[84:87], a[236:239], v[140:143], a[84:87]
ds_read_b128 a[140:143], v5 offset:0
ds_read_b128 a[144:147], v2 offset:4096
v_mfma_f32_16x16x32_bf16 a[88:91], a[232:235], v[144:147], a[88:91]
v_exp_f32 v101, v101
v_mfma_f32_16x16x32_bf16 a[88:91], a[236:239], v[148:151], a[88:91]
v_cvt_pk_bf16_f32 v165, v98, v99
v_cvt_pk_bf16_f32 v172, v100, v101
v_mfma_f32_16x16x32_bf16 a[92:95], a[232:235], v[152:155], a[92:95]
v_exp_f32 v102, v102
v_mfma_f32_16x16x32_bf16 a[92:95], a[236:239], v[156:159], a[92:95]
ds_read_b128 a[148:151], v3 offset:4096
v_lshl_add_u32 v56, v56, 4, v60
v_smfmac_f32_16x16x64_bf16 v[48:51], v[20:23], v[144:151], v62
v_add_u32 v56, 0, v56
v_xor_b32 v57, 4, v61
v_mfma_f32_16x16x32_bf16 a[96:99], a[240:243], v[128:131], a[96:99]
v_exp_f32 v103, v103
v_mfma_f32_16x16x32_bf16 a[96:99], a[244:247], v[132:135], a[96:99]
v_exp_f32 v104, v104
v_mfma_f32_16x16x32_bf16 a[100:103], a[240:243], v[136:139], a[100:103]
ds_read_b128 a[152:155], v4 offset:4096
ds_read_b128 a[156:159], v5 offset:4096
v_mfma_f32_16x16x32_bf16 a[100:103], a[244:247], v[140:143], a[100:103]
v_exp_f32 v105, v105
v_mfma_f32_16x16x32_bf16 a[104:107], a[240:243], v[144:147], a[104:107]
v_cvt_pk_bf16_f32 v173, v102, v103
v_cvt_pk_bf16_f32 v180, v104, v105
v_mfma_f32_16x16x32_bf16 a[104:107], a[244:247], v[148:151], a[104:107]
v_exp_f32 v106, v106
v_mfma_f32_16x16x32_bf16 a[108:111], a[240:243], v[152:155], a[108:111]
ds_read_b128 a[160:163], v2 offset:8192
v_lshl_add_u32 v57, v57, 4, v60
v_mfma_f32_16x16x32_bf16 a[108:111], a[244:247], v[156:159], a[108:111]
v_exp_f32 v107, v107
v_mfma_f32_16x16x32_bf16 a[112:115], a[248:251], v[128:131], a[112:115]
ds_read_b128 a[164:167], v3 offset:8192
v_cvt_pk_bf16_f32 v181, v106, v107
v_add_u32 v57, 26624, v57
v_mfma_f32_16x16x32_bf16 a[112:115], a[252:255], v[132:135], a[112:115]
v_exp_f32 v108, v108
v_mfma_f32_16x16x32_bf16 a[116:119], a[248:251], v[136:139], a[116:119]
v_xor_b32 v58, 0, v61
v_lshl_add_u32 v58, v58, 4, v60
v_mfma_f32_16x16x32_bf16 a[116:119], a[252:255], v[140:143], a[116:119]
v_exp_f32 v109, v109
v_mfma_f32_16x16x32_bf16 a[120:123], a[248:251], v[144:147], a[120:123]
ds_read_b128 a[168:171], v4 offset:8192
v_cvt_pk_bf16_f32 v188, v108, v109
v_mfma_f32_16x16x32_bf16 a[120:123], a[252:255], v[148:151], a[120:123]
v_exp_f32 v110, v110
v_mfma_f32_16x16x32_bf16 a[124:127], a[248:251], v[152:155], a[124:127]
ds_read_b128 a[172:175], v5 offset:8192
v_add_u32 v58, 53248, v58
v_mfma_f32_16x16x32_bf16 a[124:127], a[252:255], v[156:159], a[124:127]
v_exp_f32 v111, v111
v_smfmac_f32_16x16x64_bf16 v[52:55], v[20:23], v[152:159], v62
ds_read_b128 a[176:179], v2 offset:12288
v_xor_b32 v59, 4, v61
v_lshl_add_u32 v59, v59, 4, v60
v_add_u32 v59, 79872, v59
s_mul_i32 s45, s40, 110592
s_waitcnt lgkmcnt(5)
v_mfma_f32_16x16x32_bf16 v[64:67], a[128:131], v[192:195], v[24:27]
v_cvt_pk_bf16_f32 v189, v110, v111
v_mfma_f32_16x16x32_bf16 v[64:67], a[132:135], v[196:199], v[64:67]
v_exp_f32 v112, v112
v_mfma_f32_16x16x32_bf16 v[64:67], a[136:139], v[200:203], v[64:67]
ds_read_b128 a[180:183], v3 offset:12288
v_mfma_f32_16x16x32_bf16 v[64:67], a[140:143], v[204:207], v[64:67]
v_exp_f32 v113, v113
v_mfma_f32_16x16x32_bf16 v[68:71], a[128:131], v[208:211], v[28:31]
ds_read_b128 a[184:187], v4 offset:12288
v_cvt_pk_bf16_f32 v166, v112, v113
v_mfma_f32_16x16x32_bf16 v[68:71], a[132:135], v[212:215], v[68:71]
v_exp_f32 v114, v114
v_mfma_f32_16x16x32_bf16 v[68:71], a[136:139], v[216:219], v[68:71]
v_mfma_f32_16x16x32_bf16 v[68:71], a[140:143], v[220:223], v[68:71]
v_exp_f32 v115, v115
v_mfma_f32_16x16x32_bf16 v[72:75], a[128:131], v[224:227], v[32:35]
ds_read_b128 a[188:191], v5 offset:12288
v_cvt_pk_bf16_f32 v167, v114, v115
v_mfma_f32_16x16x32_bf16 v[72:75], a[132:135], v[228:231], v[72:75]
v_exp_f32 v116, v116
v_mfma_f32_16x16x32_bf16 v[72:75], a[136:139], v[232:235], v[72:75]
ds_read_b64_tr_b16 a[192:193], v6 offset:49152
v_mfma_f32_16x16x32_bf16 v[72:75], a[140:143], v[236:239], v[72:75]
v_exp_f32 v117, v117
v_mfma_f32_16x16x32_bf16 v[76:79], a[128:131], v[240:243], v[36:39]
ds_read_b64_tr_b16 a[194:195], v6 offset:53248
v_cvt_pk_bf16_f32 v174, v116, v117
v_mfma_f32_16x16x32_bf16 v[76:79], a[132:135], v[244:247], v[76:79]
v_exp_f32 v118, v118
v_mfma_f32_16x16x32_bf16 v[76:79], a[136:139], v[248:251], v[76:79]
s_mov_b32 m0, s53
v_mfma_f32_16x16x32_bf16 v[76:79], a[140:143], v[252:255], v[76:79]
v_exp_f32 v119, v119
v_mfma_f32_16x16x32_bf16 v[80:83], a[144:147], v[192:195], v[24:27]
ds_read_b64_tr_b16 a[196:197], v6 offset:57344
v_cvt_pk_bf16_f32 v175, v118, v119
v_mfma_f32_16x16x32_bf16 v[80:83], a[148:151], v[196:199], v[80:83]
v_exp_f32 v120, v120
v_mfma_f32_16x16x32_bf16 v[80:83], a[152:155], v[200:203], v[80:83]
buffer_load_dwordx4 v18, s[16:19], s41 offen offset:0 lds
v_mfma_f32_16x16x32_bf16 v[80:83], a[156:159], v[204:207], v[80:83]
ds_read_b64_tr_b16 a[198:199], v6 offset:61440
v_mfma_f32_16x16x32_bf16 v[84:87], a[144:147], v[208:211], v[28:31]
v_exp_f32 v121, v121
v_mfma_f32_16x16x32_bf16 v[84:87], a[148:151], v[212:215], v[84:87]
v_exp_f32 v122, v122
v_mfma_f32_16x16x32_bf16 v[84:87], a[152:155], v[216:219], v[84:87]
ds_read_b64_tr_b16 a[200:201], v7 offset:49152
v_cvt_pk_bf16_f32 v182, v120, v121
v_mfma_f32_16x16x32_bf16 v[84:87], a[156:159], v[220:223], v[84:87]
v_exp_f32 v123, v123
v_mfma_f32_16x16x32_bf16 v[88:91], a[144:147], v[224:227], v[32:35]
ds_read_b64_tr_b16 a[202:203], v7 offset:53248
v_cvt_pk_bf16_f32 v183, v122, v123
v_mfma_f32_16x16x32_bf16 v[88:91], a[148:151], v[228:231], v[88:91]
v_exp_f32 v124, v124
v_mfma_f32_16x16x32_bf16 v[88:91], a[152:155], v[232:235], v[88:91]
ds_read_b64_tr_b16 a[204:205], v7 offset:57344
s_lshl_b32 s92, s2, 2
v_mfma_f32_16x16x32_bf16 v[88:91], a[156:159], v[236:239], v[88:91]
v_exp_f32 v125, v125
v_mfma_f32_16x16x32_bf16 v[92:95], a[144:147], v[240:243], v[36:39]
ds_read_b64_tr_b16 a[206:207], v7 offset:61440
v_cvt_pk_bf16_f32 v190, v124, v125
v_mfma_f32_16x16x32_bf16 v[92:95], a[148:151], v[244:247], v[92:95]
v_exp_f32 v126, v126
v_mfma_f32_16x16x32_bf16 v[92:95], a[152:155], v[248:251], v[92:95]
buffer_load_dwordx4 v19, s[16:19], s41 offen offset:1024 lds
v_mfma_f32_16x16x32_bf16 v[92:95], a[156:159], v[252:255], v[92:95]
ds_read_b64_tr_b16 a[208:209], v8 offset:49152
s_add_u32 s92, s92, 2048
s_waitcnt lgkmcnt(9)
v_mfma_f32_16x16x32_bf16 v[96:99], a[160:163], v[192:195], v[24:27]
v_exp_f32 v127, v127
v_mfma_f32_16x16x32_bf16 v[96:99], a[164:167], v[196:199], v[96:99]
ds_read_b64_tr_b16 a[210:211], v8 offset:53248
v_cvt_pk_bf16_f32 v191, v126, v127
v_mfma_f32_16x16x32_bf16 v[96:99], a[168:171], v[200:203], v[96:99]
v_exp_f32 v64, v64
v_mfma_f32_16x16x32_bf16 v[96:99], a[172:175], v[204:207], v[96:99]
v_add_u32 v60, s40, v1
v_mfma_f32_16x16x32_bf16 v[100:103], a[160:163], v[208:211], v[28:31]
v_exp_f32 v65, v65
v_mfma_f32_16x16x32_bf16 v[100:103], a[164:167], v[212:215], v[100:103]
ds_read_b64_tr_b16 a[212:213], v8 offset:57344
v_cvt_pk_bf16_f32 v128, v64, v65
v_mfma_f32_16x16x32_bf16 v[100:103], a[168:171], v[216:219], v[100:103]
v_exp_f32 v66, v66
v_mfma_f32_16x16x32_bf16 v[100:103], a[172:175], v[220:223], v[100:103]
ds_read_b64_tr_b16 a[214:215], v8 offset:61440
v_mfma_f32_16x16x32_bf16 v[104:107], a[160:163], v[224:227], v[32:35]
v_exp_f32 v67, v67
v_mfma_f32_16x16x32_bf16 v[104:107], a[164:167], v[228:231], v[104:107]
ds_read_b64_tr_b16 a[216:217], v9 offset:49152
v_cvt_pk_bf16_f32 v129, v66, v67
v_mfma_f32_16x16x32_bf16 v[104:107], a[168:171], v[232:235], v[104:107]
v_exp_f32 v68, v68
v_mfma_f32_16x16x32_bf16 v[104:107], a[172:175], v[236:239], v[104:107]
buffer_load_dwordx4 v18, s[16:19], s41 offen offset:2048 lds
v_mfma_f32_16x16x32_bf16 v[108:111], a[160:163], v[240:243], v[36:39]
v_exp_f32 v69, v69
v_mfma_f32_16x16x32_bf16 v[108:111], a[164:167], v[244:247], v[108:111]
ds_read_b64_tr_b16 a[218:219], v9 offset:53248
v_cvt_pk_bf16_f32 v136, v68, v69
v_mfma_f32_16x16x32_bf16 v[108:111], a[168:171], v[248:251], v[108:111]
v_exp_f32 v70, v70
v_mfma_f32_16x16x32_bf16 v[108:111], a[172:175], v[252:255], v[108:111]
ds_read_b64_tr_b16 a[220:221], v9 offset:57344
v_min_u32 v60, 1, v60
v_mfma_f32_16x16x32_bf16 v[112:115], a[176:179], v[192:195], v[24:27]
v_exp_f32 v71, v71
v_mfma_f32_16x16x32_bf16 v[112:115], a[180:183], v[196:199], v[112:115]
ds_read_b64_tr_b16 a[222:223], v9 offset:61440
v_cvt_pk_bf16_f32 v137, v70, v71
v_mfma_f32_16x16x32_bf16 v[112:115], a[184:187], v[200:203], v[112:115]
v_exp_f32 v72, v72
v_mfma_f32_16x16x32_bf16 v[112:115], a[188:191], v[204:207], v[112:115]
v_lshlrev_b32 v60, 31, v60
v_mfma_f32_16x16x32_bf16 v[116:119], a[176:179], v[208:211], v[28:31]
v_exp_f32 v73, v73
v_mfma_f32_16x16x32_bf16 v[116:119], a[180:183], v[212:215], v[116:119]
ds_read_b64_tr_b16 a[224:225], v10 offset:49152
v_cvt_pk_bf16_f32 v144, v72, v73
v_mfma_f32_16x16x32_bf16 v[116:119], a[184:187], v[216:219], v[116:119]
v_exp_f32 v74, v74
v_mfma_f32_16x16x32_bf16 v[116:119], a[188:191], v[220:223], v[116:119]
buffer_load_dwordx4 v19, s[16:19], s41 offen offset:3072 lds
v_mfma_f32_16x16x32_bf16 v[120:123], a[176:179], v[224:227], v[32:35]
v_exp_f32 v75, v75
v_mfma_f32_16x16x32_bf16 v[120:123], a[180:183], v[228:231], v[120:123]
ds_read_b64_tr_b16 a[226:227], v10 offset:53248
v_cvt_pk_bf16_f32 v145, v74, v75
v_mfma_f32_16x16x32_bf16 v[120:123], a[184:187], v[232:235], v[120:123]
v_exp_f32 v76, v76
v_mfma_f32_16x16x32_bf16 v[120:123], a[188:191], v[236:239], v[120:123]
ds_read_b64_tr_b16 a[228:229], v10 offset:57344
s_add_u32 s41, s41, 16384
v_mfma_f32_16x16x32_bf16 v[124:127], a[176:179], v[240:243], v[36:39]
v_exp_f32 v77, v77
v_mfma_f32_16x16x32_bf16 v[124:127], a[180:183], v[244:247], v[124:127]
ds_read_b64_tr_b16 a[230:231], v10 offset:61440
v_cvt_pk_bf16_f32 v152, v76, v77
v_mfma_f32_16x16x32_bf16 v[124:127], a[184:187], v[248:251], v[124:127]
v_exp_f32 v78, v78
v_mfma_f32_16x16x32_bf16 v[124:127], a[188:191], v[252:255], v[124:127]
ds_read_b64_tr_b16 a[232:233], v11 offset:49152
v_mov_b32 v61, s82
s_waitcnt lgkmcnt(5)
v_mfma_f32_16x16x32_bf16 a[0:3], a[192:195], v[160:163], a[0:3]
v_exp_f32 v79, v79
v_mfma_f32_16x16x32_bf16 a[0:3], a[196:199], v[164:167], a[0:3]
ds_read_b64_tr_b16 a[234:235], v11 offset:53248
v_cvt_pk_bf16_f32 v153, v78, v79
v_mfma_f32_16x16x32_bf16 a[4:7], a[192:195], v[168:171], a[4:7]
s_and_b32 s66, s64, 15
s_lshr_b64 s[64:65], s[64:65], 4
v_mfma_f32_16x16x32_bf16 a[4:7], a[196:199], v[172:175], a[4:7]
v_exp_f32 v80, v80
v_mfma_f32_16x16x32_bf16 a[8:11], a[192:195], v[176:179], a[8:11]
ds_read_b64_tr_b16 a[236:237], v11 offset:57344
s_mul_i32 s42, s66, 442368
v_mfma_f32_16x16x32_bf16 a[8:11], a[196:199], v[180:183], a[8:11]
v_exp_f32 v81, v81
v_mfma_f32_16x16x32_bf16 a[12:15], a[192:195], v[184:187], a[12:15]
v_cvt_pk_bf16_f32 v130, v80, v81
s_add_u32 s42, s42, s45
v_mfma_f32_16x16x32_bf16 a[12:15], a[196:199], v[188:191], a[12:15]
v_exp_f32 v82, v82
v_mfma_f32_16x16x32_bf16 a[16:19], a[200:203], v[160:163], a[16:19]
ds_read_b64_tr_b16 a[238:239], v11 offset:61440
s_mov_b32 m0, s50
v_mfma_f32_16x16x32_bf16 a[16:19], a[204:207], v[164:167], a[16:19]
v_exp_f32 v83, v83
v_mfma_f32_16x16x32_bf16 a[20:23], a[200:203], v[168:171], a[20:23]
ds_read_b64_tr_b16 a[240:241], v12 offset:49152
v_cvt_pk_bf16_f32 v131, v82, v83
v_mfma_f32_16x16x32_bf16 a[20:23], a[204:207], v[172:175], a[20:23]
v_exp_f32 v84, v84
v_mfma_f32_16x16x32_bf16 a[24:27], a[200:203], v[176:179], a[24:27]
ds_read_b64_tr_b16 a[242:243], v12 offset:53248
buffer_load_dwordx4 v56, s[24:27], s42 offen offset:0 lds
v_mfma_f32_16x16x32_bf16 a[24:27], a[204:207], v[180:183], a[24:27]
v_exp_f32 v85, v85
v_mfma_f32_16x16x32_bf16 a[28:31], a[200:203], v[184:187], a[28:31]
v_cvt_pk_bf16_f32 v138, v84, v85
v_mfma_f32_16x16x32_bf16 a[28:31], a[204:207], v[188:191], a[28:31]
v_exp_f32 v86, v86
v_smfmac_f32_16x16x64_bf16 v[40:43], v[20:23], v[160:167], v62
ds_read_b64_tr_b16 a[244:245], v12 offset:57344
v_mfma_f32_16x16x32_bf16 a[32:35], a[208:211], v[160:163], a[32:35]
v_exp_f32 v87, v87
v_mfma_f32_16x16x32_bf16 a[32:35], a[212:215], v[164:167], a[32:35]
ds_read_b64_tr_b16 a[246:247], v12 offset:61440
v_cvt_pk_bf16_f32 v139, v86, v87
v_mfma_f32_16x16x32_bf16 a[36:39], a[208:211], v[168:171], a[36:39]
v_exp_f32 v88, v88
buffer_load_dwordx4 v57, s[24:27], s42 offen offset:1024 lds
v_mfma_f32_16x16x32_bf16 a[36:39], a[212:215], v[172:175], a[36:39]
ds_read_b64_tr_b16 a[248:249], v13 offset:49152
v_mfma_f32_16x16x32_bf16 a[40:43], a[208:211], v[176:179], a[40:43]
v_exp_f32 v89, v89
v_mfma_f32_16x16x32_bf16 a[40:43], a[212:215], v[180:183], a[40:43]
v_cvt_pk_bf16_f32 v146, v88, v89
v_mfma_f32_16x16x32_bf16 a[44:47], a[208:211], v[184:187], a[44:47]
v_exp_f32 v90, v90
v_mfma_f32_16x16x32_bf16 a[44:47], a[212:215], v[188:191], a[44:47]
ds_read_b64_tr_b16 a[250:251], v13 offset:53248
v_mfma_f32_16x16x32_bf16 a[48:51], a[216:219], v[160:163], a[48:51]
v_exp_f32 v91, v91
v_mfma_f32_16x16x32_bf16 a[48:51], a[220:223], v[164:167], a[48:51]
ds_read_b64_tr_b16 a[252:253], v13 offset:57344
v_cvt_pk_bf16_f32 v147, v90, v91
buffer_load_dwordx4 v58, s[24:27], s42 offen offset:2048 lds
v_mfma_f32_16x16x32_bf16 a[52:55], a[216:219], v[168:171], a[52:55]
v_exp_f32 v92, v92
v_mfma_f32_16x16x32_bf16 a[52:55], a[220:223], v[172:175], a[52:55]
ds_read_b64_tr_b16 a[254:255], v13 offset:61440
v_mfma_f32_16x16x32_bf16 a[56:59], a[216:219], v[176:179], a[56:59]
v_exp_f32 v93, v93
v_mfma_f32_16x16x32_bf16 a[56:59], a[220:223], v[180:183], a[56:59]
v_cvt_pk_bf16_f32 v154, v92, v93
v_mfma_f32_16x16x32_bf16 a[60:63], a[216:219], v[184:187], a[60:63]
v_exp_f32 v94, v94
v_mfma_f32_16x16x32_bf16 a[60:63], a[220:223], v[188:191], a[60:63]
buffer_load_dwordx4 v59, s[24:27], s42 offen offset:3072 lds
v_smfmac_f32_16x16x64_bf16 v[44:47], v[20:23], v[168:175], v62
s_mul_i32 s43, s66, 20480
s_add_u32 s43, s43, s46
s_waitcnt lgkmcnt(0)
v_mfma_f32_16x16x32_bf16 a[64:67], a[224:227], v[160:163], a[64:67]
s_waitcnt vmcnt(8)
s_barrier
v_mfma_f32_16x16x32_bf16 a[64:67], a[228:231], v[164:167], a[64:67]
v_exp_f32 v95, v95
v_mfma_f32_16x16x32_bf16 a[68:71], a[224:227], v[168:171], a[68:71]
ds_read_b128 a[128:131], v2 offset:16384
s_add_u32 m0, s71, 61440
v_mfma_f32_16x16x32_bf16 a[68:71], a[228:231], v[172:175], a[68:71]
v_exp_f32 v96, v96
v_mfma_f32_16x16x32_bf16 a[72:75], a[224:227], v[176:179], a[72:75]
buffer_load_dwordx4 v1, s[28:31], s43 offen sc1 lds
v_mfma_f32_16x16x32_bf16 a[72:75], a[228:231], v[180:183], a[72:75]
v_exp_f32 v97, v97
v_mfma_f32_16x16x32_bf16 a[76:79], a[224:227], v[184:187], a[76:79]
ds_read_b128 a[132:135], v3 offset:16384
v_cvt_pk_bf16_f32 v155, v94, v95
v_mfma_f32_16x16x32_bf16 a[76:79], a[228:231], v[188:191], a[76:79]
v_exp_f32 v98, v98
v_mfma_f32_16x16x32_bf16 a[80:83], a[232:235], v[160:163], a[80:83]
ds_read_b128 a[136:139], v4 offset:16384
v_cvt_pk_bf16_f32 v132, v96, v97
v_mfma_f32_16x16x32_bf16 a[80:83], a[236:239], v[164:167], a[80:83]
v_exp_f32 v99, v99
v_mfma_f32_16x16x32_bf16 a[84:87], a[232:235], v[168:171], a[84:87]
v_exp_f32 v100, v100
buffer_store_dword v61, v60, s[56:59], s92 offen sc1
v_mfma_f32_16x16x32_bf16 a[84:87], a[236:239], v[172:175], a[84:87]
ds_read_b128 a[140:143], v5 offset:16384
ds_read_b128 a[144:147], v2 offset:20480
v_mfma_f32_16x16x32_bf16 a[88:91], a[232:235], v[176:179], a[88:91]
v_exp_f32 v101, v101
v_mfma_f32_16x16x32_bf16 a[88:91], a[236:239], v[180:183], a[88:91]
v_cvt_pk_bf16_f32 v133, v98, v99
v_cvt_pk_bf16_f32 v140, v100, v101
v_mfma_f32_16x16x32_bf16 a[92:95], a[232:235], v[184:187], a[92:95]
v_exp_f32 v102, v102
buffer_load_dwordx4 v1, s[28:31], s43 offen offset:1024 sc1 lds
v_mfma_f32_16x16x32_bf16 a[92:95], a[236:239], v[188:191], a[92:95]
ds_read_b128 a[148:151], v3 offset:20480
v_smfmac_f32_16x16x64_bf16 v[48:51], v[20:23], v[176:183], v62
buffer_load_dwordx4 v1, s[28:31], s43 offen offset:2048 sc1 lds
v_mfma_f32_16x16x32_bf16 a[96:99], a[240:243], v[160:163], a[96:99]
v_exp_f32 v103, v103
v_mfma_f32_16x16x32_bf16 a[96:99], a[244:247], v[164:167], a[96:99]
v_exp_f32 v104, v104
v_mfma_f32_16x16x32_bf16 a[100:103], a[240:243], v[168:171], a[100:103]
ds_read_b128 a[152:155], v4 offset:20480
ds_read_b128 a[156:159], v5 offset:20480
v_mfma_f32_16x16x32_bf16 a[100:103], a[244:247], v[172:175], a[100:103]
v_exp_f32 v105, v105
v_mfma_f32_16x16x32_bf16 a[104:107], a[240:243], v[176:179], a[104:107]
v_cvt_pk_bf16_f32 v141, v102, v103
v_cvt_pk_bf16_f32 v148, v104, v105
v_mfma_f32_16x16x32_bf16 a[104:107], a[244:247], v[180:183], a[104:107]
v_exp_f32 v106, v106
v_mfma_f32_16x16x32_bf16 a[108:111], a[240:243], v[184:187], a[108:111]
ds_read_b128 a[160:163], v2 offset:24576
v_mfma_f32_16x16x32_bf16 a[108:111], a[244:247], v[188:191], a[108:111]
v_exp_f32 v107, v107
v_mfma_f32_16x16x32_bf16 a[112:115], a[248:251], v[160:163], a[112:115]
ds_read_b128 a[164:167], v3 offset:24576
v_cvt_pk_bf16_f32 v149, v106, v107
v_mfma_f32_16x16x32_bf16 a[112:115], a[252:255], v[164:167], a[112:115]
v_exp_f32 v108, v108
v_mfma_f32_16x16x32_bf16 a[116:119], a[248:251], v[168:171], a[116:119]
buffer_load_dwordx4 v1, s[28:31], s43 offen offset:3072 sc1 lds
v_mfma_f32_16x16x32_bf16 a[116:119], a[252:255], v[172:175], a[116:119]
v_exp_f32 v109, v109
v_mfma_f32_16x16x32_bf16 a[120:123], a[248:251], v[176:179], a[120:123]
ds_read_b128 a[168:171], v4 offset:24576
v_cvt_pk_bf16_f32 v156, v108, v109
v_mfma_f32_16x16x32_bf16 a[120:123], a[252:255], v[180:183], a[120:123]
v_exp_f32 v110, v110
v_mfma_f32_16x16x32_bf16 a[124:127], a[248:251], v[184:187], a[124:127]
ds_read_b128 a[172:175], v5 offset:24576
s_add_u32 m0, s71, 65536
v_mfma_f32_16x16x32_bf16 a[124:127], a[252:255], v[188:191], a[124:127]
v_exp_f32 v111, v111
v_smfmac_f32_16x16x64_bf16 v[52:55], v[20:23], v[184:191], v62
ds_read_b128 a[176:179], v2 offset:28672
buffer_load_dwordx4 v63, s[28:31], s43 offen sc1 lds
s_waitcnt lgkmcnt(5)
v_mfma_f32_16x16x32_bf16 v[64:67], a[128:131], v[192:195], v[24:27]
v_cvt_pk_bf16_f32 v157, v110, v111
s_and_b32 s67, s64, 15
v_mfma_f32_16x16x32_bf16 v[64:67], a[132:135], v[196:199], v[64:67]
v_exp_f32 v112, v112
v_mfma_f32_16x16x32_bf16 v[64:67], a[136:139], v[200:203], v[64:67]
ds_read_b128 a[180:183], v3 offset:28672
s_lshr_b64 s[64:65], s[64:65], 4
v_mfma_f32_16x16x32_bf16 v[64:67], a[140:143], v[204:207], v[64:67]
v_exp_f32 v113, v113
v_mfma_f32_16x16x32_bf16 v[68:71], a[128:131], v[208:211], v[28:31]
ds_read_b128 a[184:187], v4 offset:28672
v_cvt_pk_bf16_f32 v134, v112, v113
v_mfma_f32_16x16x32_bf16 v[68:71], a[132:135], v[212:215], v[68:71]
v_exp_f32 v114, v114
v_mfma_f32_16x16x32_bf16 v[68:71], a[136:139], v[216:219], v[68:71]
s_mul_i32 s42, s67, 442368
s_add_u32 s42, s42, s45
v_mfma_f32_16x16x32_bf16 v[68:71], a[140:143], v[220:223], v[68:71]
v_exp_f32 v115, v115
v_mfma_f32_16x16x32_bf16 v[72:75], a[128:131], v[224:227], v[32:35]
ds_read_b128 a[188:191], v5 offset:28672
v_cvt_pk_bf16_f32 v135, v114, v115
v_mfma_f32_16x16x32_bf16 v[72:75], a[132:135], v[228:231], v[72:75]
v_exp_f32 v116, v116
v_mfma_f32_16x16x32_bf16 v[72:75], a[136:139], v[232:235], v[72:75]
ds_read_b64_tr_b16 a[192:193], v6 offset:0
s_mov_b32 m0, s51
s_nop 0
buffer_load_dwordx4 v56, s[24:27], s42 offen offset:0 lds
v_mfma_f32_16x16x32_bf16 v[72:75], a[140:143], v[236:239], v[72:75]
v_exp_f32 v117, v117
v_mfma_f32_16x16x32_bf16 v[76:79], a[128:131], v[240:243], v[36:39]
ds_read_b64_tr_b16 a[194:195], v6 offset:4096
v_cvt_pk_bf16_f32 v142, v116, v117
v_mfma_f32_16x16x32_bf16 v[76:79], a[132:135], v[244:247], v[76:79]
v_exp_f32 v118, v118
v_mfma_f32_16x16x32_bf16 v[76:79], a[136:139], v[248:251], v[76:79]
buffer_load_dwordx4 v57, s[24:27], s42 offen offset:1024 lds
v_mfma_f32_16x16x32_bf16 v[76:79], a[140:143], v[252:255], v[76:79]
v_exp_f32 v119, v119
v_mfma_f32_16x16x32_bf16 v[80:83], a[144:147], v[192:195], v[24:27]
ds_read_b64_tr_b16 a[196:197], v6 offset:8192
v_cvt_pk_bf16_f32 v143, v118, v119
v_mfma_f32_16x16x32_bf16 v[80:83], a[148:151], v[196:199], v[80:83]
v_exp_f32 v120, v120
v_mfma_f32_16x16x32_bf16 v[80:83], a[152:155], v[200:203], v[80:83]
v_mfma_f32_16x16x32_bf16 v[80:83], a[156:159], v[204:207], v[80:83]
ds_read_b64_tr_b16 a[198:199], v6 offset:12288
v_mfma_f32_16x16x32_bf16 v[84:87], a[144:147], v[208:211], v[28:31]
v_exp_f32 v121, v121
v_mfma_f32_16x16x32_bf16 v[84:87], a[148:151], v[212:215], v[84:87]
v_exp_f32 v122, v122
v_mfma_f32_16x16x32_bf16 v[84:87], a[152:155], v[216:219], v[84:87]
ds_read_b64_tr_b16 a[200:201], v7 offset:0
v_cvt_pk_bf16_f32 v150, v120, v121
v_mfma_f32_16x16x32_bf16 v[84:87], a[156:159], v[220:223], v[84:87]
v_exp_f32 v123, v123
v_mfma_f32_16x16x32_bf16 v[88:91], a[144:147], v[224:227], v[32:35]
ds_read_b64_tr_b16 a[202:203], v7 offset:4096
v_cvt_pk_bf16_f32 v151, v122, v123
v_mfma_f32_16x16x32_bf16 v[88:91], a[148:151], v[228:231], v[88:91]
v_exp_f32 v124, v124
v_mfma_f32_16x16x32_bf16 v[88:91], a[152:155], v[232:235], v[88:91]
ds_read_b64_tr_b16 a[204:205], v7 offset:8192
v_mfma_f32_16x16x32_bf16 v[88:91], a[156:159], v[236:239], v[88:91]
v_exp_f32 v125, v125
v_mfma_f32_16x16x32_bf16 v[92:95], a[144:147], v[240:243], v[36:39]
ds_read_b64_tr_b16 a[206:207], v7 offset:12288
v_cvt_pk_bf16_f32 v158, v124, v125
v_mfma_f32_16x16x32_bf16 v[92:95], a[148:151], v[244:247], v[92:95]
v_exp_f32 v126, v126
v_mfma_f32_16x16x32_bf16 v[92:95], a[152:155], v[248:251], v[92:95]
buffer_load_dwordx4 v58, s[24:27], s42 offen offset:2048 lds
v_mfma_f32_16x16x32_bf16 v[92:95], a[156:159], v[252:255], v[92:95]
ds_read_b64_tr_b16 a[208:209], v8 offset:0
s_waitcnt lgkmcnt(9)
v_mfma_f32_16x16x32_bf16 v[96:99], a[160:163], v[192:195], v[24:27]
v_exp_f32 v127, v127
v_mfma_f32_16x16x32_bf16 v[96:99], a[164:167], v[196:199], v[96:99]
ds_read_b64_tr_b16 a[210:211], v8 offset:4096
v_cvt_pk_bf16_f32 v159, v126, v127
v_mfma_f32_16x16x32_bf16 v[96:99], a[168:171], v[200:203], v[96:99]
v_exp_f32 v64, v64
v_mfma_f32_16x16x32_bf16 v[96:99], a[172:175], v[204:207], v[96:99]
v_mfma_f32_16x16x32_bf16 v[100:103], a[160:163], v[208:211], v[28:31]
v_exp_f32 v65, v65
v_mfma_f32_16x16x32_bf16 v[100:103], a[164:167], v[212:215], v[100:103]
ds_read_b64_tr_b16 a[212:213], v8 offset:8192
v_cvt_pk_bf16_f32 v160, v64, v65
v_mfma_f32_16x16x32_bf16 v[100:103], a[168:171], v[216:219], v[100:103]
v_exp_f32 v66, v66
v_mfma_f32_16x16x32_bf16 v[100:103], a[172:175], v[220:223], v[100:103]
ds_read_b64_tr_b16 a[214:215], v8 offset:12288
v_mfma_f32_16x16x32_bf16 v[104:107], a[160:163], v[224:227], v[32:35]
v_exp_f32 v67, v67
v_mfma_f32_16x16x32_bf16 v[104:107], a[164:167], v[228:231], v[104:107]
ds_read_b64_tr_b16 a[216:217], v9 offset:0
v_cvt_pk_bf16_f32 v161, v66, v67
v_mfma_f32_16x16x32_bf16 v[104:107], a[168:171], v[232:235], v[104:107]
v_exp_f32 v68, v68
v_mfma_f32_16x16x32_bf16 v[104:107], a[172:175], v[236:239], v[104:107]
buffer_load_dwordx4 v59, s[24:27], s42 offen offset:3072 lds
v_mfma_f32_16x16x32_bf16 v[108:111], a[160:163], v[240:243], v[36:39]
v_exp_f32 v69, v69
v_mfma_f32_16x16x32_bf16 v[108:111], a[164:167], v[244:247], v[108:111]
ds_read_b64_tr_b16 a[218:219], v9 offset:4096
v_cvt_pk_bf16_f32 v168, v68, v69
v_mfma_f32_16x16x32_bf16 v[108:111], a[168:171], v[248:251], v[108:111]
v_exp_f32 v70, v70
v_mfma_f32_16x16x32_bf16 v[108:111], a[172:175], v[252:255], v[108:111]
ds_read_b64_tr_b16 a[220:221], v9 offset:8192
v_mfma_f32_16x16x32_bf16 v[112:115], a[176:179], v[192:195], v[24:27]
v_exp_f32 v71, v71
v_mfma_f32_16x16x32_bf16 v[112:115], a[180:183], v[196:199], v[112:115]
ds_read_b64_tr_b16 a[222:223], v9 offset:12288
v_cvt_pk_bf16_f32 v169, v70, v71
v_mfma_f32_16x16x32_bf16 v[112:115], a[184:187], v[200:203], v[112:115]
v_exp_f32 v72, v72
v_mfma_f32_16x16x32_bf16 v[112:115], a[188:191], v[204:207], v[112:115]
s_and_b32 s68, s64, 15
s_lshr_b64 s[64:65], s[64:65], 4
v_mfma_f32_16x16x32_bf16 v[116:119], a[176:179], v[208:211], v[28:31]
v_exp_f32 v73, v73
v_mfma_f32_16x16x32_bf16 v[116:119], a[180:183], v[212:215], v[116:119]
ds_read_b64_tr_b16 a[224:225], v10 offset:0
v_cvt_pk_bf16_f32 v176, v72, v73
v_mfma_f32_16x16x32_bf16 v[116:119], a[184:187], v[216:219], v[116:119]
v_exp_f32 v74, v74
v_mfma_f32_16x16x32_bf16 v[116:119], a[188:191], v[220:223], v[116:119]
s_mul_i32 s42, s68, 442368
s_add_u32 s42, s42, s45
v_mfma_f32_16x16x32_bf16 v[120:123], a[176:179], v[224:227], v[32:35]
v_exp_f32 v75, v75
v_mfma_f32_16x16x32_bf16 v[120:123], a[180:183], v[228:231], v[120:123]
ds_read_b64_tr_b16 a[226:227], v10 offset:4096
v_cvt_pk_bf16_f32 v177, v74, v75
v_mfma_f32_16x16x32_bf16 v[120:123], a[184:187], v[232:235], v[120:123]
v_exp_f32 v76, v76
s_mov_b32 m0, s48
s_nop 0
buffer_load_dwordx4 v56, s[24:27], s42 offen offset:0 lds
v_mfma_f32_16x16x32_bf16 v[120:123], a[188:191], v[236:239], v[120:123]
ds_read_b64_tr_b16 a[228:229], v10 offset:8192
v_mfma_f32_16x16x32_bf16 v[124:127], a[176:179], v[240:243], v[36:39]
v_exp_f32 v77, v77
v_mfma_f32_16x16x32_bf16 v[124:127], a[180:183], v[244:247], v[124:127]
ds_read_b64_tr_b16 a[230:231], v10 offset:12288
v_cvt_pk_bf16_f32 v184, v76, v77
v_mfma_f32_16x16x32_bf16 v[124:127], a[184:187], v[248:251], v[124:127]
v_exp_f32 v78, v78
v_mfma_f32_16x16x32_bf16 v[124:127], a[188:191], v[252:255], v[124:127]
ds_read_b64_tr_b16 a[232:233], v11 offset:0
s_waitcnt lgkmcnt(5)
v_mfma_f32_16x16x32_bf16 a[0:3], a[192:195], v[128:131], a[0:3]
v_exp_f32 v79, v79
v_mfma_f32_16x16x32_bf16 a[0:3], a[196:199], v[132:135], a[0:3]
ds_read_b64_tr_b16 a[234:235], v11 offset:4096
v_cvt_pk_bf16_f32 v185, v78, v79
v_mfma_f32_16x16x32_bf16 a[4:7], a[192:195], v[136:139], a[4:7]
buffer_load_dwordx4 v57, s[24:27], s42 offen offset:1024 lds
v_mfma_f32_16x16x32_bf16 a[4:7], a[196:199], v[140:143], a[4:7]
v_exp_f32 v80, v80
v_mfma_f32_16x16x32_bf16 a[8:11], a[192:195], v[144:147], a[8:11]
ds_read_b64_tr_b16 a[236:237], v11 offset:8192
v_lshrrev_b32 v33, 8, v1
v_mfma_f32_16x16x32_bf16 a[8:11], a[196:199], v[148:151], a[8:11]
v_exp_f32 v81, v81
v_mfma_f32_16x16x32_bf16 a[12:15], a[192:195], v[152:155], a[12:15]
v_cvt_pk_bf16_f32 v162, v80, v81
v_bfe_u32 v34, v1, 6, 2
v_mfma_f32_16x16x32_bf16 a[12:15], a[196:199], v[156:159], a[12:15]
v_exp_f32 v82, v82
v_mfma_f32_16x16x32_bf16 a[16:19], a[200:203], v[128:131], a[16:19]
ds_read_b64_tr_b16 a[238:239], v11 offset:12288
v_mfma_f32_16x16x32_bf16 a[16:19], a[204:207], v[132:135], a[16:19]
v_exp_f32 v83, v83
v_mfma_f32_16x16x32_bf16 a[20:23], a[200:203], v[136:139], a[20:23]
ds_read_b64_tr_b16 a[240:241], v12 offset:0
v_cvt_pk_bf16_f32 v163, v82, v83
v_mfma_f32_16x16x32_bf16 a[20:23], a[204:207], v[140:143], a[20:23]
v_exp_f32 v84, v84
v_mfma_f32_16x16x32_bf16 a[24:27], a[200:203], v[144:147], a[24:27]
ds_read_b64_tr_b16 a[242:243], v12 offset:4096
v_mfma_f32_16x16x32_bf16 a[24:27], a[204:207], v[148:151], a[24:27]
v_exp_f32 v85, v85
v_mfma_f32_16x16x32_bf16 a[28:31], a[200:203], v[152:155], a[28:31]
v_cvt_pk_bf16_f32 v170, v84, v85
v_mfma_f32_16x16x32_bf16 a[28:31], a[204:207], v[156:159], a[28:31]
v_exp_f32 v86, v86
v_smfmac_f32_16x16x64_bf16 v[40:43], v[20:23], v[128:135], v62
ds_read_b64_tr_b16 a[244:245], v12 offset:8192
v_mfma_f32_16x16x32_bf16 a[32:35], a[208:211], v[128:131], a[32:35]
v_exp_f32 v87, v87
v_mfma_f32_16x16x32_bf16 a[32:35], a[212:215], v[132:135], a[32:35]
ds_read_b64_tr_b16 a[246:247], v12 offset:12288
v_cvt_pk_bf16_f32 v171, v86, v87
buffer_load_dwordx4 v58, s[24:27], s42 offen offset:2048 lds
v_lshl_add_u32 v34, v33, 3, v34
v_mfma_f32_16x16x32_bf16 a[36:39], a[208:211], v[136:139], a[36:39]
v_exp_f32 v88, v88
v_mfma_f32_16x16x32_bf16 a[36:39], a[212:215], v[140:143], a[36:39]
ds_read_b64_tr_b16 a[248:249], v13 offset:0
v_lshlrev_b32 v34, 7, v34
v_mfma_f32_16x16x32_bf16 a[40:43], a[208:211], v[144:147], a[40:43]
v_exp_f32 v89, v89
v_mfma_f32_16x16x32_bf16 a[40:43], a[212:215], v[148:151], a[40:43]
v_cvt_pk_bf16_f32 v178, v88, v89
v_bfe_u32 v35, v1, 4, 2
v_mfma_f32_16x16x32_bf16 a[44:47], a[208:211], v[152:155], a[44:47]
v_exp_f32 v90, v90
v_mfma_f32_16x16x32_bf16 a[44:47], a[212:215], v[156:159], a[44:47]
ds_read_b64_tr_b16 a[250:251], v13 offset:4096
v_lshl_add_u32 v34, v35, 3, v34
v_mfma_f32_16x16x32_bf16 a[48:51], a[216:219], v[128:131], a[48:51]
v_exp_f32 v91, v91
v_mfma_f32_16x16x32_bf16 a[48:51], a[220:223], v[132:135], a[48:51]
ds_read_b64_tr_b16 a[252:253], v13 offset:8192
v_cvt_pk_bf16_f32 v179, v90, v91
v_bfe_u32 v35, v1, 7, 1
v_mfma_f32_16x16x32_bf16 a[52:55], a[216:219], v[136:139], a[52:55]
v_exp_f32 v92, v92
v_mfma_f32_16x16x32_bf16 a[52:55], a[220:223], v[140:143], a[52:55]
ds_read_b64_tr_b16 a[254:255], v13 offset:12288
v_and_b32 v37, 1, v33
v_mfma_f32_16x16x32_bf16 a[56:59], a[216:219], v[144:147], a[56:59]
v_exp_f32 v93, v93
v_mfma_f32_16x16x32_bf16 a[56:59], a[220:223], v[148:151], a[56:59]
v_cvt_pk_bf16_f32 v186, v92, v93
buffer_load_dwordx4 v59, s[24:27], s42 offen offset:3072 lds
v_lshl_or_b32 v35, v37, 1, v35
v_mfma_f32_16x16x32_bf16 a[60:63], a[216:219], v[152:155], a[60:63]
v_exp_f32 v94, v94
v_mfma_f32_16x16x32_bf16 a[60:63], a[220:223], v[156:159], a[60:63]
s_and_b32 s92, s40, 1
s_lshl_b32 s92, s92, 1
v_smfmac_f32_16x16x64_bf16 v[44:47], v[20:23], v[136:143], v62
v_xor_b32 v35, s92, v35
v_lshl_add_u32 v24, v35, 5, v34
s_waitcnt lgkmcnt(0)
v_mfma_f32_16x16x32_bf16 a[64:67], a[224:227], v[128:131], a[64:67]
s_waitcnt vmcnt(18)
s_barrier
v_mfma_f32_16x16x32_bf16 a[64:67], a[228:231], v[132:135], a[64:67]
v_exp_f32 v95, v95
v_mfma_f32_16x16x32_bf16 a[68:71], a[224:227], v[136:139], a[68:71]
v_xor_b32 v35, 1, v35
v_lshl_add_u32 v25, v35, 5, v34
v_mfma_f32_16x16x32_bf16 a[68:71], a[228:231], v[140:143], a[68:71]
v_exp_f32 v96, v96
v_mfma_f32_16x16x32_bf16 a[72:75], a[224:227], v[144:147], a[72:75]
s_lshl_b32 s92, s92, 5
s_mul_i32 s43, s67, 20480
v_mfma_f32_16x16x32_bf16 a[72:75], a[228:231], v[148:151], a[72:75]
v_exp_f32 v97, v97
v_mfma_f32_16x16x32_bf16 a[76:79], a[224:227], v[152:155], a[76:79]
v_cvt_pk_bf16_f32 v187, v94, v95
s_add_u32 s43, s43, s46
v_mfma_f32_16x16x32_bf16 a[76:79], a[228:231], v[156:159], a[76:79]
v_exp_f32 v98, v98
v_mfma_f32_16x16x32_bf16 a[80:83], a[232:235], v[128:131], a[80:83]
v_cvt_pk_bf16_f32 v164, v96, v97
s_add_u32 m0, s71, 40960
v_mfma_f32_16x16x32_bf16 a[80:83], a[236:239], v[132:135], a[80:83]
v_exp_f32 v99, v99
v_mfma_f32_16x16x32_bf16 a[84:87], a[232:235], v[136:139], a[84:87]
v_exp_f32 v100, v100
v_mfma_f32_16x16x32_bf16 a[84:87], a[236:239], v[140:143], a[84:87]
buffer_load_dwordx4 v1, s[28:31], s43 offen sc1 lds
v_mfma_f32_16x16x32_bf16 a[88:91], a[232:235], v[144:147], a[88:91]
v_exp_f32 v101, v101
v_lshl_add_u32 v32, v33, 3, s92
v_mfma_f32_16x16x32_bf16 a[88:91], a[236:239], v[148:151], a[88:91]
v_cvt_pk_bf16_f32 v165, v98, v99
v_cvt_pk_bf16_f32 v172, v100, v101
buffer_load_dwordx4 v1, s[28:31], s43 offen offset:1024 sc1 lds
v_mfma_f32_16x16x32_bf16 a[92:95], a[232:235], v[152:155], a[92:95]
v_exp_f32 v102, v102
s_lshr_b32 s92, s40, 1
v_mfma_f32_16x16x32_bf16 a[92:95], a[236:239], v[156:159], a[92:95]
buffer_load_dwordx4 v1, s[28:31], s43 offen offset:2048 sc1 lds
v_smfmac_f32_16x16x64_bf16 v[48:51], v[20:23], v[144:151], v62
s_mul_i32 s93, s92, 3072
s_add_u32 s93, s93, 81920
v_mfma_f32_16x16x32_bf16 a[96:99], a[240:243], v[128:131], a[96:99]
v_exp_f32 v103, v103
v_mfma_f32_16x16x32_bf16 a[96:99], a[244:247], v[132:135], a[96:99]
v_exp_f32 v104, v104
buffer_load_dwordx4 v1, s[28:31], s43 offen offset:3072 sc1 lds
v_mfma_f32_16x16x32_bf16 a[100:103], a[240:243], v[136:139], a[100:103]
v_add_u32 v26, s93, v1
s_add_u32 m0, s71, 45056
v_mfma_f32_16x16x32_bf16 a[100:103], a[244:247], v[140:143], a[100:103]
v_exp_f32 v105, v105
buffer_load_dwordx4 v63, s[28:31], s43 offen sc1 lds
v_mfma_f32_16x16x32_bf16 a[104:107], a[240:243], v[144:147], a[104:107]
v_cvt_pk_bf16_f32 v173, v102, v103
v_cvt_pk_bf16_f32 v180, v104, v105
v_mfma_f32_16x16x32_bf16 a[104:107], a[244:247], v[148:151], a[104:107]
v_exp_f32 v106, v106
s_lshl_b32 s93, s92, 11
ds_read_b64_tr_b16 a[192:193], v6 offset:16384
v_mfma_f32_16x16x32_bf16 a[108:111], a[240:243], v[152:155], a[108:111]
s_add_u32 s93, s93, 83968
ds_read_b64_tr_b16 a[194:195], v6 offset:20480
v_mfma_f32_16x16x32_bf16 a[108:111], a[244:247], v[156:159], a[108:111]
v_exp_f32 v107, v107
v_mfma_f32_16x16x32_bf16 a[112:115], a[248:251], v[128:131], a[112:115]
v_cvt_pk_bf16_f32 v181, v106, v107
v_add_u32 v27, s93, v1
v_mfma_f32_16x16x32_bf16 a[112:115], a[252:255], v[132:135], a[112:115]
v_exp_f32 v108, v108
v_mfma_f32_16x16x32_bf16 a[116:119], a[248:251], v[136:139], a[116:119]
ds_read_b64_tr_b16 a[200:201], v7 offset:16384
v_add_u32 v28, 32768, v24
v_mfma_f32_16x16x32_bf16 a[116:119], a[252:255], v[140:143], a[116:119]
v_exp_f32 v109, v109
v_mfma_f32_16x16x32_bf16 a[120:123], a[248:251], v[144:147], a[120:123]
v_cvt_pk_bf16_f32 v188, v108, v109
v_add_u32 v29, 32768, v25
v_mfma_f32_16x16x32_bf16 a[120:123], a[252:255], v[148:151], a[120:123]
v_exp_f32 v110, v110
ds_read_b64_tr_b16 a[202:203], v7 offset:20480
v_mfma_f32_16x16x32_bf16 a[124:127], a[248:251], v[152:155], a[124:127]
v_add_u32 v30, 61440, v26
ds_read_b64_tr_b16 a[208:209], v8 offset:16384
v_mfma_f32_16x16x32_bf16 a[124:127], a[252:255], v[156:159], a[124:127]
v_exp_f32 v111, v111
v_smfmac_f32_16x16x64_bf16 v[52:55], v[20:23], v[152:159], v62
v_add_u32 v31, 61440, v27
ds_read_b64_tr_b16 a[210:211], v8 offset:20480
buffer_load_dwordx2 v[34:35], v32, s[36:39], 0 offen offset:0
ds_read_b64_tr_b16 a[216:217], v9 offset:16384
buffer_load_dwordx2 v[36:37], v32, s[36:39], 0 offen offset:32
ds_read_b64_tr_b16 a[218:219], v9 offset:20480
s_waitcnt lgkmcnt(6)
v_mfma_f32_16x16x32_bf16 a[0:3], a[192:195], v[160:163], a[0:3]
ds_read_b64_tr_b16 a[224:225], v10 offset:16384
v_cvt_pk_bf16_f32 v189, v110, v111
v_mfma_f32_16x16x32_bf16 a[4:7], a[192:195], v[168:171], a[4:7]
ds_read_b64_tr_b16 a[226:227], v10 offset:20480
v_mfma_f32_16x16x32_bf16 a[8:11], a[192:195], v[176:179], a[8:11]
v_exp_f32 v112, v112
v_mfma_f32_16x16x32_bf16 a[12:15], a[192:195], v[184:187], a[12:15]
ds_read_b64_tr_b16 a[232:233], v11 offset:16384
s_waitcnt lgkmcnt(7)
v_mfma_f32_16x16x32_bf16 a[16:19], a[200:203], v[160:163], a[16:19]
v_exp_f32 v113, v113
v_mfma_f32_16x16x32_bf16 a[20:23], a[200:203], v[168:171], a[20:23]
v_cvt_pk_bf16_f32 v166, v112, v113
ds_read_b64_tr_b16 a[234:235], v11 offset:20480
v_mfma_f32_16x16x32_bf16 a[24:27], a[200:203], v[176:179], a[24:27]
v_exp_f32 v114, v114
s_mul_i32 s43, s68, 20480
s_add_u32 s43, s43, s46
s_add_u32 m0, s71, 20480
s_nop 0
buffer_load_dwordx4 v1, s[28:31], s43 offen sc1 lds
v_mfma_f32_16x16x32_bf16 a[28:31], a[200:203], v[184:187], a[28:31]
ds_read_b64_tr_b16 a[240:241], v12 offset:16384
ds_read_b64_tr_b16 a[242:243], v12 offset:20480
s_waitcnt lgkmcnt(8)
v_mfma_f32_16x16x32_bf16 a[32:35], a[208:211], v[160:163], a[32:35]
v_exp_f32 v115, v115
v_mfma_f32_16x16x32_bf16 a[36:39], a[208:211], v[168:171], a[36:39]
v_cvt_pk_bf16_f32 v167, v114, v115
ds_read_b64_tr_b16 a[248:249], v13 offset:16384
v_mfma_f32_16x16x32_bf16 a[40:43], a[208:211], v[176:179], a[40:43]
v_exp_f32 v116, v116
v_mfma_f32_16x16x32_bf16 a[44:47], a[208:211], v[184:187], a[44:47]
ds_read_b64_tr_b16 a[250:251], v13 offset:20480
v_exp_f32 v117, v117
s_waitcnt lgkmcnt(8)
v_mfma_f32_16x16x32_bf16 a[48:51], a[216:219], v[160:163], a[48:51]
v_cvt_pk_bf16_f32 v174, v116, v117
buffer_load_dwordx4 v1, s[28:31], s43 offen offset:1024 sc1 lds
v_mfma_f32_16x16x32_bf16 a[52:55], a[216:219], v[168:171], a[52:55]
v_exp_f32 v118, v118
v_mfma_f32_16x16x32_bf16 a[56:59], a[216:219], v[176:179], a[56:59]
v_exp_f32 v119, v119
v_mfma_f32_16x16x32_bf16 a[60:63], a[216:219], v[184:187], a[60:63]
v_cvt_pk_bf16_f32 v175, v118, v119
ds_read_b64_tr_b16 a[196:197], v6 offset:24576
s_waitcnt lgkmcnt(7)
v_mfma_f32_16x16x32_bf16 a[64:67], a[224:227], v[160:163], a[64:67]
v_exp_f32 v120, v120
v_mfma_f32_16x16x32_bf16 a[68:71], a[224:227], v[168:171], a[68:71]
v_exp_f32 v121, v121
v_mfma_f32_16x16x32_bf16 a[72:75], a[224:227], v[176:179], a[72:75]
ds_read_b64_tr_b16 a[198:199], v6 offset:28672
v_mfma_f32_16x16x32_bf16 a[76:79], a[224:227], v[184:187], a[76:79]
buffer_load_dwordx4 v1, s[28:31], s43 offen offset:2048 sc1 lds
s_waitcnt lgkmcnt(6)
v_mfma_f32_16x16x32_bf16 a[80:83], a[232:235], v[160:163], a[80:83]
v_exp_f32 v122, v122
ds_read_b64_tr_b16 a[204:205], v7 offset:24576
v_mfma_f32_16x16x32_bf16 a[84:87], a[232:235], v[168:171], a[84:87]
v_cvt_pk_bf16_f32 v182, v120, v121
v_mfma_f32_16x16x32_bf16 a[88:91], a[232:235], v[176:179], a[88:91]
v_exp_f32 v123, v123
ds_read_b64_tr_b16 a[206:207], v7 offset:28672
v_mfma_f32_16x16x32_bf16 a[92:95], a[232:235], v[184:187], a[92:95]
v_cvt_pk_bf16_f32 v183, v122, v123
s_waitcnt lgkmcnt(6)
v_mfma_f32_16x16x32_bf16 a[96:99], a[240:243], v[160:163], a[96:99]
v_exp_f32 v124, v124
ds_read_b64_tr_b16 a[212:213], v8 offset:24576
v_mfma_f32_16x16x32_bf16 a[100:103], a[240:243], v[168:171], a[100:103]
v_exp_f32 v125, v125
v_mfma_f32_16x16x32_bf16 a[104:107], a[240:243], v[176:179], a[104:107]
ds_read_b64_tr_b16 a[214:215], v8 offset:28672
buffer_load_dwordx4 v1, s[28:31], s43 offen offset:3072 sc1 lds
v_mfma_f32_16x16x32_bf16 a[108:111], a[240:243], v[184:187], a[108:111]
v_cvt_pk_bf16_f32 v190, v124, v125
s_waitcnt lgkmcnt(6)
v_mfma_f32_16x16x32_bf16 a[112:115], a[248:251], v[160:163], a[112:115]
v_exp_f32 v126, v126
v_mfma_f32_16x16x32_bf16 a[116:119], a[248:251], v[168:171], a[116:119]
v_exp_f32 v127, v127
ds_read_b64_tr_b16 a[220:221], v9 offset:24576
v_mfma_f32_16x16x32_bf16 a[120:123], a[248:251], v[176:179], a[120:123]
v_cvt_pk_bf16_f32 v191, v126, v127
ds_read_b64_tr_b16 a[222:223], v9 offset:28672
v_mfma_f32_16x16x32_bf16 a[124:127], a[248:251], v[184:187], a[124:127]
ds_read_b64_tr_b16 a[228:229], v10 offset:24576
s_add_u32 m0, s71, 24576
v_smfmac_f32_16x16x64_bf16 v[40:43], v[20:23], v[160:167], v62
buffer_load_dwordx4 v63, s[28:31], s43 offen sc1 lds
v_smfmac_f32_16x16x64_bf16 v[44:47], v[20:23], v[168:175], v62
ds_read_b64_tr_b16 a[230:231], v10 offset:28672
v_smfmac_f32_16x16x64_bf16 v[48:51], v[20:23], v[176:183], v62
v_smfmac_f32_16x16x64_bf16 v[52:55], v[20:23], v[184:191], v62
ds_read_b64_tr_b16 a[236:237], v11 offset:24576
s_waitcnt lgkmcnt(9)
v_mfma_f32_16x16x32_bf16 a[0:3], a[196:199], v[164:167], a[0:3]
v_mfma_f32_16x16x32_bf16 a[4:7], a[196:199], v[172:175], a[4:7]
s_and_b32 s69, s64, 15
s_lshr_b64 s[64:65], s[64:65], 4
v_mfma_f32_16x16x32_bf16 a[8:11], a[196:199], v[180:183], a[8:11]
s_mul_i32 s42, s69, 442368
s_add_u32 s42, s42, s45
v_mfma_f32_16x16x32_bf16 a[12:15], a[196:199], v[188:191], a[12:15]
s_mov_b32 m0, s49
s_nop 0
buffer_load_dwordx4 v56, s[24:27], s42 offen offset:0 lds
s_waitcnt lgkmcnt(7)
v_mfma_f32_16x16x32_bf16 a[16:19], a[204:207], v[164:167], a[16:19]
ds_read_b64_tr_b16 a[238:239], v11 offset:28672
ds_read_b64_tr_b16 a[244:245], v12 offset:24576
v_mfma_f32_16x16x32_bf16 a[20:23], a[204:207], v[172:175], a[20:23]
v_add_f32 v40, v40, v41
v_add_f32 v44, v44, v45
v_mfma_f32_16x16x32_bf16 a[24:27], a[204:207], v[180:183], a[24:27]
ds_read_b64_tr_b16 a[246:247], v12 offset:28672
v_add_f32 v48, v48, v49
v_mfma_f32_16x16x32_bf16 a[28:31], a[204:207], v[188:191], a[28:31]
v_add_f32 v52, v52, v53
v_mov_b32 v41, v40
s_waitcnt lgkmcnt(8)
v_mfma_f32_16x16x32_bf16 a[32:35], a[212:215], v[164:167], a[32:35]
v_mov_b32 v45, v44
ds_read_b64_tr_b16 a[252:253], v13 offset:24576
v_mfma_f32_16x16x32_bf16 a[36:39], a[212:215], v[172:175], a[36:39]
v_mov_b32 v49, v48
v_mfma_f32_16x16x32_bf16 a[40:43], a[212:215], v[180:183], a[40:43]
buffer_load_dwordx4 v57, s[24:27], s42 offen offset:1024 lds
v_mfma_f32_16x16x32_bf16 a[44:47], a[212:215], v[188:191], a[44:47]
v_mov_b32 v53, v52
v_permlane32_swap_b32 v40, v41
s_waitcnt lgkmcnt(7)
v_mfma_f32_16x16x32_bf16 a[48:51], a[220:223], v[164:167], a[48:51]
ds_read_b64_tr_b16 a[254:255], v13 offset:28672
v_permlane32_swap_b32 v44, v45
v_permlane32_swap_b32 v48, v49
v_mfma_f32_16x16x32_bf16 a[52:55], a[220:223], v[172:175], a[52:55]
v_permlane32_swap_b32 v52, v53
v_add_f32 v40, v40, v41
v_mfma_f32_16x16x32_bf16 a[56:59], a[220:223], v[180:183], a[56:59]
v_add_f32 v44, v44, v45
v_add_f32 v48, v48, v49
v_mfma_f32_16x16x32_bf16 a[60:63], a[220:223], v[188:191], a[60:63]
v_add_f32 v52, v52, v53
v_mov_b32 v41, v40
s_waitcnt lgkmcnt(6)
v_mfma_f32_16x16x32_bf16 a[64:67], a[228:231], v[164:167], a[64:67]
v_mov_b32 v45, v44
v_mov_b32 v49, v48
v_mfma_f32_16x16x32_bf16 a[68:71], a[228:231], v[172:175], a[68:71]
buffer_load_dwordx4 v58, s[24:27], s42 offen offset:2048 lds
v_mfma_f32_16x16x32_bf16 a[72:75], a[228:231], v[180:183], a[72:75]
v_mov_b32 v53, v52
v_permlane16_swap_b32 v40, v41
v_mfma_f32_16x16x32_bf16 a[76:79], a[228:231], v[188:191], a[76:79]
v_permlane16_swap_b32 v44, v45
v_permlane16_swap_b32 v48, v49
s_waitcnt lgkmcnt(4)
v_mfma_f32_16x16x32_bf16 a[80:83], a[236:239], v[164:167], a[80:83]
v_permlane16_swap_b32 v52, v53
v_add_f32 v40, v40, v41
v_mfma_f32_16x16x32_bf16 a[84:87], a[236:239], v[172:175], a[84:87]
v_add_f32 v44, v44, v45
v_add_f32 v48, v48, v49
v_mfma_f32_16x16x32_bf16 a[88:91], a[236:239], v[180:183], a[88:91]
v_add_f32 v52, v52, v53
v_add_f32 v33, v40, v44
v_mfma_f32_16x16x32_bf16 a[92:95], a[236:239], v[188:191], a[92:95]
v_add_f32 v61, v48, v52
v_add_f32 v61, v61, v33
s_waitcnt lgkmcnt(2)
v_mfma_f32_16x16x32_bf16 a[96:99], a[244:247], v[164:167], a[96:99]
buffer_load_dwordx4 v59, s[24:27], s42 offen offset:3072 lds
v_mfma_f32_16x16x32_bf16 a[100:103], a[244:247], v[172:175], a[100:103]
v_mov_b32 v60, 0x5d800000
s_lshl_b32 s94, s40, 2
v_mfma_f32_16x16x32_bf16 a[104:107], a[244:247], v[180:183], a[104:107]
s_add_u32 s94, s94, 65536
v_cmp_nle_f32 vcc, v61, v60
v_mfma_f32_16x16x32_bf16 a[108:111], a[244:247], v[188:191], a[108:111]
v_mov_b32 v33, s94
s_waitcnt lgkmcnt(0)
v_mfma_f32_16x16x32_bf16 a[112:115], a[252:255], v[164:167], a[112:115]
v_rcp_f32 v40, v40
v_rcp_f32 v44, v44
v_mfma_f32_16x16x32_bf16 a[116:119], a[252:255], v[172:175], a[116:119]
v_rcp_f32 v48, v48
v_mfma_f32_16x16x32_bf16 a[120:123], a[252:255], v[180:183], a[120:123]
v_rcp_f32 v52, v52
s_or_b32 s92, vcc_lo, vcc_hi
v_mfma_f32_16x16x32_bf16 a[124:127], a[252:255], v[188:191], a[124:127]
v_mov_b32 v61, s92
ds_write_b32 v33, v61
v_mov_b32 v33, 65536
s_waitcnt vmcnt(24)
s_waitcnt lgkmcnt(0)
s_barrier
ds_read_b128 v[64:67], v33
ds_read_b64_tr_b16 a[176:177], v28 offset:0
ds_read_b64_tr_b16 a[178:179], v28 offset:512
ds_read_b128 a[208:211], v30 offset:0
ds_read_b64_tr_b16 a[180:181], v28 offset:4096
ds_read_b64_tr_b16 a[182:183], v28 offset:4608
ds_read_b128 a[212:215], v30 offset:5120
ds_read_b64_tr_b16 a[184:185], v28 offset:8192
ds_read_b64_tr_b16 a[186:187], v28 offset:8704
ds_read_b128 a[216:219], v30 offset:10240
ds_read_b64_tr_b16 a[188:189], v28 offset:12288
ds_read_b64_tr_b16 a[190:191], v28 offset:12800
ds_read_b128 a[220:223], v30 offset:15360
ds_read_b64_tr_b16 a[192:193], v29 offset:0
ds_read_b64_tr_b16 a[194:195], v29 offset:512
ds_read_b64_tr_b16 a[196:197], v29 offset:4096
ds_read_b64_tr_b16 a[198:199], v29 offset:4608
ds_read_b64_tr_b16 a[200:201], v29 offset:8192
ds_read_b64_tr_b16 a[202:203], v29 offset:8704
ds_read_b64_tr_b16 a[204:205], v29 offset:12288
ds_read_b64_tr_b16 a[206:207], v29 offset:12800
ds_read_b128 a[224:227], v30 offset:1024
ds_read_b128 a[228:231], v30 offset:6144
ds_read_b128 a[232:235], v30 offset:11264
ds_read_b128 a[236:239], v30 offset:16384
ds_read_b128 a[240:243], v31 offset:0
ds_read_b128 a[244:247], v31 offset:5120
ds_read_b128 a[248:251], v31 offset:10240
ds_read_b128 a[252:255], v31 offset:15360
s_mul_i32 s43, s69, 20480
s_add_u32 s43, s43, s46
s_add_u32 m0, s71, 0
s_nop 0
buffer_load_dwordx4 v1, s[28:31], s43 offen sc1 lds
buffer_load_dwordx4 v1, s[28:31], s43 offen offset:1024 sc1 lds
buffer_load_dwordx4 v1, s[28:31], s43 offen offset:2048 sc1 lds
buffer_load_dwordx4 v1, s[28:31], s43 offen offset:3072 sc1 lds
s_add_u32 m0, s71, 4096
s_nop 0
buffer_load_dwordx4 v63, s[28:31], s43 offen sc1 lds
s_waitcnt vmcnt(15)
v_lshlrev_b32 v148, 16, v34
v_and_b32 v149, 0xffff0000, v34
v_lshlrev_b32 v150, 16, v35
v_and_b32 v151, 0xffff0000, v35
s_waitcnt vmcnt(14)
v_lshlrev_b32 v152, 16, v36
v_and_b32 v153, 0xffff0000, v36
v_lshlrev_b32 v154, 16, v37
v_and_b32 v155, 0xffff0000, v37
s_waitcnt lgkmcnt(15)
v_or_b32 v64, v64, v65
v_or3_b32 v64, v64, v66, v67
s_nop 0
v_readfirstlane_b32 s92, v64
s_nop 3
s_cmp_eq_u32 s92, 0
s_cbranch_scc1 L_at_ok
s_cmp_eq_u32 s44, 0
s_cbranch_scc1 L_at_retry
L_at_ok:
s_mov_b32 s49, 32768
s_mov_b32 s50, 61440
v_mfma_f32_16x16x32_bf16 v[192:195], a[176:179], a[208:211], v[148:151]
s_mov_b32 s95, 0
v_accvgpr_read_b32 v64, a0
v_accvgpr_read_b32 v65, a1
v_accvgpr_read_b32 v66, a2
v_accvgpr_read_b32 v67, a3
v_accvgpr_read_b32 v68, a16
v_accvgpr_read_b32 v69, a17
s_add_u32 s51, s49, s48
s_add_u32 s62, s50, s71
v_mfma_f32_16x16x32_bf16 v[192:195], a[180:183], a[212:215], v[192:195]
v_accvgpr_read_b32 v70, a18
v_accvgpr_read_b32 v71, a19
v_pk_mul_f32 v[64:65], v[64:65], v[40:41] op_sel_hi:[1,0]
v_pk_mul_f32 v[66:67], v[66:67], v[40:41] op_sel_hi:[1,0]
v_pk_mul_f32 v[68:69], v[68:69], v[40:41] op_sel_hi:[1,0]
v_pk_mul_f32 v[70:71], v[70:71], v[40:41] op_sel_hi:[1,0]
v_cvt_pk_bf16_f32 v128, v64, v65
s_and_b32 s63, s64, 15
s_lshr_b64 s[64:65], s[64:65], 4
v_mfma_f32_16x16x32_bf16 v[192:195], a[184:187], a[216:219], v[192:195]
v_cvt_pk_bf16_f32 v129, v66, v67
v_cvt_pk_bf16_f32 v130, v68, v69
v_cvt_pk_bf16_f32 v131, v70, v71
buffer_store_dwordx4 v[128:131], v1, s[20:23], s95 offen offset:0 sc1
v_accvgpr_read_b32 v72, a4
v_accvgpr_read_b32 v73, a5
s_mul_i32 s42, s63, 442368
v_mfma_f32_16x16x32_bf16 v[192:195], a[188:191], a[220:223], v[192:195]
v_accvgpr_read_b32 v74, a6
v_accvgpr_read_b32 v75, a7
v_accvgpr_read_b32 v76, a20
v_accvgpr_read_b32 v77, a21
v_accvgpr_read_b32 v78, a22
v_accvgpr_read_b32 v79, a23
v_pk_mul_f32 v[72:73], v[72:73], v[44:45] op_sel_hi:[1,0]
s_mul_i32 s66, s63, 20480
s_add_u32 s42, s42, s45
s_waitcnt lgkmcnt(8)
v_mfma_f32_16x16x32_bf16 v[196:199], a[192:195], a[208:211], v[152:155]
v_pk_mul_f32 v[74:75], v[74:75], v[44:45] op_sel_hi:[1,0]
v_pk_mul_f32 v[76:77], v[76:77], v[44:45] op_sel_hi:[1,0]
v_pk_mul_f32 v[78:79], v[78:79], v[44:45] op_sel_hi:[1,0]
v_cvt_pk_bf16_f32 v132, v72, v73
v_cvt_pk_bf16_f32 v133, v74, v75
v_cvt_pk_bf16_f32 v134, v76, v77
s_add_u32 s49, s49, 16384
s_and_b32 s49, s49, 0xffff
v_mfma_f32_16x16x32_bf16 v[196:199], a[196:199], a[212:215], v[196:199]
v_cvt_pk_bf16_f32 v135, v78, v79
buffer_store_dwordx4 v[132:135], v1, s[20:23], s95 offen offset:1024 sc1
v_accvgpr_read_b32 v80, a8
v_accvgpr_read_b32 v81, a9
v_accvgpr_read_b32 v82, a10
v_accvgpr_read_b32 v83, a11
v_accvgpr_read_b32 v84, a24
s_sub_u32 s50, s50, 20480
s_cselect_b32 s50, 61440, s50
v_mfma_f32_16x16x32_bf16 v[196:199], a[200:203], a[216:219], v[196:199]
v_accvgpr_read_b32 v85, a25
v_accvgpr_read_b32 v86, a26
v_accvgpr_read_b32 v87, a27
v_pk_mul_f32 v[80:81], v[80:81], v[48:49] op_sel_hi:[1,0]
v_pk_mul_f32 v[82:83], v[82:83], v[48:49] op_sel_hi:[1,0]
v_pk_mul_f32 v[84:85], v[84:85], v[48:49] op_sel_hi:[1,0]
v_add_u32 v28, s49, v24
v_add_u32 v29, s49, v25
v_add_u32 v30, s50, v26
v_add_u32 v31, s50, v27
v_mfma_f32_16x16x32_bf16 v[196:199], a[204:207], a[220:223], v[196:199]
s_mov_b32 s44, s62
s_add_u32 s43, s66, s46
s_waitcnt lgkmcnt(0)
s_barrier
s_mov_b32 m0, s51
s_nop 0
buffer_load_dwordx4 v56, s[24:27], s42 offen offset:0 lds
v_mfma_f32_16x16x32_bf16 v[200:203], a[176:179], a[224:227], v[148:151]
ds_read_b64_tr_b16 a[128:129], v28 offset:0
ds_read_b64_tr_b16 a[130:131], v28 offset:512
v_pk_mul_f32 v[86:87], v[86:87], v[48:49] op_sel_hi:[1,0]
v_cvt_pk_bf16_f32 v136, v80, v81
v_cvt_pk_bf16_f32 v137, v82, v83
v_mfma_f32_16x16x32_bf16 v[200:203], a[180:183], a[228:231], v[200:203]
ds_read_b128 a[160:163], v30 offset:0
ds_read_b64_tr_b16 a[132:133], v28 offset:4096
v_cvt_pk_bf16_f32 v138, v84, v85
v_cvt_pk_bf16_f32 v139, v86, v87
buffer_store_dwordx4 v[136:139], v1, s[20:23], s95 offen offset:2048 sc1
v_mfma_f32_16x16x32_bf16 v[200:203], a[184:187], a[232:235], v[200:203]
buffer_load_dwordx4 v57, s[24:27], s42 offen offset:1024 lds
ds_read_b64_tr_b16 a[134:135], v28 offset:4608
ds_read_b128 a[164:167], v30 offset:5120
v_accvgpr_read_b32 v88, a12
v_accvgpr_read_b32 v89, a13
v_accvgpr_read_b32 v90, a14
v_mfma_f32_16x16x32_bf16 v[200:203], a[188:191], a[236:239], v[200:203]
ds_read_b64_tr_b16 a[136:137], v28 offset:8192
ds_read_b64_tr_b16 a[138:139], v28 offset:8704
v_accvgpr_read_b32 v91, a15
v_accvgpr_read_b32 v92, a28
v_accvgpr_read_b32 v93, a29
v_mfma_f32_16x16x32_bf16 v[204:207], a[192:195], a[224:227], v[152:155]
buffer_load_dwordx4 v58, s[24:27], s42 offen offset:2048 lds
ds_read_b128 a[168:171], v30 offset:10240
ds_read_b64_tr_b16 a[140:141], v28 offset:12288
v_accvgpr_read_b32 v94, a30
v_accvgpr_read_b32 v95, a31
v_pk_mul_f32 v[88:89], v[88:89], v[52:53] op_sel_hi:[1,0]
v_mfma_f32_16x16x32_bf16 v[204:207], a[196:199], a[228:231], v[204:207]
ds_read_b64_tr_b16 a[142:143], v28 offset:12800
ds_read_b128 a[172:175], v30 offset:15360
v_pk_mul_f32 v[90:91], v[90:91], v[52:53] op_sel_hi:[1,0]
v_pk_mul_f32 v[92:93], v[92:93], v[52:53] op_sel_hi:[1,0]
v_pk_mul_f32 v[94:95], v[94:95], v[52:53] op_sel_hi:[1,0]
v_mfma_f32_16x16x32_bf16 v[204:207], a[200:203], a[232:235], v[204:207]
ds_read_b64_tr_b16 a[144:145], v29 offset:0
ds_read_b64_tr_b16 a[146:147], v29 offset:512
buffer_load_dwordx4 v59, s[24:27], s42 offen offset:3072 lds
v_cvt_pk_bf16_f32 v140, v88, v89
v_cvt_pk_bf16_f32 v141, v90, v91
v_cvt_pk_bf16_f32 v142, v92, v93
v_mfma_f32_16x16x32_bf16 v[204:207], a[204:207], a[236:239], v[204:207]
ds_read_b64_tr_b16 a[148:149], v29 offset:4096
v_cvt_pk_bf16_f32 v143, v94, v95
buffer_store_dwordx4 v[140:143], v1, s[20:23], s95 offen offset:3072 sc1
v_mfma_f32_16x16x32_bf16 v[208:211], a[176:179], a[240:243], v[148:151]
ds_read_b64_tr_b16 a[150:151], v29 offset:4608
ds_read_b64_tr_b16 a[152:153], v29 offset:8192
s_mov_b32 s95, 4096
v_accvgpr_read_b32 v64, a32
v_accvgpr_read_b32 v65, a33
s_mov_b32 m0, s44
s_nop 0
buffer_load_dwordx4 v1, s[28:31], s43 offen offset:0 sc1 lds
v_mfma_f32_16x16x32_bf16 v[208:211], a[180:183], a[244:247], v[208:211]
ds_read_b64_tr_b16 a[154:155], v29 offset:8704
ds_read_b64_tr_b16 a[156:157], v29 offset:12288
v_accvgpr_read_b32 v66, a34
v_accvgpr_read_b32 v67, a35
v_accvgpr_read_b32 v68, a48
v_mfma_f32_16x16x32_bf16 v[208:211], a[184:187], a[248:251], v[208:211]
ds_read_b64_tr_b16 a[158:159], v29 offset:12800
ds_read_b128 v[96:99], v30 offset:1024
v_accvgpr_read_b32 v69, a49
v_accvgpr_read_b32 v70, a50
v_accvgpr_read_b32 v71, a51
v_mfma_f32_16x16x32_bf16 v[208:211], a[188:191], a[252:255], v[208:211]
buffer_load_dwordx4 v1, s[28:31], s43 offen offset:1024 sc1 lds
ds_read_b128 v[100:103], v30 offset:6144
ds_read_b128 v[104:107], v30 offset:11264
v_pk_mul_f32 v[64:65], v[64:65], v[40:41] op_sel_hi:[1,0]
v_pk_mul_f32 v[66:67], v[66:67], v[40:41] op_sel_hi:[1,0]
v_pk_mul_f32 v[68:69], v[68:69], v[40:41] op_sel_hi:[1,0]
v_mfma_f32_16x16x32_bf16 v[212:215], a[192:195], a[240:243], v[152:155]
ds_read_b128 v[108:111], v30 offset:16384
ds_read_b128 v[112:115], v31 offset:0
v_pk_mul_f32 v[70:71], v[70:71], v[40:41] op_sel_hi:[1,0]
v_cvt_pk_bf16_f32 v128, v64, v65
v_cvt_pk_bf16_f32 v129, v66, v67
v_mfma_f32_16x16x32_bf16 v[212:215], a[196:199], a[244:247], v[212:215]
buffer_load_dwordx4 v1, s[28:31], s43 offen offset:2048 sc1 lds
ds_read_b128 v[116:119], v31 offset:5120
ds_read_b128 v[120:123], v31 offset:10240
v_cvt_pk_bf16_f32 v130, v68, v69
v_cvt_pk_bf16_f32 v131, v70, v71
buffer_store_dwordx4 v[128:131], v1, s[20:23], s95 offen offset:0 sc1
v_mfma_f32_16x16x32_bf16 v[212:215], a[200:203], a[248:251], v[212:215]
ds_read_b128 v[124:127], v31 offset:15360
v_accvgpr_read_b32 v72, a36
v_accvgpr_read_b32 v73, a37
v_accvgpr_read_b32 v74, a38
v_mfma_f32_16x16x32_bf16 v[212:215], a[204:207], a[252:255], v[212:215]
v_accvgpr_read_b32 v75, a39
v_accvgpr_read_b32 v76, a52
s_waitcnt lgkmcnt(15)
v_mfma_f32_16x16x32_bf16 v[192:195], a[128:131], a[160:163], v[192:195]
v_accvgpr_read_b32 v77, a53
v_accvgpr_read_b32 v78, a54
v_accvgpr_read_b32 v79, a55
v_pk_mul_f32 v[72:73], v[72:73], v[44:45] op_sel_hi:[1,0]
v_pk_mul_f32 v[74:75], v[74:75], v[44:45] op_sel_hi:[1,0]
v_pk_mul_f32 v[76:77], v[76:77], v[44:45] op_sel_hi:[1,0]
v_pk_mul_f32 v[78:79], v[78:79], v[44:45] op_sel_hi:[1,0]
s_add_u32 s51, s49, s48
s_add_u32 s62, s50, s71
v_mfma_f32_16x16x32_bf16 v[192:195], a[132:135], a[164:167], v[192:195]
v_cvt_pk_bf16_f32 v132, v72, v73
v_cvt_pk_bf16_f32 v133, v74, v75
v_cvt_pk_bf16_f32 v134, v76, v77
v_cvt_pk_bf16_f32 v135, v78, v79
buffer_store_dwordx4 v[132:135], v1, s[20:23], s95 offen offset:1024 sc1
v_accvgpr_read_b32 v80, a40
buffer_load_dwordx4 v1, s[28:31], s43 offen offset:3072 sc1 lds
v_accvgpr_read_b32 v81, a41
s_and_b32 s63, s64, 15
s_lshr_b64 s[64:65], s[64:65], 4
v_mfma_f32_16x16x32_bf16 v[192:195], a[136:139], a[168:171], v[192:195]
v_accvgpr_read_b32 v82, a42
v_accvgpr_read_b32 v83, a43
v_accvgpr_read_b32 v84, a56
v_accvgpr_read_b32 v85, a57
v_accvgpr_read_b32 v86, a58
v_accvgpr_read_b32 v87, a59
s_mul_i32 s42, s63, 442368
v_mfma_f32_16x16x32_bf16 v[192:195], a[140:143], a[172:175], v[192:195]
v_pk_mul_f32 v[80:81], v[80:81], v[48:49] op_sel_hi:[1,0]
v_pk_mul_f32 v[82:83], v[82:83], v[48:49] op_sel_hi:[1,0]
v_pk_mul_f32 v[84:85], v[84:85], v[48:49] op_sel_hi:[1,0]
v_pk_mul_f32 v[86:87], v[86:87], v[48:49] op_sel_hi:[1,0]
v_cvt_pk_bf16_f32 v136, v80, v81
v_cvt_pk_bf16_f32 v137, v82, v83
v_cvt_pk_bf16_f32 v138, v84, v85
s_mul_i32 s66, s63, 20480
s_add_u32 s42, s42, s45
s_waitcnt lgkmcnt(8)
v_mfma_f32_16x16x32_bf16 v[196:199], a[144:147], a[160:163], v[196:199]
v_cvt_pk_bf16_f32 v139, v86, v87
buffer_store_dwordx4 v[136:139], v1, s[20:23], s95 offen offset:2048 sc1
v_accvgpr_read_b32 v88, a44
v_accvgpr_read_b32 v89, a45
v_accvgpr_read_b32 v90, a46
v_accvgpr_read_b32 v91, a47
s_add_u32 s49, s49, 16384
s_and_b32 s49, s49, 0xffff
v_mfma_f32_16x16x32_bf16 v[196:199], a[148:151], a[164:167], v[196:199]
v_accvgpr_read_b32 v92, a60
v_accvgpr_read_b32 v93, a61
v_accvgpr_read_b32 v94, a62
s_add_u32 m0, s44, 4096
s_nop 0
buffer_load_dwordx4 v63, s[28:31], s43 offen sc1 lds
v_accvgpr_read_b32 v95, a63
v_pk_mul_f32 v[88:89], v[88:89], v[52:53] op_sel_hi:[1,0]
v_pk_mul_f32 v[90:91], v[90:91], v[52:53] op_sel_hi:[1,0]
v_pk_mul_f32 v[92:93], v[92:93], v[52:53] op_sel_hi:[1,0]
s_sub_u32 s50, s50, 20480
s_cselect_b32 s50, 61440, s50
v_mfma_f32_16x16x32_bf16 v[196:199], a[152:155], a[168:171], v[196:199]
v_pk_mul_f32 v[94:95], v[94:95], v[52:53] op_sel_hi:[1,0]
v_cvt_pk_bf16_f32 v140, v88, v89
v_cvt_pk_bf16_f32 v141, v90, v91
v_cvt_pk_bf16_f32 v142, v92, v93
v_cvt_pk_bf16_f32 v143, v94, v95
buffer_store_dwordx4 v[140:143], v1, s[20:23], s95 offen offset:3072 sc1
v_add_u32 v28, s49, v24
v_add_u32 v29, s49, v25
v_add_u32 v30, s50, v26
v_add_u32 v31, s50, v27
v_mfma_f32_16x16x32_bf16 v[196:199], a[156:159], a[172:175], v[196:199]
s_mov_b32 s44, s62
s_add_u32 s43, s66, s46
s_waitcnt vmcnt(26)
s_waitcnt lgkmcnt(0)
s_barrier
s_mov_b32 m0, s51
s_nop 0
buffer_load_dwordx4 v56, s[24:27], s42 offen offset:0 lds
v_mfma_f32_16x16x32_bf16 v[200:203], a[128:131], v[96:99], v[200:203]
ds_read_b64_tr_b16 a[176:177], v28 offset:0
ds_read_b64_tr_b16 a[178:179], v28 offset:512
s_mov_b32 s95, 8192
v_accvgpr_read_b32 v64, a64
v_accvgpr_read_b32 v65, a65
v_mfma_f32_16x16x32_bf16 v[200:203], a[132:135], v[100:103], v[200:203]
ds_read_b128 a[208:211], v30 offset:0
ds_read_b64_tr_b16 a[180:181], v28 offset:4096
v_accvgpr_read_b32 v66, a66
v_accvgpr_read_b32 v67, a67
v_accvgpr_read_b32 v68, a80
v_mfma_f32_16x16x32_bf16 v[200:203], a[136:139], v[104:107], v[200:203]
buffer_load_dwordx4 v57, s[24:27], s42 offen offset:1024 lds
ds_read_b64_tr_b16 a[182:183], v28 offset:4608
ds_read_b128 a[212:215], v30 offset:5120
v_accvgpr_read_b32 v69, a81
v_accvgpr_read_b32 v70, a82
v_accvgpr_read_b32 v71, a83
v_mfma_f32_16x16x32_bf16 v[200:203], a[140:143], v[108:111], v[200:203]
ds_read_b64_tr_b16 a[184:185], v28 offset:8192
ds_read_b64_tr_b16 a[186:187], v28 offset:8704
v_pk_mul_f32 v[64:65], v[64:65], v[40:41] op_sel_hi:[1,0]
v_pk_mul_f32 v[66:67], v[66:67], v[40:41] op_sel_hi:[1,0]
v_pk_mul_f32 v[68:69], v[68:69], v[40:41] op_sel_hi:[1,0]
v_mfma_f32_16x16x32_bf16 v[204:207], a[144:147], v[96:99], v[204:207]
buffer_load_dwordx4 v58, s[24:27], s42 offen offset:2048 lds
ds_read_b128 a[216:219], v30 offset:10240
ds_read_b64_tr_b16 a[188:189], v28 offset:12288
v_pk_mul_f32 v[70:71], v[70:71], v[40:41] op_sel_hi:[1,0]
v_cvt_pk_bf16_f32 v128, v64, v65
v_cvt_pk_bf16_f32 v129, v66, v67
v_mfma_f32_16x16x32_bf16 v[204:207], a[148:151], v[100:103], v[204:207]
ds_read_b64_tr_b16 a[190:191], v28 offset:12800
ds_read_b128 a[220:223], v30 offset:15360
v_cvt_pk_bf16_f32 v130, v68, v69
v_cvt_pk_bf16_f32 v131, v70, v71
buffer_store_dwordx4 v[128:131], v1, s[20:23], s95 offen offset:0 sc1
v_mfma_f32_16x16x32_bf16 v[204:207], a[152:155], v[104:107], v[204:207]
ds_read_b64_tr_b16 a[192:193], v29 offset:0
ds_read_b64_tr_b16 a[194:195], v29 offset:512
buffer_load_dwordx4 v59, s[24:27], s42 offen offset:3072 lds
v_accvgpr_read_b32 v72, a68
v_accvgpr_read_b32 v73, a69
v_accvgpr_read_b32 v74, a70
v_mfma_f32_16x16x32_bf16 v[204:207], a[156:159], v[108:111], v[204:207]
ds_read_b64_tr_b16 a[196:197], v29 offset:4096
v_accvgpr_read_b32 v75, a71
v_accvgpr_read_b32 v76, a84
v_mfma_f32_16x16x32_bf16 v[208:211], a[128:131], v[112:115], v[208:211]
ds_read_b64_tr_b16 a[198:199], v29 offset:4608
ds_read_b64_tr_b16 a[200:201], v29 offset:8192
v_accvgpr_read_b32 v77, a85
v_accvgpr_read_b32 v78, a86
v_accvgpr_read_b32 v79, a87
s_mov_b32 m0, s44
s_nop 0
buffer_load_dwordx4 v1, s[28:31], s43 offen offset:0 sc1 lds
v_mfma_f32_16x16x32_bf16 v[208:211], a[132:135], v[116:119], v[208:211]
ds_read_b64_tr_b16 a[202:203], v29 offset:8704
ds_read_b64_tr_b16 a[204:205], v29 offset:12288
v_pk_mul_f32 v[72:73], v[72:73], v[44:45] op_sel_hi:[1,0]
v_pk_mul_f32 v[74:75], v[74:75], v[44:45] op_sel_hi:[1,0]
v_pk_mul_f32 v[76:77], v[76:77], v[44:45] op_sel_hi:[1,0]
v_mfma_f32_16x16x32_bf16 v[208:211], a[136:139], v[120:123], v[208:211]
ds_read_b64_tr_b16 a[206:207], v29 offset:12800
ds_read_b128 a[224:227], v30 offset:1024
v_pk_mul_f32 v[78:79], v[78:79], v[44:45] op_sel_hi:[1,0]
v_cvt_pk_bf16_f32 v132, v72, v73
v_cvt_pk_bf16_f32 v133, v74, v75
v_mfma_f32_16x16x32_bf16 v[208:211], a[140:143], v[124:127], v[208:211]
buffer_load_dwordx4 v1, s[28:31], s43 offen offset:1024 sc1 lds
ds_read_b128 a[228:231], v30 offset:6144
ds_read_b128 a[232:235], v30 offset:11264
v_cvt_pk_bf16_f32 v134, v76, v77
v_cvt_pk_bf16_f32 v135, v78, v79
buffer_store_dwordx4 v[132:135], v1, s[20:23], s95 offen offset:1024 sc1
v_mfma_f32_16x16x32_bf16 v[212:215], a[144:147], v[112:115], v[212:215]
ds_read_b128 a[236:239], v30 offset:16384
ds_read_b128 a[240:243], v31 offset:0
v_accvgpr_read_b32 v80, a72
v_accvgpr_read_b32 v81, a73
v_accvgpr_read_b32 v82, a74
v_mfma_f32_16x16x32_bf16 v[212:215], a[148:151], v[116:119], v[212:215]
buffer_load_dwordx4 v1, s[28:31], s43 offen offset:2048 sc1 lds
ds_read_b128 a[244:247], v31 offset:5120
ds_read_b128 a[248:251], v31 offset:10240
v_accvgpr_read_b32 v83, a75
v_accvgpr_read_b32 v84, a88
v_accvgpr_read_b32 v85, a89
v_mfma_f32_16x16x32_bf16 v[212:215], a[152:155], v[120:123], v[212:215]
ds_read_b128 a[252:255], v31 offset:15360
v_accvgpr_read_b32 v86, a90
v_accvgpr_read_b32 v87, a91
v_pk_mul_f32 v[80:81], v[80:81], v[48:49] op_sel_hi:[1,0]
v_mfma_f32_16x16x32_bf16 v[212:215], a[156:159], v[124:127], v[212:215]
v_pk_mul_f32 v[82:83], v[82:83], v[48:49] op_sel_hi:[1,0]
v_pk_mul_f32 v[84:85], v[84:85], v[48:49] op_sel_hi:[1,0]
s_waitcnt lgkmcnt(15)
v_mfma_f32_16x16x32_bf16 v[192:195], a[176:179], a[208:211], v[192:195]
v_pk_mul_f32 v[86:87], v[86:87], v[48:49] op_sel_hi:[1,0]
v_cvt_pk_bf16_f32 v136, v80, v81
v_cvt_pk_bf16_f32 v137, v82, v83
v_cvt_pk_bf16_f32 v138, v84, v85
v_cvt_pk_bf16_f32 v139, v86, v87
buffer_store_dwordx4 v[136:139], v1, s[20:23], s95 offen offset:2048 sc1
v_accvgpr_read_b32 v88, a76
s_add_u32 s51, s49, s48
s_add_u32 s62, s50, s71
v_mfma_f32_16x16x32_bf16 v[192:195], a[180:183], a[212:215], v[192:195]
v_accvgpr_read_b32 v89, a77
v_accvgpr_read_b32 v90, a78
v_accvgpr_read_b32 v91, a79
v_accvgpr_read_b32 v92, a92
v_accvgpr_read_b32 v93, a93
v_accvgpr_read_b32 v94, a94
buffer_load_dwordx4 v1, s[28:31], s43 offen offset:3072 sc1 lds
v_accvgpr_read_b32 v95, a95
s_and_b32 s63, s64, 15
s_lshr_b64 s[64:65], s[64:65], 4
v_mfma_f32_16x16x32_bf16 v[192:195], a[184:187], a[216:219], v[192:195]
v_pk_mul_f32 v[88:89], v[88:89], v[52:53] op_sel_hi:[1,0]
v_pk_mul_f32 v[90:91], v[90:91], v[52:53] op_sel_hi:[1,0]
v_pk_mul_f32 v[92:93], v[92:93], v[52:53] op_sel_hi:[1,0]
v_pk_mul_f32 v[94:95], v[94:95], v[52:53] op_sel_hi:[1,0]
v_cvt_pk_bf16_f32 v140, v88, v89
v_cvt_pk_bf16_f32 v141, v90, v91
s_mul_i32 s42, s63, 442368
v_mfma_f32_16x16x32_bf16 v[192:195], a[188:191], a[220:223], v[192:195]
v_cvt_pk_bf16_f32 v142, v92, v93
v_cvt_pk_bf16_f32 v143, v94, v95
buffer_store_dwordx4 v[140:143], v1, s[20:23], s95 offen offset:3072 sc1
s_mov_b32 s95, 12288
v_accvgpr_read_b32 v64, a96
v_accvgpr_read_b32 v65, a97
v_accvgpr_read_b32 v66, a98
s_mul_i32 s66, s63, 20480
s_add_u32 s42, s42, s45
s_waitcnt lgkmcnt(8)
v_mfma_f32_16x16x32_bf16 v[196:199], a[192:195], a[208:211], v[196:199]
v_accvgpr_read_b32 v67, a99
v_accvgpr_read_b32 v68, a112
v_accvgpr_read_b32 v69, a113
v_accvgpr_read_b32 v70, a114
v_accvgpr_read_b32 v71, a115
v_pk_mul_f32 v[64:65], v[64:65], v[40:41] op_sel_hi:[1,0]
s_add_u32 s49, s49, 16384
s_and_b32 s49, s49, 0xffff
v_mfma_f32_16x16x32_bf16 v[196:199], a[196:199], a[212:215], v[196:199]
v_pk_mul_f32 v[66:67], v[66:67], v[40:41] op_sel_hi:[1,0]
v_pk_mul_f32 v[68:69], v[68:69], v[40:41] op_sel_hi:[1,0]
v_pk_mul_f32 v[70:71], v[70:71], v[40:41] op_sel_hi:[1,0]
s_add_u32 m0, s44, 4096
s_nop 0
buffer_load_dwordx4 v63, s[28:31], s43 offen sc1 lds
v_cvt_pk_bf16_f32 v128, v64, v65
v_cvt_pk_bf16_f32 v129, v66, v67
v_cvt_pk_bf16_f32 v130, v68, v69
v_cvt_pk_bf16_f32 v131, v70, v71
s_sub_u32 s50, s50, 20480
s_cselect_b32 s50, 61440, s50
v_mfma_f32_16x16x32_bf16 v[196:199], a[200:203], a[216:219], v[196:199]
buffer_store_dwordx4 v[128:131], v1, s[20:23], s95 offen offset:0 sc1
v_accvgpr_read_b32 v72, a100
v_accvgpr_read_b32 v73, a101
v_accvgpr_read_b32 v74, a102
v_accvgpr_read_b32 v75, a103
v_accvgpr_read_b32 v76, a116
v_add_u32 v28, s49, v24
v_add_u32 v29, s49, v25
v_add_u32 v30, s50, v26
v_add_u32 v31, s50, v27
v_mfma_f32_16x16x32_bf16 v[196:199], a[204:207], a[220:223], v[196:199]
s_mov_b32 s44, s62
s_add_u32 s43, s66, s46
s_waitcnt vmcnt(31)
s_waitcnt lgkmcnt(0)
s_barrier
s_mov_b32 m0, s51
s_nop 0
buffer_load_dwordx4 v56, s[24:27], s42 offen offset:0 lds
v_mfma_f32_16x16x32_bf16 v[200:203], a[176:179], a[224:227], v[200:203]
ds_read_b64_tr_b16 a[128:129], v28 offset:0
ds_read_b64_tr_b16 a[130:131], v28 offset:512
v_accvgpr_read_b32 v77, a117
v_accvgpr_read_b32 v78, a118
v_accvgpr_read_b32 v79, a119
v_mfma_f32_16x16x32_bf16 v[200:203], a[180:183], a[228:231], v[200:203]
ds_read_b128 a[160:163], v30 offset:0
ds_read_b64_tr_b16 a[132:133], v28 offset:4096
v_pk_mul_f32 v[72:73], v[72:73], v[44:45] op_sel_hi:[1,0]
v_pk_mul_f32 v[74:75], v[74:75], v[44:45] op_sel_hi:[1,0]
v_pk_mul_f32 v[76:77], v[76:77], v[44:45] op_sel_hi:[1,0]
v_mfma_f32_16x16x32_bf16 v[200:203], a[184:187], a[232:235], v[200:203]
buffer_load_dwordx4 v57, s[24:27], s42 offen offset:1024 lds
ds_read_b64_tr_b16 a[134:135], v28 offset:4608
ds_read_b128 a[164:167], v30 offset:5120
v_pk_mul_f32 v[78:79], v[78:79], v[44:45] op_sel_hi:[1,0]
v_cvt_pk_bf16_f32 v132, v72, v73
v_cvt_pk_bf16_f32 v133, v74, v75
v_mfma_f32_16x16x32_bf16 v[200:203], a[188:191], a[236:239], v[200:203]
ds_read_b64_tr_b16 a[136:137], v28 offset:8192
ds_read_b64_tr_b16 a[138:139], v28 offset:8704
v_cvt_pk_bf16_f32 v134, v76, v77
v_cvt_pk_bf16_f32 v135, v78, v79
buffer_store_dwordx4 v[132:135], v1, s[20:23], s95 offen offset:1024 sc1
v_mfma_f32_16x16x32_bf16 v[204:207], a[192:195], a[224:227], v[204:207]
buffer_load_dwordx4 v58, s[24:27], s42 offen offset:2048 lds
ds_read_b128 a[168:171], v30 offset:10240
ds_read_b64_tr_b16 a[140:141], v28 offset:12288
v_accvgpr_read_b32 v80, a104
v_accvgpr_read_b32 v81, a105
v_accvgpr_read_b32 v82, a106
v_mfma_f32_16x16x32_bf16 v[204:207], a[196:199], a[228:231], v[204:207]
ds_read_b64_tr_b16 a[142:143], v28 offset:12800
ds_read_b128 a[172:175], v30 offset:15360
v_accvgpr_read_b32 v83, a107
v_accvgpr_read_b32 v84, a120
v_accvgpr_read_b32 v85, a121
v_mfma_f32_16x16x32_bf16 v[204:207], a[200:203], a[232:235], v[204:207]
ds_read_b64_tr_b16 a[144:145], v29 offset:0
ds_read_b64_tr_b16 a[146:147], v29 offset:512
buffer_load_dwordx4 v59, s[24:27], s42 offen offset:3072 lds
v_accvgpr_read_b32 v86, a122
v_accvgpr_read_b32 v87, a123
v_pk_mul_f32 v[80:81], v[80:81], v[48:49] op_sel_hi:[1,0]
v_mfma_f32_16x16x32_bf16 v[204:207], a[204:207], a[236:239], v[204:207]
ds_read_b64_tr_b16 a[148:149], v29 offset:4096
v_pk_mul_f32 v[82:83], v[82:83], v[48:49] op_sel_hi:[1,0]
v_pk_mul_f32 v[84:85], v[84:85], v[48:49] op_sel_hi:[1,0]
v_mfma_f32_16x16x32_bf16 v[208:211], a[176:179], a[240:243], v[208:211]
ds_read_b64_tr_b16 a[150:151], v29 offset:4608
ds_read_b64_tr_b16 a[152:153], v29 offset:8192
v_pk_mul_f32 v[86:87], v[86:87], v[48:49] op_sel_hi:[1,0]
v_cvt_pk_bf16_f32 v136, v80, v81
v_cvt_pk_bf16_f32 v137, v82, v83
s_mov_b32 m0, s44
s_nop 0
buffer_load_dwordx4 v1, s[28:31], s43 offen offset:0 sc1 lds
v_mfma_f32_16x16x32_bf16 v[208:211], a[180:183], a[244:247], v[208:211]
ds_read_b64_tr_b16 a[154:155], v29 offset:8704
ds_read_b64_tr_b16 a[156:157], v29 offset:12288
v_cvt_pk_bf16_f32 v138, v84, v85
v_cvt_pk_bf16_f32 v139, v86, v87
buffer_store_dwordx4 v[136:139], v1, s[20:23], s95 offen offset:2048 sc1
v_mfma_f32_16x16x32_bf16 v[208:211], a[184:187], a[248:251], v[208:211]
ds_read_b64_tr_b16 a[158:159], v29 offset:12800
ds_read_b128 v[96:99], v30 offset:1024
v_accvgpr_read_b32 v88, a108
v_accvgpr_read_b32 v89, a109
v_accvgpr_read_b32 v90, a110
v_mfma_f32_16x16x32_bf16 v[208:211], a[188:191], a[252:255], v[208:211]
buffer_load_dwordx4 v1, s[28:31], s43 offen offset:1024 sc1 lds
ds_read_b128 v[100:103], v30 offset:6144
ds_read_b128 v[104:107], v30 offset:11264
v_accvgpr_read_b32 v91, a111
v_accvgpr_read_b32 v92, a124
v_accvgpr_read_b32 v93, a125
v_mfma_f32_16x16x32_bf16 v[212:215], a[192:195], a[240:243], v[212:215]
ds_read_b128 v[108:111], v30 offset:16384
ds_read_b128 v[112:115], v31 offset:0
v_accvgpr_read_b32 v94, a126
v_accvgpr_read_b32 v95, a127
v_pk_mul_f32 v[88:89], v[88:89], v[52:53] op_sel_hi:[1,0]
v_mfma_f32_16x16x32_bf16 v[212:215], a[196:199], a[244:247], v[212:215]
buffer_load_dwordx4 v1, s[28:31], s43 offen offset:2048 sc1 lds
ds_read_b128 v[116:119], v31 offset:5120
ds_read_b128 v[120:123], v31 offset:10240
v_pk_mul_f32 v[90:91], v[90:91], v[52:53] op_sel_hi:[1,0]
v_pk_mul_f32 v[92:93], v[92:93], v[52:53] op_sel_hi:[1,0]
v_pk_mul_f32 v[94:95], v[94:95], v[52:53] op_sel_hi:[1,0]
v_mfma_f32_16x16x32_bf16 v[212:215], a[200:203], a[248:251], v[212:215]
ds_read_b128 v[124:127], v31 offset:15360
v_cvt_pk_bf16_f32 v140, v88, v89
v_cvt_pk_bf16_f32 v141, v90, v91
v_cvt_pk_bf16_f32 v142, v92, v93
v_mfma_f32_16x16x32_bf16 v[212:215], a[204:207], a[252:255], v[212:215]
v_cvt_pk_bf16_f32 v143, v94, v95
buffer_store_dwordx4 v[140:143], v1, s[20:23], s95 offen offset:3072 sc1
s_waitcnt lgkmcnt(15)
v_mfma_f32_16x16x32_bf16 v[192:195], a[128:131], a[160:163], v[192:195]
s_add_u32 s51, s49, s48
s_add_u32 s62, s50, s71
v_mfma_f32_16x16x32_bf16 v[192:195], a[132:135], a[164:167], v[192:195]
s_and_b32 s63, s64, 15
s_lshr_b64 s[64:65], s[64:65], 4
buffer_load_dwordx4 v1, s[28:31], s43 offen offset:3072 sc1 lds
v_mfma_f32_16x16x32_bf16 v[192:195], a[136:139], a[168:171], v[192:195]
s_mul_i32 s42, s63, 442368
v_mfma_f32_16x16x32_bf16 v[192:195], a[140:143], a[172:175], v[192:195]
s_mul_i32 s66, s63, 20480
s_add_u32 s42, s42, s45
s_waitcnt lgkmcnt(8)
v_mfma_f32_16x16x32_bf16 v[196:199], a[144:147], a[160:163], v[196:199]
s_add_u32 s49, s49, 16384
s_and_b32 s49, s49, 0xffff
v_mfma_f32_16x16x32_bf16 v[196:199], a[148:151], a[164:167], v[196:199]
s_sub_u32 s50, s50, 20480
s_cselect_b32 s50, 61440, s50
v_mfma_f32_16x16x32_bf16 v[196:199], a[152:155], a[168:171], v[196:199]
s_add_u32 m0, s44, 4096
s_nop 0
buffer_load_dwordx4 v63, s[28:31], s43 offen sc1 lds
v_add_u32 v28, s49, v24
v_add_u32 v29, s49, v25
v_add_u32 v30, s50, v26
v_add_u32 v31, s50, v27
v_mfma_f32_16x16x32_bf16 v[196:199], a[156:159], a[172:175], v[196:199]
s_mov_b32 s44, s62
s_add_u32 s43, s66, s46
s_waitcnt vmcnt(27)
s_waitcnt lgkmcnt(0)
s_barrier
s_mov_b32 m0, s51
s_nop 0
buffer_load_dwordx4 v56, s[24:27], s42 offen offset:0 lds
v_mfma_f32_16x16x32_bf16 v[200:203], a[128:131], v[96:99], v[200:203]
ds_read_b64_tr_b16 a[176:177], v28 offset:0
ds_read_b64_tr_b16 a[178:179], v28 offset:512
s_and_b32 s55, s86, 3
s_lshr_b32 s92, s86, 2
s_lshl_b32 s92, s92, 3
s_lshr_b32 s93, s87, 2
v_mfma_f32_16x16x32_bf16 v[200:203], a[132:135], v[100:103], v[200:203]
ds_read_b128 a[208:211], v30 offset:0
ds_read_b64_tr_b16 a[180:181], v28 offset:4096
s_add_u32 s53, s92, s93
s_and_b32 s54, s87, 3
s_lshr_b32 s94, s40, 1
v_mfma_f32_16x16x32_bf16 v[200:203], a[136:139], v[104:107], v[200:203]
buffer_load_dwordx4 v57, s[24:27], s42 offen offset:1024 lds
ds_read_b64_tr_b16 a[182:183], v28 offset:4608
ds_read_b128 a[212:215], v30 offset:5120
s_and_b32 s95, s40, 1
s_lshl_b32 s92, s53, 1
s_add_u32 s92, s92, s94
v_mfma_f32_16x16x32_bf16 v[200:203], a[140:143], v[108:111], v[200:203]
ds_read_b64_tr_b16 a[184:185], v28 offset:8192
ds_read_b64_tr_b16 a[186:187], v28 offset:8704
s_lshl_b32 s92, s92, 7
s_lshl_b32 s93, s55, 5
s_add_u32 s93, s93, s95
v_mfma_f32_16x16x32_bf16 v[204:207], a[144:147], v[96:99], v[204:207]
ds_read_b128 a[216:219], v30 offset:10240
buffer_load_dwordx4 v58, s[24:27], s42 offen offset:2048 lds
ds_read_b64_tr_b16 a[188:189], v28 offset:12288
s_add_u32 s92, s92, s93
s_lshl_b32 s92, s92, 12
s_add_u32 s92, s92, 8388608
v_mfma_f32_16x16x32_bf16 v[204:207], a[148:151], v[100:103], v[204:207]
ds_read_b64_tr_b16 a[190:191], v28 offset:12800
ds_read_b128 a[220:223], v30 offset:15360
s_add_u32 s12, s84, s92
s_addc_u32 s13, s85, 0
s_mov_b32 s14, 126976
s_mov_b32 s15, 0x20000
s_lshl_b32 s92, s54, 1
v_mfma_f32_16x16x32_bf16 v[204:207], a[152:155], v[104:107], v[204:207]
ds_read_b64_tr_b16 a[192:193], v29 offset:0
ds_read_b64_tr_b16 a[194:195], v29 offset:512
buffer_load_dwordx4 v59, s[24:27], s42 offen offset:3072 lds
s_add_u32 s92, s92, s94
s_lshl_b32 s92, s92, 7
s_add_u32 s92, s92, s93
v_mfma_f32_16x16x32_bf16 v[204:207], a[156:159], v[108:111], v[204:207]
ds_read_b64_tr_b16 a[196:197], v29 offset:4096
s_mul_i32 s92, s92, 5120
s_add_u32 s92, s92, 37748736
s_add_u32 s16, s84, s92
s_addc_u32 s17, s85, 0
v_mfma_f32_16x16x32_bf16 v[208:211], a[128:131], v[112:115], v[208:211]
ds_read_b64_tr_b16 a[198:199], v29 offset:4608
ds_read_b64_tr_b16 a[200:201], v29 offset:8192
s_mov_b32 s18, 158720
s_mov_b32 s19, 0x20000
s_lshl_b32 s92, s95, 1
s_mov_b32 m0, s44
s_nop 0
buffer_load_dwordx4 v1, s[28:31], s43 offen offset:0 sc1 lds
v_mfma_f32_16x16x32_bf16 v[208:211], a[132:135], v[116:119], v[208:211]
ds_read_b64_tr_b16 a[202:203], v29 offset:8704
ds_read_b64_tr_b16 a[204:205], v29 offset:12288
s_add_u32 s92, s92, s94
s_lshl_b32 s96, s92, 12
s_mul_i32 s92, s92, 5120
v_mfma_f32_16x16x32_bf16 v[208:211], a[136:139], v[120:123], v[208:211]
ds_read_b64_tr_b16 a[206:207], v29 offset:12800
ds_read_b128 a[224:227], v30 offset:1024
s_add_u32 s97, s92, 81920
s_lshl_b32 s94, s94, 12
v_add_u32 v2, s94, v1
s_mul_i32 s95, s95, 5120
v_mfma_f32_16x16x32_bf16 v[208:211], a[140:143], v[124:127], v[208:211]
buffer_load_dwordx4 v1, s[28:31], s43 offen offset:1024 sc1 lds
ds_read_b128 a[228:231], v30 offset:6144
ds_read_b128 a[232:235], v30 offset:11264
s_add_u32 s95, s95, 81920
v_add_u32 v3, s95, v1
s_lshr_b32 s93, s53, 1
v_mfma_f32_16x16x32_bf16 v[212:215], a[144:147], v[112:115], v[212:215]
ds_read_b128 a[236:239], v30 offset:16384
ds_read_b128 a[240:243], v31 offset:0
s_lshl_b32 s93, s93, 2
s_add_u32 s93, s93, s55
s_lshl_b32 s93, s93, 5
v_mfma_f32_16x16x32_bf16 v[212:215], a[148:151], v[116:119], v[212:215]
buffer_load_dwordx4 v1, s[28:31], s43 offen offset:2048 sc1 lds
ds_read_b128 a[244:247], v31 offset:5120
ds_read_b128 a[248:251], v31 offset:10240
s_add_u32 s93, s93, 3072
v_lshrrev_b32 v5, 4, v1
v_and_b32 v5, 7, v5
v_mfma_f32_16x16x32_bf16 v[212:215], a[152:155], v[120:123], v[212:215]
ds_read_b128 a[252:255], v31 offset:15360
v_lshl_add_u32 v5, v5, 2, s93
s_lshl_b32 s93, s55, 8
s_add_u32 s93, s93, 2048
v_mfma_f32_16x16x32_bf16 v[212:215], a[156:159], v[124:127], v[212:215]
v_lshrrev_b32 v6, 4, v1
v_and_b32 v6, 63, v6
v_lshl_add_u32 v6, v6, 2, s93
s_waitcnt lgkmcnt(15)
v_mfma_f32_16x16x32_bf16 v[192:195], a[176:179], a[208:211], v[192:195]
s_lshl_b32 s92, s89, 5
s_add_u32 s92, s92, s88
s_add_u32 s51, s49, s48
s_add_u32 s62, s50, s71
v_mfma_f32_16x16x32_bf16 v[192:195], a[180:183], a[212:215], v[192:195]
s_lshl_b32 s92, s92, 2
s_and_b32 s63, s64, 15
buffer_load_dwordx4 v1, s[28:31], s43 offen offset:3072 sc1 lds
s_lshr_b64 s[64:65], s[64:65], 4
v_mfma_f32_16x16x32_bf16 v[192:195], a[184:187], a[216:219], v[192:195]
s_add_u32 s92, s92, 3072
s_mul_i32 s42, s63, 442368
v_mfma_f32_16x16x32_bf16 v[192:195], a[188:191], a[220:223], v[192:195]
v_add_u32 v60, s40, v1
v_min_u32 v60, 1, v60
s_mul_i32 s66, s63, 20480
s_add_u32 s42, s42, s45
s_waitcnt lgkmcnt(8)
v_mfma_f32_16x16x32_bf16 v[196:199], a[192:195], a[208:211], v[196:199]
v_lshlrev_b32 v60, 31, v60
s_add_u32 s49, s49, 16384
s_and_b32 s49, s49, 0xffff
v_mfma_f32_16x16x32_bf16 v[196:199], a[196:199], a[212:215], v[196:199]
v_mov_b32 v61, s82
s_sub_u32 s50, s50, 20480
s_cselect_b32 s50, 61440, s50
s_add_u32 m0, s44, 4096
s_nop 0
buffer_load_dwordx4 v63, s[28:31], s43 offen sc1 lds
v_mfma_f32_16x16x32_bf16 v[196:199], a[200:203], a[216:219], v[196:199]
s_mov_b32 s67, s92
v_add_u32 v28, s49, v24
v_add_u32 v29, s49, v25
v_add_u32 v30, s50, v26
v_add_u32 v31, s50, v27
v_mfma_f32_16x16x32_bf16 v[196:199], a[204:207], a[220:223], v[196:199]
s_mov_b32 s44, s62
s_add_u32 s43, s66, s46
s_waitcnt vmcnt(22)
s_waitcnt lgkmcnt(0)
s_barrier
s_mov_b32 m0, s51
s_nop 0
buffer_load_dwordx4 v56, s[24:27], s42 offen offset:0 lds
v_mfma_f32_16x16x32_bf16 v[200:203], a[176:179], a[224:227], v[200:203]
ds_read_b64_tr_b16 a[128:129], v28 offset:0
ds_read_b64_tr_b16 a[130:131], v28 offset:512
s_mul_i32 s92, s91, 276480
s_mul_i32 s93, s90, 10240
v_mfma_f32_16x16x32_bf16 v[200:203], a[180:183], a[228:231], v[200:203]
ds_read_b128 a[160:163], v30 offset:0
ds_read_b64_tr_b16 a[132:133], v28 offset:4096
s_add_u32 s92, s92, s93
v_mfma_f32_16x16x32_bf16 v[200:203], a[184:187], a[232:235], v[200:203]
buffer_load_dwordx4 v57, s[24:27], s42 offen offset:1024 lds
ds_read_b64_tr_b16 a[134:135], v28 offset:4608
ds_read_b128 a[164:167], v30 offset:5120
s_add_u32 s92, s92, 33554432
v_mfma_f32_16x16x32_bf16 v[200:203], a[188:191], a[236:239], v[200:203]
ds_read_b64_tr_b16 a[136:137], v28 offset:8192
ds_read_b64_tr_b16 a[138:139], v28 offset:8704
s_add_u32 s32, s84, s92
s_addc_u32 s33, s85, 0
v_mfma_f32_16x16x32_bf16 v[204:207], a[192:195], a[224:227], v[204:207]
buffer_load_dwordx4 v58, s[24:27], s42 offen offset:2048 lds
ds_read_b128 a[168:171], v30 offset:10240
ds_read_b64_tr_b16 a[140:141], v28 offset:12288
s_mov_b32 s34, 10240
v_mfma_f32_16x16x32_bf16 v[204:207], a[196:199], a[228:231], v[204:207]
ds_read_b64_tr_b16 a[142:143], v28 offset:12800
ds_read_b128 a[172:175], v30 offset:15360
s_mov_b32 s35, 0x20000
s_cmp_eq_u32 s3, 1
s_cselect_b32 s34, 0, 10240
s_cselect_b32 s93, 31, s90
v_mfma_f32_16x16x32_bf16 v[204:207], a[200:203], a[232:235], v[204:207]
buffer_load_dwordx4 v59, s[24:27], s42 offen offset:3072 lds
ds_read_b64_tr_b16 a[144:145], v29 offset:0
ds_read_b64_tr_b16 a[146:147], v29 offset:512
s_lshl_b32 s92, s91, 5
v_mfma_f32_16x16x32_bf16 v[204:207], a[204:207], a[236:239], v[204:207]
ds_read_b64_tr_b16 a[148:149], v29 offset:4096
s_add_u32 s92, s92, s93
v_mfma_f32_16x16x32_bf16 v[208:211], a[176:179], a[240:243], v[208:211]
ds_read_b64_tr_b16 a[150:151], v29 offset:4608
ds_read_b64_tr_b16 a[152:153], v29 offset:8192
s_mov_b32 m0, s44
s_nop 0
buffer_load_dwordx4 v1, s[28:31], s43 offen offset:0 sc1 lds
s_lshl_b32 s92, s92, 2
v_mfma_f32_16x16x32_bf16 v[208:211], a[180:183], a[244:247], v[208:211]
ds_read_b64_tr_b16 a[154:155], v29 offset:8704
ds_read_b64_tr_b16 a[156:157], v29 offset:12288
s_add_u32 s52, s92, 4096
v_mfma_f32_16x16x32_bf16 v[208:211], a[184:187], a[248:251], v[208:211]
ds_read_b64_tr_b16 a[158:159], v29 offset:12800
ds_read_b128 v[96:99], v30 offset:1024
s_and_b32 s92, s40, 1
s_mul_i32 s92, s92, 5120
buffer_load_dwordx4 v1, s[28:31], s43 offen offset:1024 sc1 lds
v_mfma_f32_16x16x32_bf16 v[208:211], a[188:191], a[252:255], v[208:211]
ds_read_b128 v[100:103], v30 offset:6144
ds_read_b128 v[104:107], v30 offset:11264
s_lshr_b32 s93, s40, 1
v_mfma_f32_16x16x32_bf16 v[212:215], a[192:195], a[240:243], v[212:215]
ds_read_b128 v[108:111], v30 offset:16384
ds_read_b128 v[112:115], v31 offset:0
s_mul_i32 s94, s93, 3072
v_mfma_f32_16x16x32_bf16 v[212:215], a[196:199], a[244:247], v[212:215]
buffer_load_dwordx4 v1, s[28:31], s43 offen offset:2048 sc1 lds
ds_read_b128 v[116:119], v31 offset:5120
ds_read_b128 v[120:123], v31 offset:10240
s_add_u32 s41, s92, s94
v_mfma_f32_16x16x32_bf16 v[212:215], a[200:203], a[248:251], v[212:215]
ds_read_b128 v[124:127], v31 offset:15360
s_lshl_b32 s93, s93, 20
v_mfma_f32_16x16x32_bf16 v[212:215], a[204:207], a[252:255], v[212:215]
s_add_u32 s47, s41, s93
s_waitcnt lgkmcnt(15)
v_mfma_f32_16x16x32_bf16 v[192:195], a[128:131], a[160:163], v[192:195]
s_getpc_b64 s[92:93]
L_pc_b:
s_lshr_b32 s94, s2, 3
s_add_u32 s51, s49, s48
s_add_u32 s62, s50, s71
v_mfma_f32_16x16x32_bf16 v[192:195], a[132:135], a[164:167], v[192:195]
s_lshl_b32 s94, s94, 2
s_add_u32 s94, s94, s40
s_and_b32 s63, s64, 15
buffer_load_dwordx4 v1, s[28:31], s43 offen offset:3072 sc1 lds
s_lshr_b64 s[64:65], s[64:65], 4
v_mfma_f32_16x16x32_bf16 v[192:195], a[136:139], a[168:171], v[192:195]
s_lshl_b32 s94, s94, 9
v_and_b32 v158, 0x30, v1
s_mul_i32 s42, s63, 442368
v_mfma_f32_16x16x32_bf16 v[192:195], a[140:143], a[172:175], v[192:195]
v_lshl_add_u32 v158, v158, 3, s94
s_mul_i32 s66, s63, 20480
s_add_u32 s42, s42, s45
s_waitcnt lgkmcnt(8)
v_mfma_f32_16x16x32_bf16 v[196:199], a[144:147], a[160:163], v[196:199]
v_min_u32 v158, (L_end-L_pc_b-4), v158
v_mov_b32 v159, s93
s_add_u32 s49, s49, 16384
s_and_b32 s49, s49, 0xffff
v_mfma_f32_16x16x32_bf16 v[196:199], a[148:151], a[164:167], v[196:199]
v_add_co_u32 v158, vcc, s92, v158
s_nop 1
v_addc_co_u32 v159, vcc, 0, v159, vcc
s_add_u32 m0, s44, 4096
s_nop 0
buffer_load_dwordx4 v63, s[28:31], s43 offen sc1 lds
s_sub_u32 s50, s50, 20480
s_cselect_b32 s50, 61440, s50
v_mfma_f32_16x16x32_bf16 v[196:199], a[152:155], a[168:171], v[196:199]
global_load_dword v160, v[158:159], off
v_add_u32 v28, s49, v24
v_add_u32 v29, s49, v25
v_add_u32 v30, s50, v26
v_add_u32 v31, s50, v27
v_mfma_f32_16x16x32_bf16 v[196:199], a[156:159], a[172:175], v[196:199]
s_mov_b32 s44, s62
s_add_u32 s43, s66, s46
s_waitcnt vmcnt(19)
s_waitcnt lgkmcnt(0)
s_barrier
buffer_store_dword v61, v60, s[56:59], s67 offen sc1
s_mov_b32 m0, s51
s_nop 0
buffer_load_dwordx4 v56, s[24:27], s42 offen offset:0 lds
v_mfma_f32_16x16x32_bf16 v[200:203], a[128:131], v[96:99], v[200:203]
ds_read_b64_tr_b16 a[176:177], v28 offset:0
ds_read_b64_tr_b16 a[178:179], v28 offset:512
v_mfma_f32_16x16x32_bf16 v[200:203], a[132:135], v[100:103], v[200:203]
ds_read_b128 a[208:211], v30 offset:0
ds_read_b64_tr_b16 a[180:181], v28 offset:4096
v_mfma_f32_16x16x32_bf16 v[200:203], a[136:139], v[104:107], v[200:203]
buffer_load_dwordx4 v57, s[24:27], s42 offen offset:1024 lds
ds_read_b64_tr_b16 a[182:183], v28 offset:4608
ds_read_b128 a[212:215], v30 offset:5120
v_mfma_f32_16x16x32_bf16 v[200:203], a[140:143], v[108:111], v[200:203]
ds_read_b64_tr_b16 a[184:185], v28 offset:8192
ds_read_b64_tr_b16 a[186:187], v28 offset:8704
v_mfma_f32_16x16x32_bf16 v[204:207], a[144:147], v[96:99], v[204:207]
buffer_load_dwordx4 v58, s[24:27], s42 offen offset:2048 lds
ds_read_b128 a[216:219], v30 offset:10240
ds_read_b64_tr_b16 a[188:189], v28 offset:12288
v_mfma_f32_16x16x32_bf16 v[204:207], a[148:151], v[100:103], v[204:207]
ds_read_b64_tr_b16 a[190:191], v28 offset:12800
ds_read_b128 a[220:223], v30 offset:15360
v_mfma_f32_16x16x32_bf16 v[204:207], a[152:155], v[104:107], v[204:207]
buffer_load_dwordx4 v59, s[24:27], s42 offen offset:3072 lds
ds_read_b64_tr_b16 a[192:193], v29 offset:0
ds_read_b64_tr_b16 a[194:195], v29 offset:512
v_mfma_f32_16x16x32_bf16 v[204:207], a[156:159], v[108:111], v[204:207]
ds_read_b64_tr_b16 a[196:197], v29 offset:4096
v_mfma_f32_16x16x32_bf16 v[208:211], a[128:131], v[112:115], v[208:211]
ds_read_b64_tr_b16 a[198:199], v29 offset:4608
ds_read_b64_tr_b16 a[200:201], v29 offset:8192
s_mov_b32 m0, s44
s_nop 0
buffer_load_dwordx4 v1, s[28:31], s43 offen offset:0 sc1 lds
v_mfma_f32_16x16x32_bf16 v[208:211], a[132:135], v[116:119], v[208:211]
ds_read_b64_tr_b16 a[202:203], v29 offset:8704
ds_read_b64_tr_b16 a[204:205], v29 offset:12288
v_mfma_f32_16x16x32_bf16 v[208:211], a[136:139], v[120:123], v[208:211]
ds_read_b64_tr_b16 a[206:207], v29 offset:12800
ds_read_b128 a[224:227], v30 offset:1024
v_mfma_f32_16x16x32_bf16 v[208:211], a[140:143], v[124:127], v[208:211]
buffer_load_dwordx4 v1, s[28:31], s43 offen offset:1024 sc1 lds
ds_read_b128 a[228:231], v30 offset:6144
ds_read_b128 a[232:235], v30 offset:11264
v_mfma_f32_16x16x32_bf16 v[212:215], a[144:147], v[112:115], v[212:215]
ds_read_b128 a[236:239], v30 offset:16384
ds_read_b128 a[240:243], v31 offset:0
v_mfma_f32_16x16x32_bf16 v[212:215], a[148:151], v[116:119], v[212:215]
buffer_load_dwordx4 v1, s[28:31], s43 offen offset:2048 sc1 lds
ds_read_b128 a[244:247], v31 offset:5120
ds_read_b128 a[248:251], v31 offset:10240
v_mfma_f32_16x16x32_bf16 v[212:215], a[152:155], v[120:123], v[212:215]
ds_read_b128 a[252:255], v31 offset:15360
v_mfma_f32_16x16x32_bf16 v[212:215], a[156:159], v[124:127], v[212:215]
s_mov_b32 s83, 3
.p2align 3
L_m1a:
s_cmp_lg_u32 s83, 1
s_cbranch_scc1 L_np_o
buffer_load_dword v156, v5, s[56:59], 0 offen sc1
buffer_load_dword v157, v6, s[56:59], 0 offen sc1
L_np_o:
s_waitcnt lgkmcnt(15)
v_mfma_f32_16x16x32_bf16 v[192:195], a[176:179], a[208:211], v[192:195]
s_add_u32 s51, s49, s48
s_add_u32 s62, s50, s71
v_mfma_f32_16x16x32_bf16 v[192:195], a[180:183], a[212:215], v[192:195]
s_and_b32 s63, s64, 15
buffer_load_dwordx4 v1, s[28:31], s43 offen offset:3072 sc1 lds
s_lshr_b64 s[64:65], s[64:65], 4
v_mfma_f32_16x16x32_bf16 v[192:195], a[184:187], a[216:219], v[192:195]
s_mul_i32 s42, s63, 442368
v_mfma_f32_16x16x32_bf16 v[192:195], a[188:191], a[220:223], v[192:195]
s_mul_i32 s66, s63, 20480
s_add_u32 s42, s42, s45
s_waitcnt lgkmcnt(8)
v_mfma_f32_16x16x32_bf16 v[196:199], a[192:195], a[208:211], v[196:199]
s_add_u32 s49, s49, 16384
s_and_b32 s49, s49, 0xffff
v_mfma_f32_16x16x32_bf16 v[196:199], a[196:199], a[212:215], v[196:199]
s_sub_u32 s50, s50, 20480
s_cselect_b32 s50, 61440, s50
v_mfma_f32_16x16x32_bf16 v[196:199], a[200:203], a[216:219], v[196:199]
s_add_u32 m0, s44, 4096
s_nop 0
buffer_load_dwordx4 v63, s[28:31], s43 offen sc1 lds
v_add_u32 v28, s49, v24
v_add_u32 v29, s49, v25
v_add_u32 v30, s50, v26
v_add_u32 v31, s50, v27
v_mfma_f32_16x16x32_bf16 v[196:199], a[204:207], a[220:223], v[196:199]
s_mov_b32 s44, s62
s_add_u32 s43, s66, s46
s_waitcnt vmcnt(18)
s_waitcnt lgkmcnt(0)
s_barrier
s_mov_b32 m0, s51
s_nop 0
buffer_load_dwordx4 v56, s[24:27], s42 offen offset:0 lds
v_mfma_f32_16x16x32_bf16 v[200:203], a[176:179], a[224:227], v[200:203]
ds_read_b64_tr_b16 a[128:129], v28 offset:0
ds_read_b64_tr_b16 a[130:131], v28 offset:512
v_mfma_f32_16x16x32_bf16 v[200:203], a[180:183], a[228:231], v[200:203]
ds_read_b128 a[160:163], v30 offset:0
ds_read_b64_tr_b16 a[132:133], v28 offset:4096
v_mfma_f32_16x16x32_bf16 v[200:203], a[184:187], a[232:235], v[200:203]
buffer_load_dwordx4 v57, s[24:27], s42 offen offset:1024 lds
ds_read_b64_tr_b16 a[134:135], v28 offset:4608
ds_read_b128 a[164:167], v30 offset:5120
v_mfma_f32_16x16x32_bf16 v[200:203], a[188:191], a[236:239], v[200:203]
ds_read_b64_tr_b16 a[136:137], v28 offset:8192
ds_read_b64_tr_b16 a[138:139], v28 offset:8704
v_mfma_f32_16x16x32_bf16 v[204:207], a[192:195], a[224:227], v[204:207]
buffer_load_dwordx4 v58, s[24:27], s42 offen offset:2048 lds
ds_read_b128 a[168:171], v30 offset:10240
ds_read_b64_tr_b16 a[140:141], v28 offset:12288
v_mfma_f32_16x16x32_bf16 v[204:207], a[196:199], a[228:231], v[204:207]
ds_read_b64_tr_b16 a[142:143], v28 offset:12800
ds_read_b128 a[172:175], v30 offset:15360
v_mfma_f32_16x16x32_bf16 v[204:207], a[200:203], a[232:235], v[204:207]
buffer_load_dwordx4 v59, s[24:27], s42 offen offset:3072 lds
ds_read_b64_tr_b16 a[144:145], v29 offset:0
ds_read_b64_tr_b16 a[146:147], v29 offset:512
v_mfma_f32_16x16x32_bf16 v[204:207], a[204:207], a[236:239], v[204:207]
ds_read_b64_tr_b16 a[148:149], v29 offset:4096
v_mfma_f32_16x16x32_bf16 v[208:211], a[176:179], a[240:243], v[208:211]
ds_read_b64_tr_b16 a[150:151], v29 offset:4608
ds_read_b64_tr_b16 a[152:153], v29 offset:8192
s_mov_b32 m0, s44
s_nop 0
buffer_load_dwordx4 v1, s[28:31], s43 offen offset:0 sc1 lds
v_mfma_f32_16x16x32_bf16 v[208:211], a[180:183], a[244:247], v[208:211]
ds_read_b64_tr_b16 a[154:155], v29 offset:8704
ds_read_b64_tr_b16 a[156:157], v29 offset:12288
v_mfma_f32_16x16x32_bf16 v[208:211], a[184:187], a[248:251], v[208:211]
ds_read_b64_tr_b16 a[158:159], v29 offset:12800
ds_read_b128 v[96:99], v30 offset:1024
v_mfma_f32_16x16x32_bf16 v[208:211], a[188:191], a[252:255], v[208:211]
buffer_load_dwordx4 v1, s[28:31], s43 offen offset:1024 sc1 lds
ds_read_b128 v[100:103], v30 offset:6144
ds_read_b128 v[104:107], v30 offset:11264
v_mfma_f32_16x16x32_bf16 v[212:215], a[192:195], a[240:243], v[212:215]
ds_read_b128 v[108:111], v30 offset:16384
ds_read_b128 v[112:115], v31 offset:0
v_mfma_f32_16x16x32_bf16 v[212:215], a[196:199], a[244:247], v[212:215]
buffer_load_dwordx4 v1, s[28:31], s43 offen offset:2048 sc1 lds
ds_read_b128 v[116:119], v31 offset:5120
ds_read_b128 v[120:123], v31 offset:10240
v_mfma_f32_16x16x32_bf16 v[212:215], a[200:203], a[248:251], v[212:215]
ds_read_b128 v[124:127], v31 offset:15360
v_mfma_f32_16x16x32_bf16 v[212:215], a[204:207], a[252:255], v[212:215]
s_waitcnt lgkmcnt(15)
v_mfma_f32_16x16x32_bf16 v[192:195], a[128:131], a[160:163], v[192:195]
s_add_u32 s51, s49, s48
s_add_u32 s62, s50, s71
v_mfma_f32_16x16x32_bf16 v[192:195], a[132:135], a[164:167], v[192:195]
s_and_b32 s63, s64, 15
s_lshr_b64 s[64:65], s[64:65], 4
buffer_load_dwordx4 v1, s[28:31], s43 offen offset:3072 sc1 lds
v_mfma_f32_16x16x32_bf16 v[192:195], a[136:139], a[168:171], v[192:195]
s_mul_i32 s42, s63, 442368
v_mfma_f32_16x16x32_bf16 v[192:195], a[140:143], a[172:175], v[192:195]
s_mul_i32 s66, s63, 20480
s_add_u32 s42, s42, s45
s_waitcnt lgkmcnt(8)
v_mfma_f32_16x16x32_bf16 v[196:199], a[144:147], a[160:163], v[196:199]
s_add_u32 s49, s49, 16384
s_and_b32 s49, s49, 0xffff
v_mfma_f32_16x16x32_bf16 v[196:199], a[148:151], a[164:167], v[196:199]
s_sub_u32 s50, s50, 20480
s_cselect_b32 s50, 61440, s50
v_mfma_f32_16x16x32_bf16 v[196:199], a[152:155], a[168:171], v[196:199]
s_add_u32 m0, s44, 4096
s_nop 0
buffer_load_dwordx4 v63, s[28:31], s43 offen sc1 lds
v_add_u32 v28, s49, v24
v_add_u32 v29, s49, v25
v_add_u32 v30, s50, v26
v_add_u32 v31, s50, v27
v_mfma_f32_16x16x32_bf16 v[196:199], a[156:159], a[172:175], v[196:199]
s_mov_b32 s44, s62
s_add_u32 s43, s66, s46
s_waitcnt vmcnt(18)
s_waitcnt lgkmcnt(0)
s_barrier
s_mov_b32 m0, s51
s_nop 0
buffer_load_dwordx4 v56, s[24:27], s42 offen offset:0 lds
v_mfma_f32_16x16x32_bf16 v[200:203], a[128:131], v[96:99], v[200:203]
ds_read_b64_tr_b16 a[176:177], v28 offset:0
ds_read_b64_tr_b16 a[178:179], v28 offset:512
v_mfma_f32_16x16x32_bf16 v[200:203], a[132:135], v[100:103], v[200:203]
ds_read_b128 a[208:211], v30 offset:0
ds_read_b64_tr_b16 a[180:181], v28 offset:4096
v_mfma_f32_16x16x32_bf16 v[200:203], a[136:139], v[104:107], v[200:203]
buffer_load_dwordx4 v57, s[24:27], s42 offen offset:1024 lds
ds_read_b64_tr_b16 a[182:183], v28 offset:4608
ds_read_b128 a[212:215], v30 offset:5120
v_mfma_f32_16x16x32_bf16 v[200:203], a[140:143], v[108:111], v[200:203]
ds_read_b64_tr_b16 a[184:185], v28 offset:8192
ds_read_b64_tr_b16 a[186:187], v28 offset:8704
v_mfma_f32_16x16x32_bf16 v[204:207], a[144:147], v[96:99], v[204:207]
buffer_load_dwordx4 v58, s[24:27], s42 offen offset:2048 lds
ds_read_b128 a[216:219], v30 offset:10240
ds_read_b64_tr_b16 a[188:189], v28 offset:12288
v_mfma_f32_16x16x32_bf16 v[204:207], a[148:151], v[100:103], v[204:207]
ds_read_b64_tr_b16 a[190:191], v28 offset:12800
ds_read_b128 a[220:223], v30 offset:15360
v_mfma_f32_16x16x32_bf16 v[204:207], a[152:155], v[104:107], v[204:207]
buffer_load_dwordx4 v59, s[24:27], s42 offen offset:3072 lds
ds_read_b64_tr_b16 a[192:193], v29 offset:0
ds_read_b64_tr_b16 a[194:195], v29 offset:512
v_mfma_f32_16x16x32_bf16 v[204:207], a[156:159], v[108:111], v[204:207]
ds_read_b64_tr_b16 a[196:197], v29 offset:4096
v_mfma_f32_16x16x32_bf16 v[208:211], a[128:131], v[112:115], v[208:211]
ds_read_b64_tr_b16 a[198:199], v29 offset:4608
ds_read_b64_tr_b16 a[200:201], v29 offset:8192
s_mov_b32 m0, s44
s_nop 0
buffer_load_dwordx4 v1, s[28:31], s43 offen offset:0 sc1 lds
v_mfma_f32_16x16x32_bf16 v[208:211], a[132:135], v[116:119], v[208:211]
ds_read_b64_tr_b16 a[202:203], v29 offset:8704
ds_read_b64_tr_b16 a[204:205], v29 offset:12288
v_mfma_f32_16x16x32_bf16 v[208:211], a[136:139], v[120:123], v[208:211]
ds_read_b64_tr_b16 a[206:207], v29 offset:12800
ds_read_b128 a[224:227], v30 offset:1024
v_mfma_f32_16x16x32_bf16 v[208:211], a[140:143], v[124:127], v[208:211]
buffer_load_dwordx4 v1, s[28:31], s43 offen offset:1024 sc1 lds
ds_read_b128 a[228:231], v30 offset:6144
ds_read_b128 a[232:235], v30 offset:11264
v_mfma_f32_16x16x32_bf16 v[212:215], a[144:147], v[112:115], v[212:215]
ds_read_b128 a[236:239], v30 offset:16384
ds_read_b128 a[240:243], v31 offset:0
v_mfma_f32_16x16x32_bf16 v[212:215], a[148:151], v[116:119], v[212:215]
buffer_load_dwordx4 v1, s[28:31], s43 offen offset:2048 sc1 lds
ds_read_b128 a[244:247], v31 offset:5120
ds_read_b128 a[248:251], v31 offset:10240
v_mfma_f32_16x16x32_bf16 v[212:215], a[152:155], v[120:123], v[212:215]
ds_read_b128 a[252:255], v31 offset:15360
v_mfma_f32_16x16x32_bf16 v[212:215], a[156:159], v[124:127], v[212:215]
s_sub_u32 s83, s83, 1
s_cmp_lg_u32 s83, 0
s_cbranch_scc1 L_m1a
s_waitcnt lgkmcnt(15)
v_mfma_f32_16x16x32_bf16 v[192:195], a[176:179], a[208:211], v[192:195]
s_add_u32 s51, s49, s96
s_add_u32 s62, s50, s97
s_add_u32 s63, s53, s54
v_mfma_f32_16x16x32_bf16 v[192:195], a[180:183], a[212:215], v[192:195]
s_and_b32 s63, s63, 3
s_mov_b32 s64, 0x65832140
buffer_load_dwordx4 v1, s[28:31], s43 offen offset:3072 sc1 lds
s_mov_b32 s65, 0xfedba9c7
v_mfma_f32_16x16x32_bf16 v[192:195], a[184:187], a[216:219], v[192:195]
s_cmp_eq_u32 s63, 1
s_cselect_b32 s64, 0x69432501, s64
s_cselect_b32 s65, 0xfecbad87, s65
s_cmp_eq_u32 s63, 2
s_cselect_b32 s64, 0xa5436102, s64
s_cselect_b32 s65, 0xfdcbe987, s65
v_mfma_f32_16x16x32_bf16 v[192:195], a[188:191], a[220:223], v[192:195]
s_cmp_eq_u32 s63, 3
s_cselect_b32 s64, 0x65472103, s64
s_cselect_b32 s65, 0xedcfa98b, s65
s_and_b32 s63, s64, 15
s_lshr_b64 s[64:65], s[64:65], 4
s_waitcnt lgkmcnt(8)
v_mfma_f32_16x16x32_bf16 v[196:199], a[192:195], a[208:211], v[196:199]
s_mul_i32 s42, s63, 8192
s_mul_i32 s66, s63, 10240
s_add_u32 s49, s49, 16384
v_mfma_f32_16x16x32_bf16 v[196:199], a[196:199], a[212:215], v[196:199]
s_and_b32 s49, s49, 0xffff
s_add_u32 m0, s44, 4096
s_nop 0
buffer_load_dwordx4 v63, s[28:31], s43 offen sc1 lds
s_sub_u32 s50, s50, 20480
s_cselect_b32 s50, 61440, s50
v_mfma_f32_16x16x32_bf16 v[196:199], a[200:203], a[216:219], v[196:199]
v_add_u32 v28, s49, v24
v_add_u32 v29, s49, v25
v_add_u32 v30, s50, v26
v_add_u32 v31, s50, v27
v_mfma_f32_16x16x32_bf16 v[196:199], a[204:207], a[220:223], v[196:199]
s_mov_b32 s44, s62
s_mov_b32 s43, s66
s_waitcnt vmcnt(18)
s_waitcnt lgkmcnt(0)
s_barrier
v_cmp_ne_u32 vcc, s82, v156
s_nop 3
s_cbranch_vccnz L_spin_o
L_ok_o:
v_cmp_ne_u32 vcc, s82, v157
s_nop 3
s_cbranch_vccnz L_spin_l
L_ok_l:
s_mov_b32 m0, s51
s_nop 0
buffer_load_dwordx4 v1, s[12:15], s42 offen offset:0 sc1 lds
v_mfma_f32_16x16x32_bf16 v[200:203], a[176:179], a[224:227], v[200:203]
ds_read_b64_tr_b16 a[128:129], v28 offset:0
ds_read_b64_tr_b16 a[130:131], v28 offset:512
v_mfma_f32_16x16x32_bf16 v[200:203], a[180:183], a[228:231], v[200:203]
ds_read_b128 a[160:163], v30 offset:0
ds_read_b64_tr_b16 a[132:133], v28 offset:4096
v_mfma_f32_16x16x32_bf16 v[200:203], a[184:187], a[232:235], v[200:203]
buffer_load_dwordx4 v1, s[12:15], s42 offen offset:1024 sc1 lds
ds_read_b64_tr_b16 a[134:135], v28 offset:4608
ds_read_b128 a[164:167], v30 offset:5120
v_mfma_f32_16x16x32_bf16 v[200:203], a[188:191], a[236:239], v[200:203]
ds_read_b64_tr_b16 a[136:137], v28 offset:8192
ds_read_b64_tr_b16 a[138:139], v28 offset:8704
v_mfma_f32_16x16x32_bf16 v[204:207], a[192:195], a[224:227], v[204:207]
buffer_load_dwordx4 v1, s[12:15], s42 offen offset:2048 sc1 lds
ds_read_b128 a[168:171], v30 offset:10240
ds_read_b64_tr_b16 a[140:141], v28 offset:12288
v_mfma_f32_16x16x32_bf16 v[204:207], a[196:199], a[228:231], v[204:207]
ds_read_b64_tr_b16 a[142:143], v28 offset:12800
ds_read_b128 a[172:175], v30 offset:15360
v_mfma_f32_16x16x32_bf16 v[204:207], a[200:203], a[232:235], v[204:207]
buffer_load_dwordx4 v1, s[12:15], s42 offen offset:3072 sc1 lds
ds_read_b64_tr_b16 a[144:145], v29 offset:0
ds_read_b64_tr_b16 a[146:147], v29 offset:512
v_mfma_f32_16x16x32_bf16 v[204:207], a[204:207], a[236:239], v[204:207]
ds_read_b64_tr_b16 a[148:149], v29 offset:4096
v_mfma_f32_16x16x32_bf16 v[208:211], a[176:179], a[240:243], v[208:211]
ds_read_b64_tr_b16 a[150:151], v29 offset:4608
ds_read_b64_tr_b16 a[152:153], v29 offset:8192
s_mov_b32 m0, s44
s_nop 0
buffer_load_dwordx4 v1, s[16:19], s43 offen offset:0 sc1 lds
v_mfma_f32_16x16x32_bf16 v[208:211], a[180:183], a[244:247], v[208:211]
ds_read_b64_tr_b16 a[154:155], v29 offset:8704
ds_read_b64_tr_b16 a[156:157], v29 offset:12288
v_mfma_f32_16x16x32_bf16 v[208:211], a[184:187], a[248:251], v[208:211]
ds_read_b64_tr_b16 a[158:159], v29 offset:12800
ds_read_b128 v[96:99], v30 offset:1024
v_mfma_f32_16x16x32_bf16 v[208:211], a[188:191], a[252:255], v[208:211]
buffer_load_dwordx4 v1, s[16:19], s43 offen offset:1024 sc1 lds
ds_read_b128 v[100:103], v30 offset:6144
ds_read_b128 v[104:107], v30 offset:11264
v_mfma_f32_16x16x32_bf16 v[212:215], a[192:195], a[240:243], v[212:215]
ds_read_b128 v[108:111], v30 offset:16384
ds_read_b128 v[112:115], v31 offset:0
v_mfma_f32_16x16x32_bf16 v[212:215], a[196:199], a[244:247], v[212:215]
buffer_load_dwordx4 v1, s[16:19], s43 offen offset:2048 sc1 lds
ds_read_b128 v[116:119], v31 offset:5120
ds_read_b128 v[120:123], v31 offset:10240
v_mfma_f32_16x16x32_bf16 v[212:215], a[200:203], a[248:251], v[212:215]
ds_read_b128 v[124:127], v31 offset:15360
v_mfma_f32_16x16x32_bf16 v[212:215], a[204:207], a[252:255], v[212:215]
s_waitcnt lgkmcnt(15)
v_mfma_f32_16x16x32_bf16 v[192:195], a[128:131], a[160:163], v[192:195]
s_lshl_b32 s67, s53, 1
s_lshr_b32 s92, s55, 1
s_add_u32 s67, s67, s92
s_add_u32 s51, s49, s96
s_add_u32 s62, s50, s97
v_mfma_f32_16x16x32_bf16 v[192:195], a[132:135], a[164:167], v[192:195]
s_lshl_b32 s68, s54, 1
s_and_b32 s92, s55, 1
s_add_u32 s68, s68, s92
s_and_b32 s63, s64, 15
buffer_load_dwordx4 v1, s[16:19], s43 offen offset:3072 sc1 lds
v_mfma_f32_16x16x32_bf16 v[192:195], a[136:139], a[168:171], v[192:195]
s_mul_i32 s92, s68, 276480
s_add_u32 s92, s92, 33554432
s_add_u32 s4, s84, s92
s_addc_u32 s5, s85, 0
s_lshr_b64 s[64:65], s[64:65], 4
s_mul_i32 s42, s63, 8192
v_mfma_f32_16x16x32_bf16 v[192:195], a[140:143], a[172:175], v[192:195]
s_mov_b32 s6, 276480
s_mov_b32 s7, 0x20000
s_lshl_b32 s92, s67, 7
s_mul_i32 s66, s63, 10240
s_waitcnt lgkmcnt(8)
v_mfma_f32_16x16x32_bf16 v[196:199], a[144:147], a[160:163], v[196:199]
s_add_u32 s8, s76, s92
s_addc_u32 s9, s77, 0
s_mov_b32 s10, 7073920
s_mov_b32 s11, 0x20000
s_add_u32 s49, s49, 16384
s_and_b32 s49, s49, 0xffff
v_mfma_f32_16x16x32_bf16 v[196:199], a[148:151], a[164:167], v[196:199]
s_lshl_b32 s45, s40, 17
s_mul_i32 s46, s40, 5120
s_add_u32 m0, s44, 4096
s_nop 0
buffer_load_dwordx4 v63, s[16:19], s43 offen sc1 lds
s_lshl_b32 s92, s67, 2
s_sub_u32 s50, s50, 20480
s_cselect_b32 s50, 61440, s50
v_mfma_f32_16x16x32_bf16 v[196:199], a[152:155], a[168:171], v[196:199]
s_add_u32 s92, s92, s40
s_lshl_b32 s93, s92, 5
v_add_u32 v28, s49, v24
v_add_u32 v29, s49, v25
v_add_u32 v30, s50, v26
v_add_u32 v31, s50, v27
v_mfma_f32_16x16x32_bf16 v[196:199], a[156:159], a[172:175], v[196:199]
s_mov_b32 s44, s62
s_mov_b32 s43, s66
s_waitcnt vmcnt(18)
s_waitcnt lgkmcnt(0)
s_barrier
s_mov_b32 m0, s51
s_nop 0
buffer_load_dwordx4 v1, s[12:15], s42 offen offset:0 sc1 lds
v_mfma_f32_16x16x32_bf16 v[200:203], a[128:131], v[96:99], v[200:203]
ds_read_b64_tr_b16 a[176:177], v28 offset:0
ds_read_b64_tr_b16 a[178:179], v28 offset:512
s_add_u32 s28, s78, s93
s_addc_u32 s29, s79, 0
s_mov_b32 s30, 32
v_mfma_f32_16x16x32_bf16 v[200:203], a[132:135], v[100:103], v[200:203]
ds_read_b128 a[208:211], v30 offset:0
ds_read_b64_tr_b16 a[180:181], v28 offset:4096
s_mov_b32 s31, 0x20000
v_mfma_f32_16x16x32_bf16 v[200:203], a[136:139], v[104:107], v[200:203]
buffer_load_dwordx4 v1, s[12:15], s42 offen offset:1024 sc1 lds
ds_read_b64_tr_b16 a[182:183], v28 offset:4608
ds_read_b128 a[212:215], v30 offset:5120
s_mul_i32 s92, s92, 20480
v_mfma_f32_16x16x32_bf16 v[200:203], a[140:143], v[108:111], v[200:203]
ds_read_b64_tr_b16 a[184:185], v28 offset:8192
ds_read_b64_tr_b16 a[186:187], v28 offset:8704
s_mul_i32 s93, s68, 160
v_mfma_f32_16x16x32_bf16 v[204:207], a[144:147], v[96:99], v[204:207]
buffer_load_dwordx4 v1, s[12:15], s42 offen offset:2048 sc1 lds
ds_read_b128 a[216:219], v30 offset:10240
ds_read_b64_tr_b16 a[188:189], v28 offset:12288
s_add_u32 s92, s92, s93
s_add_u32 s24, s60, s92
s_addc_u32 s25, s61, 0
v_mfma_f32_16x16x32_bf16 v[204:207], a[148:151], v[100:103], v[204:207]
ds_read_b64_tr_b16 a[190:191], v28 offset:12800
ds_read_b128 a[220:223], v30 offset:15360
s_mov_b32 s26, 19360
v_mfma_f32_16x16x32_bf16 v[204:207], a[152:155], v[104:107], v[204:207]
ds_read_b64_tr_b16 a[192:193], v29 offset:0
buffer_load_dwordx4 v1, s[12:15], s42 offen offset:3072 sc1 lds
ds_read_b64_tr_b16 a[194:195], v29 offset:512
s_mov_b32 s27, 0x20000
v_mfma_f32_16x16x32_bf16 v[204:207], a[156:159], v[108:111], v[204:207]
ds_read_b64_tr_b16 a[196:197], v29 offset:4096
s_add_u32 s36, s80, s92
s_addc_u32 s37, s81, 0
v_mfma_f32_16x16x32_bf16 v[208:211], a[128:131], v[112:115], v[208:211]
ds_read_b64_tr_b16 a[198:199], v29 offset:4608
ds_read_b64_tr_b16 a[200:201], v29 offset:8192
s_mov_b32 s38, 19360
s_mov_b32 m0, s44
s_nop 0
buffer_load_dwordx4 v1, s[16:19], s43 offen offset:0 sc1 lds
s_mov_b32 s39, 0x20000
v_mfma_f32_16x16x32_bf16 v[208:211], a[132:135], v[116:119], v[208:211]
ds_read_b64_tr_b16 a[202:203], v29 offset:8704
ds_read_b64_tr_b16 a[204:205], v29 offset:12288
s_lshl_b32 s92, s53, 2
v_mfma_f32_16x16x32_bf16 v[208:211], a[136:139], v[120:123], v[208:211]
ds_read_b64_tr_b16 a[206:207], v29 offset:12800
ds_read_b128 a[224:227], v30 offset:1024
s_add_u32 s92, s92, s54
v_mfma_f32_16x16x32_bf16 v[208:211], a[140:143], v[124:127], v[208:211]
buffer_load_dwordx4 v1, s[16:19], s43 offen offset:1024 sc1 lds
ds_read_b128 a[228:231], v30 offset:6144
ds_read_b128 a[232:235], v30 offset:11264
s_mul_i32 s92, s92, 163840
v_mfma_f32_16x16x32_bf16 v[212:215], a[144:147], v[112:115], v[212:215]
ds_read_b128 a[236:239], v30 offset:16384
ds_read_b128 a[240:243], v31 offset:0
s_add_u32 s92, s92, 67108864
s_add_u32 s20, s84, s92
s_addc_u32 s21, s85, 0
v_mfma_f32_16x16x32_bf16 v[212:215], a[148:151], v[116:119], v[212:215]
buffer_load_dwordx4 v1, s[16:19], s43 offen offset:2048 sc1 lds
ds_read_b128 a[244:247], v31 offset:5120
ds_read_b128 a[248:251], v31 offset:10240
s_mov_b32 s22, 163840
v_mfma_f32_16x16x32_bf16 v[212:215], a[152:155], v[120:123], v[212:215]
ds_read_b128 a[252:255], v31 offset:15360
s_mov_b32 s23, 0x20000
v_mfma_f32_16x16x32_bf16 v[212:215], a[156:159], v[124:127], v[212:215]
v_lshrrev_b32 v60, 4, v1
s_waitcnt lgkmcnt(15)
v_mfma_f32_16x16x32_bf16 v[192:195], a[176:179], a[208:211], v[192:195]
v_lshrrev_b32 v61, 4, v60
v_and_b32 v62, 15, v60
v_lshrrev_b32 v56, 2, v62
s_add_u32 s51, s49, s96
s_add_u32 s62, s50, s97
v_mfma_f32_16x16x32_bf16 v[192:195], a[180:183], a[212:215], v[192:195]
v_lshl_add_u32 v56, v61, 2, v56
v_and_b32 v57, 3, v60
v_lshlrev_b32 v58, 7, v56
s_and_b32 s63, s64, 15
buffer_load_dwordx4 v1, s[16:19], s43 offen offset:3072 sc1 lds
v_mfma_f32_16x16x32_bf16 v[192:195], a[184:187], a[216:219], v[192:195]
v_lshl_add_u32 v58, v57, 3, v58
v_lshrrev_b32 v56, 1, v56
v_and_b32 v56, 3, v56
s_lshr_b64 s[64:65], s[64:65], 4
s_mul_i32 s42, s63, 8192
v_mfma_f32_16x16x32_bf16 v[192:195], a[188:191], a[220:223], v[192:195]
v_xor_b32 v56, s40, v56
v_lshl_add_u32 v12, v56, 5, v58
v_add_u32 v18, 81920, v1
s_mul_i32 s66, s63, 10240
s_waitcnt lgkmcnt(8)
v_mfma_f32_16x16x32_bf16 v[196:199], a[192:195], a[208:211], v[196:199]
v_lshrrev_b32 v56, 3, v60
v_and_b32 v57, 6, v56
v_and_b32 v58, 7, v60
s_add_u32 s49, s49, 16384
s_and_b32 s49, s49, 0xffff
v_mfma_f32_16x16x32_bf16 v[196:199], a[196:199], a[212:215], v[196:199]
v_xor_b32 v57, v57, v58
v_lshlrev_b32 v56, 12, v56
s_add_u32 m0, s44, 4096
s_nop 0
buffer_load_dwordx4 v63, s[16:19], s43 offen sc1 lds
v_lshl_add_u32 v56, v57, 4, v56
s_sub_u32 s50, s50, 20480
s_cselect_b32 s50, 61440, s50
v_mfma_f32_16x16x32_bf16 v[196:199], a[200:203], a[216:219], v[196:199]
v_add_u32 v8, 0, v56
v_add_u32 v9, 31744, v56
v_add_u32 v28, s49, v24
v_add_u32 v29, s49, v25
v_add_u32 v30, s50, v26
v_add_u32 v31, s50, v27
v_mfma_f32_16x16x32_bf16 v[196:199], a[204:207], a[220:223], v[196:199]
s_mov_b32 s44, s62
s_mov_b32 s43, s66
s_waitcnt vmcnt(18)
s_waitcnt lgkmcnt(0)
s_barrier
s_mov_b32 m0, s51
s_nop 0
buffer_load_dwordx4 v1, s[12:15], s42 offen offset:0 sc1 lds
v_mfma_f32_16x16x32_bf16 v[200:203], a[176:179], a[224:227], v[200:203]
ds_read_b64_tr_b16 a[128:129], v28 offset:0
ds_read_b64_tr_b16 a[130:131], v28 offset:512
v_add_u32 v10, 63488, v56
v_add_u32 v11, 95232, v56
v_mfma_f32_16x16x32_bf16 v[200:203], a[180:183], a[228:231], v[200:203]
ds_read_b128 a[160:163], v30 offset:0
ds_read_b64_tr_b16 a[132:133], v28 offset:4096
v_mul_u32_u24 v21, 1280, v62
v_mfma_f32_16x16x32_bf16 v[200:203], a[184:187], a[232:235], v[200:203]
buffer_load_dwordx4 v1, s[12:15], s42 offen offset:1024 sc1 lds
ds_read_b64_tr_b16 a[134:135], v28 offset:4608
ds_read_b128 a[164:167], v30 offset:5120
v_lshl_add_u32 v21, v61, 3, v21
v_mfma_f32_16x16x32_bf16 v[200:203], a[188:191], a[236:239], v[200:203]
ds_read_b64_tr_b16 a[136:137], v28 offset:8192
ds_read_b64_tr_b16 a[138:139], v28 offset:8704
v_lshlrev_b32 v16, 1, v62
v_mfma_f32_16x16x32_bf16 v[204:207], a[192:195], a[224:227], v[204:207]
buffer_load_dwordx4 v1, s[12:15], s42 offen offset:2048 sc1 lds
ds_read_b128 a[168:171], v30 offset:10240
ds_read_b64_tr_b16 a[140:141], v28 offset:12288
v_lshrrev_b32 v17, 1, v1
s_lshl_b32 s92, s68, 7
v_mfma_f32_16x16x32_bf16 v[204:207], a[196:199], a[228:231], v[204:207]
ds_read_b64_tr_b16 a[142:143], v28 offset:12800
ds_read_b128 a[172:175], v30 offset:15360
s_add_u32 s92, s92, 4096
v_mfma_f32_16x16x32_bf16 v[204:207], a[200:203], a[232:235], v[204:207]
ds_read_b64_tr_b16 a[144:145], v29 offset:0
buffer_load_dwordx4 v1, s[12:15], s42 offen offset:3072 sc1 lds
ds_read_b64_tr_b16 a[146:147], v29 offset:512
v_lshrrev_b32 v5, 4, v1
v_mfma_f32_16x16x32_bf16 v[204:207], a[204:207], a[236:239], v[204:207]
ds_read_b64_tr_b16 a[148:149], v29 offset:4096
v_min_u32 v5, 26, v5
v_mfma_f32_16x16x32_bf16 v[208:211], a[176:179], a[240:243], v[208:211]
ds_read_b64_tr_b16 a[150:151], v29 offset:4608
ds_read_b64_tr_b16 a[152:153], v29 offset:8192
v_lshl_add_u32 v5, v5, 2, s92
s_mov_b32 m0, s44
s_nop 0
buffer_load_dwordx4 v1, s[16:19], s43 offen offset:0 sc1 lds
s_lshl_b32 s92, s53, 2
v_mfma_f32_16x16x32_bf16 v[208:211], a[180:183], a[244:247], v[208:211]
ds_read_b64_tr_b16 a[154:155], v29 offset:8704
ds_read_b64_tr_b16 a[156:157], v29 offset:12288
s_add_u32 s92, s92, s54
v_mfma_f32_16x16x32_bf16 v[208:211], a[184:187], a[248:251], v[208:211]
ds_read_b64_tr_b16 a[158:159], v29 offset:12800
ds_read_b128 v[96:99], v30 offset:1024
s_lshl_b32 s92, s92, 4
v_mfma_f32_16x16x32_bf16 v[208:211], a[188:191], a[252:255], v[208:211]
buffer_load_dwordx4 v1, s[16:19], s43 offen offset:1024 sc1 lds
ds_read_b128 v[100:103], v30 offset:6144
ds_read_b128 v[104:107], v30 offset:11264
s_add_u32 s92, s92, 5120
v_mfma_f32_16x16x32_bf16 v[212:215], a[192:195], a[240:243], v[212:215]
ds_read_b128 v[108:111], v30 offset:16384
ds_read_b128 v[112:115], v31 offset:0
v_lshrrev_b32 v15, 4, v1
v_and_b32 v15, 3, v15
v_mfma_f32_16x16x32_bf16 v[212:215], a[196:199], a[244:247], v[212:215]
buffer_load_dwordx4 v1, s[16:19], s43 offen offset:2048 sc1 lds
ds_read_b128 v[116:119], v31 offset:5120
ds_read_b128 v[120:123], v31 offset:10240
v_lshl_add_u32 v15, v15, 2, s92
v_mfma_f32_16x16x32_bf16 v[212:215], a[200:203], a[248:251], v[212:215]
ds_read_b128 v[124:127], v31 offset:15360
s_lshl_b32 s93, s55, 2
v_mfma_f32_16x16x32_bf16 v[212:215], a[204:207], a[252:255], v[212:215]
s_add_u32 s69, s92, s93
s_waitcnt lgkmcnt(15)
v_mfma_f32_16x16x32_bf16 v[192:195], a[128:131], a[160:163], v[192:195]
s_add_u32 s51, s49, s96
s_add_u32 s62, s50, s97
v_mfma_f32_16x16x32_bf16 v[192:195], a[132:135], a[164:167], v[192:195]
s_and_b32 s63, s64, 15
buffer_load_dwordx4 v1, s[16:19], s43 offen offset:3072 sc1 lds
v_mfma_f32_16x16x32_bf16 v[192:195], a[136:139], a[168:171], v[192:195]
s_lshr_b64 s[64:65], s[64:65], 4
s_mul_i32 s42, s63, 8192
v_mfma_f32_16x16x32_bf16 v[192:195], a[140:143], a[172:175], v[192:195]
s_mul_i32 s66, s63, 10240
s_waitcnt lgkmcnt(8)
v_mfma_f32_16x16x32_bf16 v[196:199], a[144:147], a[160:163], v[196:199]
s_add_u32 s49, s49, 16384
s_and_b32 s49, s49, 0xffff
v_mfma_f32_16x16x32_bf16 v[196:199], a[148:151], a[164:167], v[196:199]
s_sub_u32 s50, s50, 20480
s_cselect_b32 s50, 61440, s50
s_add_u32 m0, s44, 4096
s_nop 0
buffer_load_dwordx4 v63, s[16:19], s43 offen sc1 lds
v_mfma_f32_16x16x32_bf16 v[196:199], a[152:155], a[168:171], v[196:199]
v_add_u32 v7, s50, v3
v_add_u32 v4, s49, v2
v_mfma_f32_16x16x32_bf16 v[196:199], a[156:159], a[172:175], v[196:199]
s_mov_b32 s44, s62
s_mov_b32 s43, s66
s_waitcnt vmcnt(18)
s_waitcnt lgkmcnt(0)
s_barrier
s_mov_b32 m0, s51
s_nop 0
buffer_load_dwordx4 v1, s[12:15], s42 offen offset:0 sc1 lds
v_mfma_f32_16x16x32_bf16 v[200:203], a[128:131], v[96:99], v[200:203]
ds_read_b128 a[80:83], v7 offset:0
ds_read_b128 a[100:103], v7 offset:10240
v_mfma_f32_16x16x32_bf16 v[200:203], a[132:135], v[100:103], v[200:203]
ds_read_b128 a[192:195], v4 offset:0
v_mfma_f32_16x16x32_bf16 v[200:203], a[136:139], v[104:107], v[200:203]
buffer_load_dwordx4 v1, s[12:15], s42 offen offset:1024 sc1 lds
ds_read_b128 a[208:211], v4 offset:8192
v_mfma_f32_16x16x32_bf16 v[200:203], a[140:143], v[108:111], v[200:203]
ds_read_b128 a[196:199], v4 offset:1024
v_mfma_f32_16x16x32_bf16 v[204:207], a[144:147], v[96:99], v[204:207]
buffer_load_dwordx4 v1, s[12:15], s42 offen offset:2048 sc1 lds
ds_read_b128 a[212:215], v4 offset:9216
v_mfma_f32_16x16x32_bf16 v[204:207], a[148:151], v[100:103], v[204:207]
ds_read_b128 a[200:203], v4 offset:2048
ds_read_b128 a[216:219], v4 offset:10240
v_mfma_f32_16x16x32_bf16 v[204:207], a[152:155], v[104:107], v[204:207]
buffer_load_dwordx4 v1, s[12:15], s42 offen offset:3072 sc1 lds
ds_read_b128 a[204:207], v4 offset:3072
v_mfma_f32_16x16x32_bf16 v[204:207], a[156:159], v[108:111], v[204:207]
ds_read_b128 a[220:223], v4 offset:11264
v_mfma_f32_16x16x32_bf16 v[208:211], a[128:131], v[112:115], v[208:211]
ds_read_b128 a[84:87], v7 offset:1024
s_mov_b32 m0, s44
s_nop 0
buffer_load_dwordx4 v1, s[16:19], s43 offen offset:0 sc1 lds
v_mfma_f32_16x16x32_bf16 v[208:211], a[132:135], v[116:119], v[208:211]
ds_read_b128 a[104:107], v7 offset:11264
v_mfma_f32_16x16x32_bf16 v[208:211], a[136:139], v[120:123], v[208:211]
ds_read_b128 a[88:91], v7 offset:2048
ds_read_b128 a[108:111], v7 offset:12288
v_mfma_f32_16x16x32_bf16 v[208:211], a[140:143], v[124:127], v[208:211]
buffer_load_dwordx4 v1, s[16:19], s43 offen offset:1024 sc1 lds
ds_read_b128 a[92:95], v7 offset:3072
v_mfma_f32_16x16x32_bf16 v[212:215], a[144:147], v[112:115], v[212:215]
ds_read_b128 a[112:115], v7 offset:13312
v_mfma_f32_16x16x32_bf16 v[212:215], a[148:151], v[116:119], v[212:215]
buffer_load_dwordx4 v1, s[16:19], s43 offen offset:2048 sc1 lds
ds_read_b128 a[96:99], v7 offset:4096
v_mfma_f32_16x16x32_bf16 v[212:215], a[152:155], v[120:123], v[212:215]
ds_read_b128 a[116:119], v7 offset:14336
v_mfma_f32_16x16x32_bf16 v[212:215], a[156:159], v[124:127], v[212:215]
s_waitcnt lgkmcnt(8)
v_mfma_f32_16x16x32_bf16 v[88:91], a[80:83], a[192:195], 0
buffer_load_dwordx4 v1, s[16:19], s43 offen offset:3072 sc1 lds
v_mfma_f32_16x16x32_bf16 v[88:91], a[100:103], a[208:211], v[88:91]
v_mov_b32 v144, 0xbdd2d3e8
v_mul_f32 v64, v192, v192
v_mfma_f32_16x16x32_bf16 v[108:111], a[80:83], a[196:199], 0
v_mul_f32 v65, v193, v193
s_add_u32 s51, s49, s96
v_mfma_f32_16x16x32_bf16 v[108:111], a[100:103], a[212:215], v[108:111]
v_mul_f32 v66, v194, v194
v_mul_f32 v67, v195, v195
v_mfma_f32_16x16x32_bf16 v[216:219], a[80:83], a[200:203], 0
s_add_u32 s62, s50, s97
v_mul_f32 v68, v196, v196
v_mfma_f32_16x16x32_bf16 v[216:219], a[100:103], a[216:219], v[216:219]
v_mul_f32 v69, v197, v197
v_mul_f32 v70, v198, v198
s_and_b32 s63, s64, 15
v_mfma_f32_16x16x32_bf16 v[236:239], a[80:83], a[204:207], 0
v_mul_f32 v71, v199, v199
v_fmaak_f32 v64, v144, v64, 0xc0135761
s_lshr_b64 s[64:65], s[64:65], 4
v_mfma_f32_16x16x32_bf16 v[236:239], a[100:103], a[220:223], v[236:239]
v_fmaak_f32 v65, v144, v65, 0xc0135761
v_fmaak_f32 v66, v144, v66, 0xc0135761
v_fmaak_f32 v67, v144, v67, 0xc0135761
s_mul_i32 s42, s63, 8192
s_waitcnt lgkmcnt(6)
v_mfma_f32_16x16x32_bf16 v[92:95], a[84:87], a[192:195], 0
v_fmaak_f32 v68, v144, v68, 0xc0135761
v_fmaak_f32 v69, v144, v69, 0xc0135761
v_mfma_f32_16x16x32_bf16 v[92:95], a[104:107], a[208:211], v[92:95]
s_add_u32 m0, s44, 4096
s_nop 0
buffer_load_dwordx4 v63, s[16:19], s43 offen sc1 lds
v_fmaak_f32 v70, v144, v70, 0xc0135761
v_fmaak_f32 v71, v144, v71, 0xc0135761
v_mul_f32 v64, v64, v192
s_mul_i32 s66, s63, 10240
v_mfma_f32_16x16x32_bf16 v[112:115], a[84:87], a[196:199], 0
v_mul_f32 v65, v65, v193
v_mul_f32 v66, v66, v194
s_add_u32 s49, s49, 16384
v_mfma_f32_16x16x32_bf16 v[112:115], a[104:107], a[212:215], v[112:115]
v_mul_f32 v67, v67, v195
v_mul_f32 v68, v68, v196
v_mul_f32 v69, v69, v197
s_and_b32 s49, s49, 0xffff
v_mfma_f32_16x16x32_bf16 v[220:223], a[84:87], a[200:203], 0
v_mul_f32 v70, v70, v198
v_mul_f32 v71, v71, v199
s_sub_u32 s50, s50, 20480
s_cselect_b32 s50, 61440, s50
v_mfma_f32_16x16x32_bf16 v[220:223], a[104:107], a[216:219], v[220:223]
v_exp_f32 v64, v64
v_exp_f32 v65, v65
v_exp_f32 v66, v66
v_mfma_f32_16x16x32_bf16 v[240:243], a[84:87], a[204:207], 0
v_exp_f32 v67, v67
v_exp_f32 v68, v68
v_add_u32 v7, s50, v3
v_add_u32 v4, s49, v2
v_mfma_f32_16x16x32_bf16 v[240:243], a[104:107], a[220:223], v[240:243]
s_mov_b32 s44, s62
s_mov_b32 s43, s66
s_waitcnt vmcnt(18)
s_waitcnt lgkmcnt(0)
s_barrier
v_mfma_f32_16x16x32_bf16 v[96:99], a[88:91], a[192:195], 0
ds_read_b128 a[120:123], v7 offset:0
s_mov_b32 m0, s51
s_nop 0
buffer_load_dwordx4 v1, s[12:15], s42 offen offset:0 sc1 lds
v_exp_f32 v69, v69
v_exp_f32 v70, v70
v_mfma_f32_16x16x32_bf16 v[96:99], a[108:111], a[208:211], v[96:99]
ds_read_b128 a[140:143], v7 offset:10240
v_exp_f32 v71, v71
v_mfma_f32_16x16x32_bf16 v[116:119], a[88:91], a[196:199], 0
ds_read_b128 a[160:163], v4 offset:0
v_add_f32 v64, 1.0, v64
v_mfma_f32_16x16x32_bf16 v[116:119], a[108:111], a[212:215], v[116:119]
buffer_load_dwordx4 v1, s[12:15], s42 offen offset:1024 sc1 lds
v_add_f32 v65, 1.0, v65
v_mfma_f32_16x16x32_bf16 v[224:227], a[88:91], a[200:203], 0
ds_read_b128 a[176:179], v4 offset:8192
v_add_f32 v66, 1.0, v66
v_mfma_f32_16x16x32_bf16 v[224:227], a[108:111], a[216:219], v[224:227]
ds_read_b128 a[164:167], v4 offset:1024
v_add_f32 v67, 1.0, v67
v_mfma_f32_16x16x32_bf16 v[244:247], a[88:91], a[204:207], 0
v_add_f32 v68, 1.0, v68
v_add_f32 v69, 1.0, v69
v_mfma_f32_16x16x32_bf16 v[244:247], a[108:111], a[220:223], v[244:247]
ds_read_b128 a[180:183], v4 offset:9216
buffer_load_dwordx4 v1, s[12:15], s42 offen offset:2048 sc1 lds
v_add_f32 v70, 1.0, v70
v_mfma_f32_16x16x32_bf16 v[100:103], a[92:95], a[192:195], 0
ds_read_b128 a[168:171], v4 offset:2048
v_add_f32 v71, 1.0, v71
v_mfma_f32_16x16x32_bf16 v[100:103], a[112:115], a[208:211], v[100:103]
v_rcp_f32 v64, v64
v_mfma_f32_16x16x32_bf16 v[120:123], a[92:95], a[196:199], 0
ds_read_b128 a[184:187], v4 offset:10240
v_rcp_f32 v65, v65
v_mfma_f32_16x16x32_bf16 v[120:123], a[112:115], a[212:215], v[120:123]
ds_read_b128 a[172:175], v4 offset:3072
buffer_load_dwordx4 v1, s[12:15], s42 offen offset:3072 sc1 lds
v_rcp_f32 v66, v66
v_mfma_f32_16x16x32_bf16 v[228:231], a[92:95], a[200:203], 0
v_rcp_f32 v67, v67
v_mfma_f32_16x16x32_bf16 v[228:231], a[112:115], a[216:219], v[228:231]
ds_read_b128 a[188:191], v4 offset:11264
v_rcp_f32 v68, v68
v_rcp_f32 v69, v69
v_mfma_f32_16x16x32_bf16 v[248:251], a[92:95], a[204:207], 0
ds_read_b128 a[124:127], v7 offset:1024
v_rcp_f32 v70, v70
v_mfma_f32_16x16x32_bf16 v[248:251], a[112:115], a[220:223], v[248:251]
ds_read_b128 a[144:147], v7 offset:11264
s_mov_b32 m0, s44
s_nop 0
buffer_load_dwordx4 v1, s[16:19], s43 offen offset:0 sc1 lds
v_rcp_f32 v71, v71
v_mfma_f32_16x16x32_bf16 v[104:107], a[96:99], a[192:195], 0
v_mul_f32 v192, v192, v64
ds_read_b128 a[128:131], v7 offset:2048
v_mfma_f32_16x16x32_bf16 v[104:107], a[116:119], a[208:211], v[104:107]
v_mul_f32 v193, v193, v65
ds_read_b128 a[148:151], v7 offset:12288
v_mfma_f32_16x16x32_bf16 v[124:127], a[96:99], a[196:199], 0
v_mul_f32 v194, v194, v66
v_mfma_f32_16x16x32_bf16 v[124:127], a[116:119], a[212:215], v[124:127]
buffer_load_dwordx4 v1, s[16:19], s43 offen offset:1024 sc1 lds
v_mul_f32 v195, v195, v67
v_mfma_f32_16x16x32_bf16 v[232:235], a[96:99], a[200:203], 0
ds_read_b128 a[132:135], v7 offset:3072
v_mul_f32 v196, v196, v68
v_mul_f32 v197, v197, v69
v_mfma_f32_16x16x32_bf16 v[232:235], a[116:119], a[216:219], v[232:235]
ds_read_b128 a[152:155], v7 offset:13312
v_mul_f32 v198, v198, v70
v_mfma_f32_16x16x32_bf16 v[252:255], a[96:99], a[204:207], 0
v_mul_f32 v199, v199, v71
ds_read_b128 a[136:139], v7 offset:4096
v_mfma_f32_16x16x32_bf16 v[252:255], a[116:119], a[220:223], v[252:255]
buffer_load_dwordx4 v1, s[16:19], s43 offen offset:2048 sc1 lds
v_cvt_pk_bf16_f32 v128, v192, v193
ds_read_b128 a[156:159], v7 offset:14336
v_cvt_pk_bf16_f32 v129, v194, v195
v_cvt_pk_bf16_f32 v130, v196, v197
v_cvt_pk_bf16_f32 v131, v198, v199
s_waitcnt lgkmcnt(8)
v_mfma_f32_16x16x32_bf16 v[88:91], a[120:123], a[160:163], v[88:91]
buffer_load_dwordx4 v1, s[16:19], s43 offen offset:3072 sc1 lds
v_mfma_f32_16x16x32_bf16 v[88:91], a[140:143], a[176:179], v[88:91]
buffer_store_dwordx4 v[128:131], v1, s[32:35], s41 offen offset:0 sc1
v_mfma_f32_16x16x32_bf16 v[108:111], a[120:123], a[164:167], v[108:111]
v_mul_f32 v72, v200, v200
v_mul_f32 v73, v201, v201
v_mfma_f32_16x16x32_bf16 v[108:111], a[140:143], a[180:183], v[108:111]
s_add_u32 s51, s49, s96
v_mul_f32 v74, v202, v202
v_mfma_f32_16x16x32_bf16 v[216:219], a[120:123], a[168:171], v[216:219]
v_mul_f32 v75, v203, v203
v_mul_f32 v76, v204, v204
s_add_u32 s62, s50, s97
v_mfma_f32_16x16x32_bf16 v[216:219], a[140:143], a[184:187], v[216:219]
v_mul_f32 v77, v205, v205
v_mul_f32 v78, v206, v206
s_and_b32 s63, s64, 15
v_mfma_f32_16x16x32_bf16 v[236:239], a[120:123], a[172:175], v[236:239]
v_mul_f32 v79, v207, v207
v_fmaak_f32 v72, v144, v72, 0xc0135761
v_fmaak_f32 v73, v144, v73, 0xc0135761
s_lshr_b64 s[64:65], s[64:65], 4
v_mfma_f32_16x16x32_bf16 v[236:239], a[140:143], a[188:191], v[236:239]
v_fmaak_f32 v74, v144, v74, 0xc0135761
v_fmaak_f32 v75, v144, v75, 0xc0135761
s_mul_i32 s42, s63, 8192
s_waitcnt lgkmcnt(6)
v_mfma_f32_16x16x32_bf16 v[92:95], a[124:127], a[160:163], v[92:95]
v_fmaak_f32 v76, v144, v76, 0xc0135761
v_fmaak_f32 v77, v144, v77, 0xc0135761
v_fmaak_f32 v78, v144, v78, 0xc0135761
v_mfma_f32_16x16x32_bf16 v[92:95], a[144:147], a[176:179], v[92:95]
s_add_u32 m0, s44, 4096
s_nop 0
buffer_load_dwordx4 v63, s[16:19], s43 offen sc1 lds
v_fmaak_f32 v79, v144, v79, 0xc0135761
v_mul_f32 v72, v72, v200
v_mul_f32 v73, v73, v201
s_mul_i32 s66, s63, 10240
v_mfma_f32_16x16x32_bf16 v[112:115], a[124:127], a[164:167], v[112:115]
v_mul_f32 v74, v74, v202
v_mul_f32 v75, v75, v203
s_add_u32 s49, s49, 16384
v_mfma_f32_16x16x32_bf16 v[112:115], a[144:147], a[180:183], v[112:115]
v_mul_f32 v76, v76, v204
v_mul_f32 v77, v77, v205
v_mul_f32 v78, v78, v206
s_and_b32 s49, s49, 0xffff
v_mfma_f32_16x16x32_bf16 v[220:223], a[124:127], a[168:171], v[220:223]
v_mul_f32 v79, v79, v207
v_exp_f32 v72, v72
s_sub_u32 s50, s50, 20480
s_cselect_b32 s50, 61440, s50
v_mfma_f32_16x16x32_bf16 v[220:223], a[144:147], a[184:187], v[220:223]
v_exp_f32 v73, v73
v_exp_f32 v74, v74
v_exp_f32 v75, v75
v_mfma_f32_16x16x32_bf16 v[240:243], a[124:127], a[172:175], v[240:243]
v_exp_f32 v76, v76
v_exp_f32 v77, v77
v_add_u32 v7, s50, v3
v_add_u32 v4, s49, v2
v_mfma_f32_16x16x32_bf16 v[240:243], a[144:147], a[188:191], v[240:243]
s_mov_b32 s44, s62
s_mov_b32 s43, s66
s_waitcnt vmcnt(19)
s_waitcnt lgkmcnt(0)
s_barrier
v_mfma_f32_16x16x32_bf16 v[96:99], a[128:131], a[160:163], v[96:99]
ds_read_b128 a[80:83], v7 offset:0
s_mov_b32 m0, s51
s_nop 0
buffer_load_dwordx4 v1, s[12:15], s42 offen offset:0 sc1 lds
v_exp_f32 v78, v78
v_exp_f32 v79, v79
v_mfma_f32_16x16x32_bf16 v[96:99], a[148:151], a[176:179], v[96:99]
ds_read_b128 a[100:103], v7 offset:10240
v_add_f32 v72, 1.0, v72
v_mfma_f32_16x16x32_bf16 v[116:119], a[128:131], a[164:167], v[116:119]
ds_read_b128 a[192:195], v4 offset:0
v_add_f32 v73, 1.0, v73
v_mfma_f32_16x16x32_bf16 v[116:119], a[148:151], a[180:183], v[116:119]
buffer_load_dwordx4 v1, s[12:15], s42 offen offset:1024 sc1 lds
v_add_f32 v74, 1.0, v74
v_mfma_f32_16x16x32_bf16 v[224:227], a[128:131], a[168:171], v[224:227]
ds_read_b128 a[208:211], v4 offset:8192
v_add_f32 v75, 1.0, v75
v_mfma_f32_16x16x32_bf16 v[224:227], a[148:151], a[184:187], v[224:227]
ds_read_b128 a[196:199], v4 offset:1024
v_add_f32 v76, 1.0, v76
v_mfma_f32_16x16x32_bf16 v[244:247], a[128:131], a[172:175], v[244:247]
v_add_f32 v77, 1.0, v77
ds_read_b128 a[212:215], v4 offset:9216
v_mfma_f32_16x16x32_bf16 v[244:247], a[148:151], a[188:191], v[244:247]
buffer_load_dwordx4 v1, s[12:15], s42 offen offset:2048 sc1 lds
v_add_f32 v78, 1.0, v78
v_mfma_f32_16x16x32_bf16 v[100:103], a[132:135], a[160:163], v[100:103]
ds_read_b128 a[200:203], v4 offset:2048
v_add_f32 v79, 1.0, v79
v_mfma_f32_16x16x32_bf16 v[100:103], a[152:155], a[176:179], v[100:103]
v_rcp_f32 v72, v72
v_rcp_f32 v73, v73
v_mfma_f32_16x16x32_bf16 v[120:123], a[132:135], a[164:167], v[120:123]
ds_read_b128 a[216:219], v4 offset:10240
v_rcp_f32 v74, v74
v_mfma_f32_16x16x32_bf16 v[120:123], a[152:155], a[180:183], v[120:123]
ds_read_b128 a[204:207], v4 offset:3072
buffer_load_dwordx4 v1, s[12:15], s42 offen offset:3072 sc1 lds
v_rcp_f32 v75, v75
v_mfma_f32_16x16x32_bf16 v[228:231], a[132:135], a[168:171], v[228:231]
v_rcp_f32 v76, v76
v_mfma_f32_16x16x32_bf16 v[228:231], a[152:155], a[184:187], v[228:231]
ds_read_b128 a[220:223], v4 offset:11264
v_rcp_f32 v77, v77
v_mfma_f32_16x16x32_bf16 v[248:251], a[132:135], a[172:175], v[248:251]
ds_read_b128 a[84:87], v7 offset:1024
v_rcp_f32 v78, v78
v_mfma_f32_16x16x32_bf16 v[248:251], a[152:155], a[188:191], v[248:251]
ds_read_b128 a[104:107], v7 offset:11264
s_mov_b32 m0, s44
s_nop 0
buffer_load_dwordx4 v1, s[16:19], s43 offen offset:0 sc1 lds
v_rcp_f32 v79, v79
v_mfma_f32_16x16x32_bf16 v[104:107], a[136:139], a[160:163], v[104:107]
v_mul_f32 v200, v200, v72
ds_read_b128 a[88:91], v7 offset:2048
v_mfma_f32_16x16x32_bf16 v[104:107], a[156:159], a[176:179], v[104:107]
v_mul_f32 v201, v201, v73
ds_read_b128 a[108:111], v7 offset:12288
v_mfma_f32_16x16x32_bf16 v[124:127], a[136:139], a[164:167], v[124:127]
v_mul_f32 v202, v202, v74
v_mul_f32 v203, v203, v75
v_mfma_f32_16x16x32_bf16 v[124:127], a[156:159], a[180:183], v[124:127]
buffer_load_dwordx4 v1, s[16:19], s43 offen offset:1024 sc1 lds
v_mul_f32 v204, v204, v76
v_mfma_f32_16x16x32_bf16 v[232:235], a[136:139], a[168:171], v[232:235]
ds_read_b128 a[92:95], v7 offset:3072
v_mul_f32 v205, v205, v77
v_mfma_f32_16x16x32_bf16 v[232:235], a[156:159], a[184:187], v[232:235]
ds_read_b128 a[112:115], v7 offset:13312
v_mul_f32 v206, v206, v78
v_mfma_f32_16x16x32_bf16 v[252:255], a[136:139], a[172:175], v[252:255]
v_mul_f32 v207, v207, v79
ds_read_b128 a[96:99], v7 offset:4096
v_mfma_f32_16x16x32_bf16 v[252:255], a[156:159], a[188:191], v[252:255]
buffer_load_dwordx4 v1, s[16:19], s43 offen offset:2048 sc1 lds
v_cvt_pk_bf16_f32 v132, v200, v201
ds_read_b128 a[116:119], v7 offset:14336
v_cvt_pk_bf16_f32 v133, v202, v203
v_cvt_pk_bf16_f32 v134, v204, v205
v_cvt_pk_bf16_f32 v135, v206, v207
s_waitcnt lgkmcnt(8)
v_mfma_f32_16x16x32_bf16 v[88:91], a[80:83], a[192:195], v[88:91]
buffer_load_dwordx4 v1, s[16:19], s43 offen offset:3072 sc1 lds
v_mfma_f32_16x16x32_bf16 v[88:91], a[100:103], a[208:211], v[88:91]
buffer_store_dwordx4 v[132:135], v1, s[32:35], s41 offen offset:1024 sc1
v_mfma_f32_16x16x32_bf16 v[108:111], a[80:83], a[196:199], v[108:111]
v_mul_f32 v80, v208, v208
v_mul_f32 v81, v209, v209
v_mfma_f32_16x16x32_bf16 v[108:111], a[100:103], a[212:215], v[108:111]
s_add_u32 s51, s49, s96
v_mul_f32 v82, v210, v210
v_mfma_f32_16x16x32_bf16 v[216:219], a[80:83], a[200:203], v[216:219]
v_mul_f32 v83, v211, v211
v_mul_f32 v84, v212, v212
s_add_u32 s62, s50, s97
v_mfma_f32_16x16x32_bf16 v[216:219], a[100:103], a[216:219], v[216:219]
v_mul_f32 v85, v213, v213
v_mul_f32 v86, v214, v214
s_and_b32 s63, s64, 15
v_mfma_f32_16x16x32_bf16 v[236:239], a[80:83], a[204:207], v[236:239]
v_mul_f32 v87, v215, v215
v_fmaak_f32 v80, v144, v80, 0xc0135761
v_fmaak_f32 v81, v144, v81, 0xc0135761
s_lshr_b64 s[64:65], s[64:65], 4
v_mfma_f32_16x16x32_bf16 v[236:239], a[100:103], a[220:223], v[236:239]
v_fmaak_f32 v82, v144, v82, 0xc0135761
v_fmaak_f32 v83, v144, v83, 0xc0135761
s_mul_i32 s42, s63, 8192
s_waitcnt lgkmcnt(6)
v_mfma_f32_16x16x32_bf16 v[92:95], a[84:87], a[192:195], v[92:95]
v_fmaak_f32 v84, v144, v84, 0xc0135761
v_fmaak_f32 v85, v144, v85, 0xc0135761
v_fmaak_f32 v86, v144, v86, 0xc0135761
v_mfma_f32_16x16x32_bf16 v[92:95], a[104:107], a[208:211], v[92:95]
s_add_u32 m0, s44, 4096
s_nop 0
buffer_load_dwordx4 v63, s[16:19], s43 offen sc1 lds
v_fmaak_f32 v87, v144, v87, 0xc0135761
v_mul_f32 v80, v80, v208
v_mul_f32 v81, v81, v209
s_mul_i32 s66, s63, 10240
v_mfma_f32_16x16x32_bf16 v[112:115], a[84:87], a[196:199], v[112:115]
v_mul_f32 v82, v82, v210
v_mul_f32 v83, v83, v211
s_add_u32 s49, s49, 16384
v_mfma_f32_16x16x32_bf16 v[112:115], a[104:107], a[212:215], v[112:115]
v_mul_f32 v84, v84, v212
v_mul_f32 v85, v85, v213
v_mul_f32 v86, v86, v214
s_and_b32 s49, s49, 0xffff
v_mfma_f32_16x16x32_bf16 v[220:223], a[84:87], a[200:203], v[220:223]
v_mul_f32 v87, v87, v215
v_exp_f32 v80, v80
s_sub_u32 s50, s50, 20480
s_cselect_b32 s50, 61440, s50
v_mfma_f32_16x16x32_bf16 v[220:223], a[104:107], a[216:219], v[220:223]
v_exp_f32 v81, v81
v_exp_f32 v82, v82
v_exp_f32 v83, v83
v_mfma_f32_16x16x32_bf16 v[240:243], a[84:87], a[204:207], v[240:243]
v_exp_f32 v84, v84
v_exp_f32 v85, v85
v_add_u32 v7, s50, v3
v_add_u32 v4, s49, v2
v_mfma_f32_16x16x32_bf16 v[240:243], a[104:107], a[220:223], v[240:243]
s_mov_b32 s44, s62
s_mov_b32 s43, s66
s_waitcnt vmcnt(20)
s_waitcnt lgkmcnt(0)
s_barrier
v_mfma_f32_16x16x32_bf16 v[96:99], a[88:91], a[192:195], v[96:99]
ds_read_b128 a[120:123], v7 offset:0
s_mov_b32 m0, s51
s_nop 0
buffer_load_dwordx4 v1, s[12:15], s42 offen offset:0 sc1 lds
v_exp_f32 v86, v86
v_exp_f32 v87, v87
v_mfma_f32_16x16x32_bf16 v[96:99], a[108:111], a[208:211], v[96:99]
ds_read_b128 a[140:143], v7 offset:10240
v_add_f32 v80, 1.0, v80
v_mfma_f32_16x16x32_bf16 v[116:119], a[88:91], a[196:199], v[116:119]
ds_read_b128 a[160:163], v4 offset:0
v_add_f32 v81, 1.0, v81
v_mfma_f32_16x16x32_bf16 v[116:119], a[108:111], a[212:215], v[116:119]
buffer_load_dwordx4 v1, s[12:15], s42 offen offset:1024 sc1 lds
v_add_f32 v82, 1.0, v82
v_mfma_f32_16x16x32_bf16 v[224:227], a[88:91], a[200:203], v[224:227]
ds_read_b128 a[176:179], v4 offset:8192
v_add_f32 v83, 1.0, v83
v_mfma_f32_16x16x32_bf16 v[224:227], a[108:111], a[216:219], v[224:227]
ds_read_b128 a[164:167], v4 offset:1024
v_add_f32 v84, 1.0, v84
v_mfma_f32_16x16x32_bf16 v[244:247], a[88:91], a[204:207], v[244:247]
v_add_f32 v85, 1.0, v85
v_add_f32 v86, 1.0, v86
v_mfma_f32_16x16x32_bf16 v[244:247], a[108:111], a[220:223], v[244:247]
ds_read_b128 a[180:183], v4 offset:9216
buffer_load_dwordx4 v1, s[12:15], s42 offen offset:2048 sc1 lds
v_add_f32 v87, 1.0, v87
v_mfma_f32_16x16x32_bf16 v[100:103], a[92:95], a[192:195], v[100:103]
ds_read_b128 a[168:171], v4 offset:2048
v_rcp_f32 v80, v80
v_mfma_f32_16x16x32_bf16 v[100:103], a[112:115], a[208:211], v[100:103]
v_rcp_f32 v81, v81
v_mfma_f32_16x16x32_bf16 v[120:123], a[92:95], a[196:199], v[120:123]
ds_read_b128 a[184:187], v4 offset:10240
v_rcp_f32 v82, v82
v_mfma_f32_16x16x32_bf16 v[120:123], a[112:115], a[212:215], v[120:123]
ds_read_b128 a[172:175], v4 offset:3072
buffer_load_dwordx4 v1, s[12:15], s42 offen offset:3072 sc1 lds
v_rcp_f32 v83, v83
v_mfma_f32_16x16x32_bf16 v[228:231], a[92:95], a[200:203], v[228:231]
v_rcp_f32 v84, v84
v_mfma_f32_16x16x32_bf16 v[228:231], a[112:115], a[216:219], v[228:231]
ds_read_b128 a[188:191], v4 offset:11264
v_rcp_f32 v85, v85
v_rcp_f32 v86, v86
v_mfma_f32_16x16x32_bf16 v[248:251], a[92:95], a[204:207], v[248:251]
ds_read_b128 a[124:127], v7 offset:1024
v_rcp_f32 v87, v87
v_mfma_f32_16x16x32_bf16 v[248:251], a[112:115], a[220:223], v[248:251]
ds_read_b128 a[144:147], v7 offset:11264
s_mov_b32 m0, s44
s_nop 0
buffer_load_dwordx4 v1, s[16:19], s43 offen offset:0 sc1 lds
v_mul_f32 v208, v208, v80
v_mfma_f32_16x16x32_bf16 v[104:107], a[96:99], a[192:195], v[104:107]
v_mul_f32 v209, v209, v81
ds_read_b128 a[128:131], v7 offset:2048
v_mfma_f32_16x16x32_bf16 v[104:107], a[116:119], a[208:211], v[104:107]
v_mul_f32 v210, v210, v82
ds_read_b128 a[148:151], v7 offset:12288
v_mfma_f32_16x16x32_bf16 v[124:127], a[96:99], a[196:199], v[124:127]
v_mul_f32 v211, v211, v83
v_mfma_f32_16x16x32_bf16 v[124:127], a[116:119], a[212:215], v[124:127]
buffer_load_dwordx4 v1, s[16:19], s43 offen offset:1024 sc1 lds
v_mul_f32 v212, v212, v84
v_mfma_f32_16x16x32_bf16 v[232:235], a[96:99], a[200:203], v[232:235]
ds_read_b128 a[132:135], v7 offset:3072
v_mul_f32 v213, v213, v85
v_mul_f32 v214, v214, v86
v_mfma_f32_16x16x32_bf16 v[232:235], a[116:119], a[216:219], v[232:235]
ds_read_b128 a[152:155], v7 offset:13312
v_mul_f32 v215, v215, v87
v_mfma_f32_16x16x32_bf16 v[252:255], a[96:99], a[204:207], v[252:255]
v_cvt_pk_bf16_f32 v136, v208, v209
ds_read_b128 a[136:139], v7 offset:4096
v_mfma_f32_16x16x32_bf16 v[252:255], a[116:119], a[220:223], v[252:255]
buffer_load_dwordx4 v1, s[16:19], s43 offen offset:2048 sc1 lds
v_cvt_pk_bf16_f32 v137, v210, v211
ds_read_b128 a[156:159], v7 offset:14336
v_cvt_pk_bf16_f32 v138, v212, v213
v_cvt_pk_bf16_f32 v139, v214, v215
buffer_store_dwordx4 v[136:139], v1, s[32:35], s47 offen offset:2048 sc1
s_waitcnt lgkmcnt(8)
v_mfma_f32_16x16x32_bf16 v[88:91], a[120:123], a[160:163], v[88:91]
buffer_load_dwordx4 v1, s[16:19], s43 offen offset:3072 sc1 lds
v_mfma_f32_16x16x32_bf16 v[88:91], a[140:143], a[176:179], v[88:91]
s_add_u32 s51, s49, s96
s_add_u32 s62, s50, s97
v_mfma_f32_16x16x32_bf16 v[108:111], a[120:123], a[164:167], v[108:111]
s_and_b32 s63, s64, 15
v_mfma_f32_16x16x32_bf16 v[108:111], a[140:143], a[180:183], v[108:111]
s_lshr_b64 s[64:65], s[64:65], 4
v_mfma_f32_16x16x32_bf16 v[216:219], a[120:123], a[168:171], v[216:219]
s_mul_i32 s42, s63, 8192
v_mfma_f32_16x16x32_bf16 v[216:219], a[140:143], a[184:187], v[216:219]
v_mfma_f32_16x16x32_bf16 v[236:239], a[120:123], a[172:175], v[236:239]
s_add_u32 m0, s44, 4096
v_mfma_f32_16x16x32_bf16 v[236:239], a[140:143], a[188:191], v[236:239]
buffer_load_dwordx4 v63, s[16:19], s43 offen sc1 lds
s_waitcnt lgkmcnt(6)
v_mfma_f32_16x16x32_bf16 v[92:95], a[124:127], a[160:163], v[92:95]
s_mul_i32 s66, s63, 10240
s_add_u32 s49, s49, 16384
v_mfma_f32_16x16x32_bf16 v[92:95], a[144:147], a[176:179], v[92:95]
s_and_b32 s49, s49, 0xffff
s_sub_u32 s50, s50, 20480
s_cselect_b32 s50, 61440, s50
v_mfma_f32_16x16x32_bf16 v[112:115], a[124:127], a[164:167], v[112:115]
v_mfma_f32_16x16x32_bf16 v[112:115], a[144:147], a[180:183], v[112:115]
v_add_u32 v7, s50, v3
v_add_u32 v4, s49, v2
v_mfma_f32_16x16x32_bf16 v[220:223], a[124:127], a[168:171], v[220:223]
s_mov_b32 s44, s62
s_mov_b32 s43, s66
v_mfma_f32_16x16x32_bf16 v[220:223], a[144:147], a[184:187], v[220:223]
s_waitcnt vmcnt(20)
s_waitcnt lgkmcnt(0)
v_mfma_f32_16x16x32_bf16 v[240:243], a[124:127], a[172:175], v[240:243]
s_barrier
ds_read_b128 a[80:83], v7 offset:0
v_mfma_f32_16x16x32_bf16 v[240:243], a[144:147], a[188:191], v[240:243]
s_mov_b32 m0, s51
v_mfma_f32_16x16x32_bf16 v[96:99], a[128:131], a[160:163], v[96:99]
buffer_load_dwordx4 v1, s[12:15], s42 offen offset:0 sc1 lds
v_add_u32 v60, s40, v1
v_mfma_f32_16x16x32_bf16 v[96:99], a[148:151], a[176:179], v[96:99]
ds_read_b128 a[100:103], v7 offset:10240
v_min_u32 v60, 1, v60
v_mfma_f32_16x16x32_bf16 v[116:119], a[128:131], a[164:167], v[116:119]
ds_read_b128 a[192:195], v4 offset:0
v_mfma_f32_16x16x32_bf16 v[116:119], a[148:151], a[180:183], v[116:119]
buffer_load_dwordx4 v1, s[12:15], s42 offen offset:1024 sc1 lds
v_lshlrev_b32 v60, 31, v60
v_mfma_f32_16x16x32_bf16 v[224:227], a[128:131], a[168:171], v[224:227]
ds_read_b128 a[208:211], v4 offset:8192
ds_read_b128 a[196:199], v4 offset:1024
v_mfma_f32_16x16x32_bf16 v[224:227], a[148:151], a[184:187], v[224:227]
v_mov_b32 v61, s82
s_getpc_b64 s[92:93]
L_pc_c:
v_mfma_f32_16x16x32_bf16 v[244:247], a[128:131], a[172:175], v[244:247]
ds_read_b128 a[212:215], v4 offset:9216
v_mfma_f32_16x16x32_bf16 v[244:247], a[148:151], a[188:191], v[244:247]
buffer_load_dwordx4 v1, s[12:15], s42 offen offset:2048 sc1 lds
v_mfma_f32_16x16x32_bf16 v[100:103], a[132:135], a[160:163], v[100:103]
ds_read_b128 a[200:203], v4 offset:2048
s_lshr_b32 s94, s2, 3
v_mfma_f32_16x16x32_bf16 v[100:103], a[152:155], a[176:179], v[100:103]
ds_read_b128 a[216:219], v4 offset:10240
s_lshl_b32 s94, s94, 2
v_mfma_f32_16x16x32_bf16 v[120:123], a[132:135], a[164:167], v[120:123]
ds_read_b128 a[204:207], v4 offset:3072
v_mfma_f32_16x16x32_bf16 v[120:123], a[152:155], a[180:183], v[120:123]
buffer_load_dwordx4 v1, s[12:15], s42 offen offset:3072 sc1 lds
s_add_u32 s94, s94, s40
v_mfma_f32_16x16x32_bf16 v[228:231], a[132:135], a[168:171], v[228:231]
ds_read_b128 a[220:223], v4 offset:11264
s_lshl_b32 s94, s94, 9
v_mfma_f32_16x16x32_bf16 v[228:231], a[152:155], a[184:187], v[228:231]
ds_read_b128 a[84:87], v7 offset:1024
ds_read_b128 a[104:107], v7 offset:11264
v_mfma_f32_16x16x32_bf16 v[248:251], a[132:135], a[172:175], v[248:251]
s_mov_b32 m0, s44
v_mfma_f32_16x16x32_bf16 v[248:251], a[152:155], a[188:191], v[248:251]
buffer_load_dwordx4 v1, s[16:19], s43 offen offset:0 sc1 lds
v_and_b32 v158, 0x30, v1
v_mfma_f32_16x16x32_bf16 v[104:107], a[136:139], a[160:163], v[104:107]
v_lshl_add_u32 v158, v158, 3, s94
ds_read_b128 a[88:91], v7 offset:2048
v_mfma_f32_16x16x32_bf16 v[104:107], a[156:159], a[176:179], v[104:107]
ds_read_b128 a[108:111], v7 offset:12288
v_min_u32 v158, (L_end-L_pc_c-4), v158
v_mfma_f32_16x16x32_bf16 v[124:127], a[136:139], a[164:167], v[124:127]
buffer_load_dwordx4 v1, s[16:19], s43 offen offset:1024 sc1 lds
v_mfma_f32_16x16x32_bf16 v[124:127], a[156:159], a[180:183], v[124:127]
ds_read_b128 a[92:95], v7 offset:3072
v_mov_b32 v159, s93
v_mfma_f32_16x16x32_bf16 v[232:235], a[136:139], a[168:171], v[232:235]
ds_read_b128 a[112:115], v7 offset:13312
v_add_co_u32 v158, vcc, s92, v158
v_mfma_f32_16x16x32_bf16 v[232:235], a[156:159], a[184:187], v[232:235]
ds_read_b128 a[96:99], v7 offset:4096
v_mfma_f32_16x16x32_bf16 v[252:255], a[136:139], a[172:175], v[252:255]
buffer_load_dwordx4 v1, s[16:19], s43 offen offset:2048 sc1 lds
v_mfma_f32_16x16x32_bf16 v[252:255], a[156:159], a[188:191], v[252:255]
v_addc_co_u32 v159, vcc, 0, v159, vcc
ds_read_b128 a[116:119], v7 offset:14336
global_load_dword v160, v[158:159], off
s_mov_b32 s83, 4
.p2align 3
L_fa:
s_cmp_lg_u32 s83, 1
s_cbranch_scc1 L_np_u
buffer_load_dword v62, v5, s[56:59], 0 offen sc1
L_np_u:
s_waitcnt lgkmcnt(8)
v_mfma_f32_16x16x32_bf16 v[88:91], a[80:83], a[192:195], v[88:91]
buffer_load_dwordx4 v1, s[16:19], s43 offen offset:3072 sc1 lds
v_mfma_f32_16x16x32_bf16 v[88:91], a[100:103], a[208:211], v[88:91]
s_add_u32 s51, s49, s96
s_add_u32 s62, s50, s97
v_mfma_f32_16x16x32_bf16 v[108:111], a[80:83], a[196:199], v[108:111]
s_and_b32 s63, s64, 15
v_mfma_f32_16x16x32_bf16 v[108:111], a[100:103], a[212:215], v[108:111]
s_lshr_b64 s[64:65], s[64:65], 4
v_mfma_f32_16x16x32_bf16 v[216:219], a[80:83], a[200:203], v[216:219]
s_mul_i32 s42, s63, 8192
v_mfma_f32_16x16x32_bf16 v[216:219], a[100:103], a[216:219], v[216:219]
v_mfma_f32_16x16x32_bf16 v[236:239], a[80:83], a[204:207], v[236:239]
s_add_u32 m0, s44, 4096
v_mfma_f32_16x16x32_bf16 v[236:239], a[100:103], a[220:223], v[236:239]
buffer_load_dwordx4 v63, s[16:19], s43 offen sc1 lds
s_waitcnt lgkmcnt(6)
v_mfma_f32_16x16x32_bf16 v[92:95], a[84:87], a[192:195], v[92:95]
s_mul_i32 s66, s63, 10240
s_add_u32 s49, s49, 16384
v_mfma_f32_16x16x32_bf16 v[92:95], a[104:107], a[208:211], v[92:95]
s_and_b32 s49, s49, 0xffff
s_sub_u32 s50, s50, 20480
s_cselect_b32 s50, 61440, s50
v_mfma_f32_16x16x32_bf16 v[112:115], a[84:87], a[196:199], v[112:115]
v_mfma_f32_16x16x32_bf16 v[112:115], a[104:107], a[212:215], v[112:115]
v_add_u32 v7, s50, v3
v_add_u32 v4, s49, v2
v_mfma_f32_16x16x32_bf16 v[220:223], a[84:87], a[200:203], v[220:223]
s_mov_b32 s44, s62
s_mov_b32 s43, s66
v_mfma_f32_16x16x32_bf16 v[220:223], a[104:107], a[216:219], v[220:223]
s_waitcnt vmcnt(19)
s_waitcnt lgkmcnt(0)
v_mfma_f32_16x16x32_bf16 v[240:243], a[84:87], a[204:207], v[240:243]
s_barrier
ds_read_b128 a[120:123], v7 offset:0
v_mfma_f32_16x16x32_bf16 v[240:243], a[104:107], a[220:223], v[240:243]
s_mov_b32 m0, s51
v_mfma_f32_16x16x32_bf16 v[96:99], a[88:91], a[192:195], v[96:99]
buffer_load_dwordx4 v1, s[12:15], s42 offen offset:0 sc1 lds
v_mfma_f32_16x16x32_bf16 v[96:99], a[108:111], a[208:211], v[96:99]
ds_read_b128 a[140:143], v7 offset:10240
ds_read_b128 a[160:163], v4 offset:0
v_mfma_f32_16x16x32_bf16 v[116:119], a[88:91], a[196:199], v[116:119]
buffer_load_dwordx4 v1, s[12:15], s42 offen offset:1024 sc1 lds
v_mfma_f32_16x16x32_bf16 v[116:119], a[108:111], a[212:215], v[116:119]
ds_read_b128 a[176:179], v4 offset:8192
ds_read_b128 a[164:167], v4 offset:1024
v_mfma_f32_16x16x32_bf16 v[224:227], a[88:91], a[200:203], v[224:227]
ds_read_b128 a[180:183], v4 offset:9216
v_mfma_f32_16x16x32_bf16 v[224:227], a[108:111], a[216:219], v[224:227]
buffer_load_dwordx4 v1, s[12:15], s42 offen offset:2048 sc1 lds
v_mfma_f32_16x16x32_bf16 v[244:247], a[88:91], a[204:207], v[244:247]
ds_read_b128 a[168:171], v4 offset:2048
v_mfma_f32_16x16x32_bf16 v[244:247], a[108:111], a[220:223], v[244:247]
ds_read_b128 a[184:187], v4 offset:10240
v_mfma_f32_16x16x32_bf16 v[100:103], a[92:95], a[192:195], v[100:103]
ds_read_b128 a[172:175], v4 offset:3072
v_mfma_f32_16x16x32_bf16 v[100:103], a[112:115], a[208:211], v[100:103]
buffer_load_dwordx4 v1, s[12:15], s42 offen offset:3072 sc1 lds
v_mfma_f32_16x16x32_bf16 v[120:123], a[92:95], a[196:199], v[120:123]
ds_read_b128 a[188:191], v4 offset:11264
v_mfma_f32_16x16x32_bf16 v[120:123], a[112:115], a[212:215], v[120:123]
ds_read_b128 a[124:127], v7 offset:1024
v_mfma_f32_16x16x32_bf16 v[228:231], a[92:95], a[200:203], v[228:231]
ds_read_b128 a[144:147], v7 offset:11264
s_mov_b32 m0, s44
v_mfma_f32_16x16x32_bf16 v[228:231], a[112:115], a[216:219], v[228:231]
buffer_load_dwordx4 v1, s[16:19], s43 offen offset:0 sc1 lds
v_mfma_f32_16x16x32_bf16 v[248:251], a[92:95], a[204:207], v[248:251]
ds_read_b128 a[128:131], v7 offset:2048
v_mfma_f32_16x16x32_bf16 v[248:251], a[112:115], a[220:223], v[248:251]
ds_read_b128 a[148:151], v7 offset:12288
v_mfma_f32_16x16x32_bf16 v[104:107], a[96:99], a[192:195], v[104:107]
buffer_load_dwordx4 v1, s[16:19], s43 offen offset:1024 sc1 lds
v_mfma_f32_16x16x32_bf16 v[104:107], a[116:119], a[208:211], v[104:107]
ds_read_b128 a[132:135], v7 offset:3072
v_mfma_f32_16x16x32_bf16 v[124:127], a[96:99], a[196:199], v[124:127]
ds_read_b128 a[152:155], v7 offset:13312
v_mfma_f32_16x16x32_bf16 v[124:127], a[116:119], a[212:215], v[124:127]
v_mfma_f32_16x16x32_bf16 v[232:235], a[96:99], a[200:203], v[232:235]
ds_read_b128 a[136:139], v7 offset:4096
v_mfma_f32_16x16x32_bf16 v[232:235], a[116:119], a[216:219], v[232:235]
buffer_load_dwordx4 v1, s[16:19], s43 offen offset:2048 sc1 lds
v_mfma_f32_16x16x32_bf16 v[252:255], a[96:99], a[204:207], v[252:255]
ds_read_b128 a[156:159], v7 offset:14336
v_mfma_f32_16x16x32_bf16 v[252:255], a[116:119], a[220:223], v[252:255]
s_waitcnt lgkmcnt(8)
v_mfma_f32_16x16x32_bf16 v[88:91], a[120:123], a[160:163], v[88:91]
buffer_load_dwordx4 v1, s[16:19], s43 offen offset:3072 sc1 lds
v_mfma_f32_16x16x32_bf16 v[88:91], a[140:143], a[176:179], v[88:91]
s_add_u32 s51, s49, s96
s_add_u32 s62, s50, s97
v_mfma_f32_16x16x32_bf16 v[108:111], a[120:123], a[164:167], v[108:111]
s_and_b32 s63, s64, 15
v_mfma_f32_16x16x32_bf16 v[108:111], a[140:143], a[180:183], v[108:111]
s_lshr_b64 s[64:65], s[64:65], 4
v_mfma_f32_16x16x32_bf16 v[216:219], a[120:123], a[168:171], v[216:219]
s_mul_i32 s42, s63, 8192
v_mfma_f32_16x16x32_bf16 v[216:219], a[140:143], a[184:187], v[216:219]
v_mfma_f32_16x16x32_bf16 v[236:239], a[120:123], a[172:175], v[236:239]
s_add_u32 m0, s44, 4096
v_mfma_f32_16x16x32_bf16 v[236:239], a[140:143], a[188:191], v[236:239]
buffer_load_dwordx4 v63, s[16:19], s43 offen sc1 lds
s_waitcnt lgkmcnt(6)
v_mfma_f32_16x16x32_bf16 v[92:95], a[124:127], a[160:163], v[92:95]
s_mul_i32 s66, s63, 10240
s_add_u32 s49, s49, 16384
v_mfma_f32_16x16x32_bf16 v[92:95], a[144:147], a[176:179], v[92:95]
s_and_b32 s49, s49, 0xffff
s_sub_u32 s50, s50, 20480
s_cselect_b32 s50, 61440, s50
v_mfma_f32_16x16x32_bf16 v[112:115], a[124:127], a[164:167], v[112:115]
v_mfma_f32_16x16x32_bf16 v[112:115], a[144:147], a[180:183], v[112:115]
v_add_u32 v7, s50, v3
v_add_u32 v4, s49, v2
v_mfma_f32_16x16x32_bf16 v[220:223], a[124:127], a[168:171], v[220:223]
s_mov_b32 s44, s62
s_mov_b32 s43, s66
v_mfma_f32_16x16x32_bf16 v[220:223], a[144:147], a[184:187], v[220:223]
s_waitcnt vmcnt(19)
s_waitcnt lgkmcnt(0)
v_mfma_f32_16x16x32_bf16 v[240:243], a[124:127], a[172:175], v[240:243]
s_barrier
v_mfma_f32_16x16x32_bf16 v[240:243], a[144:147], a[188:191], v[240:243]
buffer_store_dword v61, v60, s[56:59], s52 offen sc1
s_mov_b32 s52, 0x10000
v_mfma_f32_16x16x32_bf16 v[96:99], a[128:131], a[160:163], v[96:99]
ds_read_b128 a[80:83], v7 offset:0
s_mov_b32 m0, s51
s_nop 0
buffer_load_dwordx4 v1, s[12:15], s42 offen offset:0 sc1 lds
v_mfma_f32_16x16x32_bf16 v[96:99], a[148:151], a[176:179], v[96:99]
ds_read_b128 a[100:103], v7 offset:10240
ds_read_b128 a[192:195], v4 offset:0
v_mfma_f32_16x16x32_bf16 v[116:119], a[128:131], a[164:167], v[116:119]
buffer_load_dwordx4 v1, s[12:15], s42 offen offset:1024 sc1 lds
v_mfma_f32_16x16x32_bf16 v[116:119], a[148:151], a[180:183], v[116:119]
ds_read_b128 a[208:211], v4 offset:8192
ds_read_b128 a[196:199], v4 offset:1024
v_mfma_f32_16x16x32_bf16 v[224:227], a[128:131], a[168:171], v[224:227]
ds_read_b128 a[212:215], v4 offset:9216
v_mfma_f32_16x16x32_bf16 v[224:227], a[148:151], a[184:187], v[224:227]
buffer_load_dwordx4 v1, s[12:15], s42 offen offset:2048 sc1 lds
v_mfma_f32_16x16x32_bf16 v[244:247], a[128:131], a[172:175], v[244:247]
ds_read_b128 a[200:203], v4 offset:2048
v_mfma_f32_16x16x32_bf16 v[244:247], a[148:151], a[188:191], v[244:247]
ds_read_b128 a[216:219], v4 offset:10240
v_mfma_f32_16x16x32_bf16 v[100:103], a[132:135], a[160:163], v[100:103]
ds_read_b128 a[204:207], v4 offset:3072
v_mfma_f32_16x16x32_bf16 v[100:103], a[152:155], a[176:179], v[100:103]
buffer_load_dwordx4 v1, s[12:15], s42 offen offset:3072 sc1 lds
v_mfma_f32_16x16x32_bf16 v[120:123], a[132:135], a[164:167], v[120:123]
ds_read_b128 a[220:223], v4 offset:11264
v_mfma_f32_16x16x32_bf16 v[120:123], a[152:155], a[180:183], v[120:123]
ds_read_b128 a[84:87], v7 offset:1024
v_mfma_f32_16x16x32_bf16 v[228:231], a[132:135], a[168:171], v[228:231]
ds_read_b128 a[104:107], v7 offset:11264
s_mov_b32 m0, s44
v_mfma_f32_16x16x32_bf16 v[228:231], a[152:155], a[184:187], v[228:231]
buffer_load_dwordx4 v1, s[16:19], s43 offen offset:0 sc1 lds
v_mfma_f32_16x16x32_bf16 v[248:251], a[132:135], a[172:175], v[248:251]
ds_read_b128 a[88:91], v7 offset:2048
v_mfma_f32_16x16x32_bf16 v[248:251], a[152:155], a[188:191], v[248:251]
ds_read_b128 a[108:111], v7 offset:12288
v_mfma_f32_16x16x32_bf16 v[104:107], a[136:139], a[160:163], v[104:107]
buffer_load_dwordx4 v1, s[16:19], s43 offen offset:1024 sc1 lds
v_mfma_f32_16x16x32_bf16 v[104:107], a[156:159], a[176:179], v[104:107]
ds_read_b128 a[92:95], v7 offset:3072
v_mfma_f32_16x16x32_bf16 v[124:127], a[136:139], a[164:167], v[124:127]
ds_read_b128 a[112:115], v7 offset:13312
v_mfma_f32_16x16x32_bf16 v[124:127], a[156:159], a[180:183], v[124:127]
v_mfma_f32_16x16x32_bf16 v[232:235], a[136:139], a[168:171], v[232:235]
ds_read_b128 a[96:99], v7 offset:4096
v_mfma_f32_16x16x32_bf16 v[232:235], a[156:159], a[184:187], v[232:235]
buffer_load_dwordx4 v1, s[16:19], s43 offen offset:2048 sc1 lds
v_mfma_f32_16x16x32_bf16 v[252:255], a[136:139], a[172:175], v[252:255]
ds_read_b128 a[116:119], v7 offset:14336
v_mfma_f32_16x16x32_bf16 v[252:255], a[156:159], a[188:191], v[252:255]
s_sub_u32 s83, s83, 1
s_cmp_lg_u32 s83, 0
s_cbranch_scc1 L_fa
s_waitcnt lgkmcnt(8)
v_mfma_f32_16x16x32_bf16 v[88:91], a[80:83], a[192:195], v[88:91]
buffer_load_dwordx4 v1, s[16:19], s43 offen offset:3072 sc1 lds
v_mfma_f32_16x16x32_bf16 v[88:91], a[100:103], a[208:211], v[88:91]
s_add_u32 s51, s49, s48
s_add_u32 s62, s50, s71
v_mfma_f32_16x16x32_bf16 v[108:111], a[80:83], a[196:199], v[108:111]
s_add_u32 s63, s53, s54
s_and_b32 s63, s63, 3
v_mfma_f32_16x16x32_bf16 v[108:111], a[100:103], a[212:215], v[108:111]
s_mov_b32 s64, 0x65832140
s_mov_b32 s65, 0xdcba97
v_mfma_f32_16x16x32_bf16 v[216:219], a[80:83], a[200:203], v[216:219]
s_cmp_eq_u32 s63, 1
s_cselect_b32 s64, 0x69432501, s64
s_cselect_b32 s65, 0xdcba87, s65
v_mfma_f32_16x16x32_bf16 v[216:219], a[100:103], a[216:219], v[216:219]
s_cmp_eq_u32 s63, 2
s_cselect_b32 s64, 0xa5436102, s64
s_cselect_b32 s65, 0xdcb987, s65
v_mfma_f32_16x16x32_bf16 v[236:239], a[80:83], a[204:207], v[236:239]
s_cmp_eq_u32 s63, 3
s_cselect_b32 s64, 0x65472103, s64
s_cselect_b32 s65, 0xdca98b, s65
v_mfma_f32_16x16x32_bf16 v[236:239], a[100:103], a[220:223], v[236:239]
s_and_b32 s63, s64, 15
s_add_u32 m0, s44, 4096
s_waitcnt lgkmcnt(6)
v_mfma_f32_16x16x32_bf16 v[92:95], a[84:87], a[192:195], v[92:95]
buffer_load_dwordx4 v63, s[16:19], s43 offen sc1 lds
v_mfma_f32_16x16x32_bf16 v[92:95], a[104:107], a[208:211], v[92:95]
s_lshr_b64 s[64:65], s[64:65], 4
s_mul_i32 s42, s63, 524288
v_mfma_f32_16x16x32_bf16 v[112:115], a[84:87], a[196:199], v[112:115]
s_mul_i32 s66, s63, 20480
s_add_u32 s42, s42, s45
v_mfma_f32_16x16x32_bf16 v[112:115], a[104:107], a[212:215], v[112:115]
s_add_u32 s49, s49, 16384
s_and_b32 s49, s49, 0xffff
v_mfma_f32_16x16x32_bf16 v[220:223], a[84:87], a[200:203], v[220:223]
s_sub_u32 s50, s50, 20480
s_cselect_b32 s50, 61440, s50
v_add_u32 v7, s50, v3
v_mfma_f32_16x16x32_bf16 v[220:223], a[104:107], a[216:219], v[220:223]
v_add_u32 v4, s49, v2
s_mov_b32 s44, s62
v_mfma_f32_16x16x32_bf16 v[240:243], a[84:87], a[204:207], v[240:243]
s_add_u32 s43, s66, s46
s_waitcnt vmcnt(19)
v_mfma_f32_16x16x32_bf16 v[240:243], a[104:107], a[220:223], v[240:243]
s_waitcnt lgkmcnt(0)
s_barrier
v_cmp_ne_u32 vcc, s82, v62
s_nop 3
s_cbranch_vccnz L_spin_u
L_ok_u:
v_mfma_f32_16x16x32_bf16 v[96:99], a[88:91], a[192:195], v[96:99]
ds_read_b128 a[120:123], v7 offset:0
s_mov_b32 m0, s51
s_nop 0
buffer_load_dwordx4 v8, s[8:11], s42 offen offset:0 lds
v_mfma_f32_16x16x32_bf16 v[96:99], a[108:111], a[208:211], v[96:99]
ds_read_b128 a[140:143], v7 offset:10240
ds_read_b128 a[160:163], v4 offset:0
v_mfma_f32_16x16x32_bf16 v[116:119], a[88:91], a[196:199], v[116:119]
buffer_load_dwordx4 v9, s[8:11], s42 offen offset:1024 lds
v_mfma_f32_16x16x32_bf16 v[116:119], a[108:111], a[212:215], v[116:119]
ds_read_b128 a[176:179], v4 offset:8192
ds_read_b128 a[164:167], v4 offset:1024
v_mfma_f32_16x16x32_bf16 v[224:227], a[88:91], a[200:203], v[224:227]
ds_read_b128 a[180:183], v4 offset:9216
v_mfma_f32_16x16x32_bf16 v[224:227], a[108:111], a[216:219], v[224:227]
buffer_load_dwordx4 v10, s[8:11], s42 offen offset:2048 lds
v_mfma_f32_16x16x32_bf16 v[244:247], a[88:91], a[204:207], v[244:247]
ds_read_b128 a[168:171], v4 offset:2048
v_mfma_f32_16x16x32_bf16 v[244:247], a[108:111], a[220:223], v[244:247]
ds_read_b128 a[184:187], v4 offset:10240
v_mfma_f32_16x16x32_bf16 v[100:103], a[92:95], a[192:195], v[100:103]
ds_read_b128 a[172:175], v4 offset:3072
v_mfma_f32_16x16x32_bf16 v[100:103], a[112:115], a[208:211], v[100:103]
buffer_load_dwordx4 v11, s[8:11], s42 offen offset:3072 lds
v_mfma_f32_16x16x32_bf16 v[120:123], a[92:95], a[196:199], v[120:123]
ds_read_b128 a[188:191], v4 offset:11264
v_mfma_f32_16x16x32_bf16 v[120:123], a[112:115], a[212:215], v[120:123]
ds_read_b128 a[124:127], v7 offset:1024
v_mfma_f32_16x16x32_bf16 v[228:231], a[92:95], a[200:203], v[228:231]
ds_read_b128 a[144:147], v7 offset:11264
s_mov_b32 m0, s44
v_mfma_f32_16x16x32_bf16 v[228:231], a[112:115], a[216:219], v[228:231]
buffer_load_dwordx4 v1, s[4:7], s43 offen offset:0 sc1 lds
v_mfma_f32_16x16x32_bf16 v[248:251], a[92:95], a[204:207], v[248:251]
ds_read_b128 a[128:131], v7 offset:2048
v_mfma_f32_16x16x32_bf16 v[248:251], a[112:115], a[220:223], v[248:251]
ds_read_b128 a[148:151], v7 offset:12288
v_mfma_f32_16x16x32_bf16 v[104:107], a[96:99], a[192:195], v[104:107]
buffer_load_dwordx4 v1, s[4:7], s43 offen offset:1024 sc1 lds
v_mfma_f32_16x16x32_bf16 v[104:107], a[116:119], a[208:211], v[104:107]
ds_read_b128 a[132:135], v7 offset:3072
v_mfma_f32_16x16x32_bf16 v[124:127], a[96:99], a[196:199], v[124:127]
ds_read_b128 a[152:155], v7 offset:13312
v_mfma_f32_16x16x32_bf16 v[124:127], a[116:119], a[212:215], v[124:127]
v_mfma_f32_16x16x32_bf16 v[232:235], a[96:99], a[200:203], v[232:235]
ds_read_b128 a[136:139], v7 offset:4096
v_mfma_f32_16x16x32_bf16 v[232:235], a[116:119], a[216:219], v[232:235]
buffer_load_dwordx4 v1, s[4:7], s43 offen offset:2048 sc1 lds
v_mfma_f32_16x16x32_bf16 v[252:255], a[96:99], a[204:207], v[252:255]
ds_read_b128 a[156:159], v7 offset:14336
v_mfma_f32_16x16x32_bf16 v[252:255], a[116:119], a[220:223], v[252:255]
s_waitcnt lgkmcnt(8)
v_mfma_f32_16x16x32_bf16 v[88:91], a[120:123], a[160:163], v[88:91]
buffer_load_dwordx4 v1, s[4:7], s43 offen offset:3072 sc1 lds
v_mfma_f32_16x16x32_bf16 v[88:91], a[140:143], a[176:179], v[88:91]
s_add_u32 s51, s49, s48
s_add_u32 s62, s50, s71
v_mfma_f32_16x16x32_bf16 v[108:111], a[120:123], a[164:167], v[108:111]
s_and_b32 s63, s64, 15
v_mfma_f32_16x16x32_bf16 v[108:111], a[140:143], a[180:183], v[108:111]
s_lshr_b64 s[64:65], s[64:65], 4
v_mfma_f32_16x16x32_bf16 v[216:219], a[120:123], a[168:171], v[216:219]
s_mul_i32 s42, s63, 524288
v_mfma_f32_16x16x32_bf16 v[216:219], a[140:143], a[184:187], v[216:219]
s_mul_i32 s66, s63, 20480
v_mfma_f32_16x16x32_bf16 v[236:239], a[120:123], a[172:175], v[236:239]
s_add_u32 m0, s44, 4096
v_mfma_f32_16x16x32_bf16 v[236:239], a[140:143], a[188:191], v[236:239]
buffer_load_dwordx4 v63, s[4:7], s43 offen sc1 lds
s_waitcnt lgkmcnt(6)
v_mfma_f32_16x16x32_bf16 v[92:95], a[124:127], a[160:163], v[92:95]
s_add_u32 s42, s42, s45
s_add_u32 s49, s49, 16384
v_mfma_f32_16x16x32_bf16 v[92:95], a[144:147], a[176:179], v[92:95]
s_and_b32 s49, s49, 0xffff
s_sub_u32 s50, s50, 20480
s_cselect_b32 s50, 61440, s50
v_mfma_f32_16x16x32_bf16 v[112:115], a[124:127], a[164:167], v[112:115]
v_mfma_f32_16x16x32_bf16 v[112:115], a[144:147], a[180:183], v[112:115]
v_add_u32 v7, s50, v3
v_add_u32 v4, s49, v2
v_mfma_f32_16x16x32_bf16 v[220:223], a[124:127], a[168:171], v[220:223]
s_mov_b32 s44, s62
s_add_u32 s43, s66, s46
v_mfma_f32_16x16x32_bf16 v[220:223], a[144:147], a[184:187], v[220:223]
s_waitcnt vmcnt(19)
s_waitcnt lgkmcnt(0)
v_mfma_f32_16x16x32_bf16 v[240:243], a[124:127], a[172:175], v[240:243]
s_barrier
ds_read_b128 a[80:83], v7 offset:0
v_mfma_f32_16x16x32_bf16 v[240:243], a[144:147], a[188:191], v[240:243]
s_mov_b32 m0, s51
v_mfma_f32_16x16x32_bf16 v[96:99], a[128:131], a[160:163], v[96:99]
buffer_load_dwordx4 v8, s[8:11], s42 offen offset:0 lds
v_mfma_f32_16x16x32_bf16 v[96:99], a[148:151], a[176:179], v[96:99]
ds_read_b128 a[100:103], v7 offset:10240
ds_read_b128 a[192:195], v4 offset:0
v_mfma_f32_16x16x32_bf16 v[116:119], a[128:131], a[164:167], v[116:119]
buffer_load_dwordx4 v9, s[8:11], s42 offen offset:1024 lds
v_mfma_f32_16x16x32_bf16 v[116:119], a[148:151], a[180:183], v[116:119]
ds_read_b128 a[208:211], v4 offset:8192
ds_read_b128 a[196:199], v4 offset:1024
v_mfma_f32_16x16x32_bf16 v[224:227], a[128:131], a[168:171], v[224:227]
ds_read_b128 a[212:215], v4 offset:9216
v_mfma_f32_16x16x32_bf16 v[224:227], a[148:151], a[184:187], v[224:227]
buffer_load_dwordx4 v10, s[8:11], s42 offen offset:2048 lds
v_mfma_f32_16x16x32_bf16 v[244:247], a[128:131], a[172:175], v[244:247]
ds_read_b128 a[200:203], v4 offset:2048
v_mfma_f32_16x16x32_bf16 v[244:247], a[148:151], a[188:191], v[244:247]
ds_read_b128 a[216:219], v4 offset:10240
v_mfma_f32_16x16x32_bf16 v[100:103], a[132:135], a[160:163], v[100:103]
ds_read_b128 a[204:207], v4 offset:3072
v_mfma_f32_16x16x32_bf16 v[100:103], a[152:155], a[176:179], v[100:103]
buffer_load_dwordx4 v11, s[8:11], s42 offen offset:3072 lds
v_mfma_f32_16x16x32_bf16 v[120:123], a[132:135], a[164:167], v[120:123]
ds_read_b128 a[220:223], v4 offset:11264
v_mfma_f32_16x16x32_bf16 v[120:123], a[152:155], a[180:183], v[120:123]
ds_read_b128 a[84:87], v7 offset:1024
v_mfma_f32_16x16x32_bf16 v[228:231], a[132:135], a[168:171], v[228:231]
ds_read_b128 a[104:107], v7 offset:11264
s_mov_b32 m0, s44
v_mfma_f32_16x16x32_bf16 v[228:231], a[152:155], a[184:187], v[228:231]
buffer_load_dwordx4 v1, s[4:7], s43 offen offset:0 sc1 lds
v_mfma_f32_16x16x32_bf16 v[248:251], a[132:135], a[172:175], v[248:251]
ds_read_b128 a[88:91], v7 offset:2048
v_mfma_f32_16x16x32_bf16 v[248:251], a[152:155], a[188:191], v[248:251]
ds_read_b128 a[108:111], v7 offset:12288
v_mfma_f32_16x16x32_bf16 v[104:107], a[136:139], a[160:163], v[104:107]
buffer_load_dwordx4 v1, s[4:7], s43 offen offset:1024 sc1 lds
v_mfma_f32_16x16x32_bf16 v[104:107], a[156:159], a[176:179], v[104:107]
ds_read_b128 a[92:95], v7 offset:3072
v_mfma_f32_16x16x32_bf16 v[124:127], a[136:139], a[164:167], v[124:127]
ds_read_b128 a[112:115], v7 offset:13312
v_mfma_f32_16x16x32_bf16 v[124:127], a[156:159], a[180:183], v[124:127]
v_mfma_f32_16x16x32_bf16 v[232:235], a[136:139], a[168:171], v[232:235]
ds_read_b128 a[96:99], v7 offset:4096
v_mfma_f32_16x16x32_bf16 v[232:235], a[156:159], a[184:187], v[232:235]
buffer_load_dwordx4 v1, s[4:7], s43 offen offset:2048 sc1 lds
v_mfma_f32_16x16x32_bf16 v[252:255], a[136:139], a[172:175], v[252:255]
ds_read_b128 a[116:119], v7 offset:14336
v_mfma_f32_16x16x32_bf16 v[252:255], a[156:159], a[188:191], v[252:255]
s_waitcnt lgkmcnt(8)
v_mfma_f32_16x16x32_bf16 v[88:91], a[80:83], a[192:195], v[88:91]
buffer_load_dwordx4 v1, s[4:7], s43 offen offset:3072 sc1 lds
v_mfma_f32_16x16x32_bf16 v[88:91], a[100:103], a[208:211], v[88:91]
s_add_u32 s51, s49, s48
s_add_u32 s62, s50, s71
v_mfma_f32_16x16x32_bf16 v[108:111], a[80:83], a[196:199], v[108:111]
s_and_b32 s63, s64, 15
v_mfma_f32_16x16x32_bf16 v[108:111], a[100:103], a[212:215], v[108:111]
s_lshr_b64 s[64:65], s[64:65], 4
v_mfma_f32_16x16x32_bf16 v[216:219], a[80:83], a[200:203], v[216:219]
s_mul_i32 s42, s63, 524288
v_mfma_f32_16x16x32_bf16 v[216:219], a[100:103], a[216:219], v[216:219]
s_mul_i32 s66, s63, 20480
v_mfma_f32_16x16x32_bf16 v[236:239], a[80:83], a[204:207], v[236:239]
s_add_u32 m0, s44, 4096
v_mfma_f32_16x16x32_bf16 v[236:239], a[100:103], a[220:223], v[236:239]
buffer_load_dwordx4 v63, s[4:7], s43 offen sc1 lds
s_waitcnt lgkmcnt(6)
v_mfma_f32_16x16x32_bf16 v[92:95], a[84:87], a[192:195], v[92:95]
s_add_u32 s42, s42, s45
s_add_u32 s49, s49, 16384
v_mfma_f32_16x16x32_bf16 v[92:95], a[104:107], a[208:211], v[92:95]
s_and_b32 s49, s49, 0xffff
s_sub_u32 s50, s50, 20480
s_cselect_b32 s50, 61440, s50
v_mfma_f32_16x16x32_bf16 v[112:115], a[84:87], a[196:199], v[112:115]
v_mfma_f32_16x16x32_bf16 v[112:115], a[104:107], a[212:215], v[112:115]
v_add_u32 v7, s50, v3
v_add_u32 v4, s49, v2
v_mfma_f32_16x16x32_bf16 v[220:223], a[84:87], a[200:203], v[220:223]
s_mov_b32 s44, s62
s_add_u32 s43, s66, s46
v_mfma_f32_16x16x32_bf16 v[220:223], a[104:107], a[216:219], v[220:223]
s_waitcnt vmcnt(18)
s_waitcnt lgkmcnt(0)
v_mfma_f32_16x16x32_bf16 v[240:243], a[84:87], a[204:207], v[240:243]
s_barrier
ds_read_b128 a[120:123], v7 offset:0
v_mfma_f32_16x16x32_bf16 v[240:243], a[104:107], a[220:223], v[240:243]
s_mov_b32 m0, s51
v_mfma_f32_16x16x32_bf16 v[96:99], a[88:91], a[192:195], v[96:99]
buffer_load_dwordx4 v8, s[8:11], s42 offen offset:0 lds
v_mfma_f32_16x16x32_bf16 v[96:99], a[108:111], a[208:211], v[96:99]
ds_read_b128 a[140:143], v7 offset:10240
ds_read_b128 a[160:163], v4 offset:0
v_mfma_f32_16x16x32_bf16 v[116:119], a[88:91], a[196:199], v[116:119]
buffer_load_dwordx4 v9, s[8:11], s42 offen offset:1024 lds
v_mfma_f32_16x16x32_bf16 v[116:119], a[108:111], a[212:215], v[116:119]
ds_read_b128 a[176:179], v4 offset:8192
ds_read_b128 a[164:167], v4 offset:1024
v_mfma_f32_16x16x32_bf16 v[224:227], a[88:91], a[200:203], v[224:227]
ds_read_b128 a[180:183], v4 offset:9216
v_mfma_f32_16x16x32_bf16 v[224:227], a[108:111], a[216:219], v[224:227]
buffer_load_dwordx4 v10, s[8:11], s42 offen offset:2048 lds
v_mfma_f32_16x16x32_bf16 v[244:247], a[88:91], a[204:207], v[244:247]
ds_read_b128 a[168:171], v4 offset:2048
v_mfma_f32_16x16x32_bf16 v[244:247], a[108:111], a[220:223], v[244:247]
ds_read_b128 a[184:187], v4 offset:10240
v_mfma_f32_16x16x32_bf16 v[100:103], a[92:95], a[192:195], v[100:103]
ds_read_b128 a[172:175], v4 offset:3072
v_mfma_f32_16x16x32_bf16 v[100:103], a[112:115], a[208:211], v[100:103]
buffer_load_dwordx4 v11, s[8:11], s42 offen offset:3072 lds
v_mfma_f32_16x16x32_bf16 v[120:123], a[92:95], a[196:199], v[120:123]
ds_read_b128 a[188:191], v4 offset:11264
v_mfma_f32_16x16x32_bf16 v[120:123], a[112:115], a[212:215], v[120:123]
ds_read_b128 a[124:127], v7 offset:1024
v_mfma_f32_16x16x32_bf16 v[228:231], a[92:95], a[200:203], v[228:231]
ds_read_b128 a[144:147], v7 offset:11264
s_mov_b32 m0, s44
v_mfma_f32_16x16x32_bf16 v[228:231], a[112:115], a[216:219], v[228:231]
buffer_load_dwordx4 v1, s[4:7], s43 offen offset:0 sc1 lds
v_mfma_f32_16x16x32_bf16 v[248:251], a[92:95], a[204:207], v[248:251]
ds_read_b128 a[128:131], v7 offset:2048
v_mfma_f32_16x16x32_bf16 v[248:251], a[112:115], a[220:223], v[248:251]
ds_read_b128 a[148:151], v7 offset:12288
v_mfma_f32_16x16x32_bf16 v[104:107], a[96:99], a[192:195], v[104:107]
buffer_load_dwordx4 v1, s[4:7], s43 offen offset:1024 sc1 lds
v_mfma_f32_16x16x32_bf16 v[104:107], a[116:119], a[208:211], v[104:107]
ds_read_b128 a[132:135], v7 offset:3072
v_mfma_f32_16x16x32_bf16 v[124:127], a[96:99], a[196:199], v[124:127]
ds_read_b128 a[152:155], v7 offset:13312
v_mfma_f32_16x16x32_bf16 v[124:127], a[116:119], a[212:215], v[124:127]
v_mfma_f32_16x16x32_bf16 v[232:235], a[96:99], a[200:203], v[232:235]
ds_read_b128 a[136:139], v7 offset:4096
v_mfma_f32_16x16x32_bf16 v[232:235], a[116:119], a[216:219], v[232:235]
buffer_load_dwordx4 v1, s[4:7], s43 offen offset:2048 sc1 lds
v_mfma_f32_16x16x32_bf16 v[252:255], a[96:99], a[204:207], v[252:255]
ds_read_b128 a[156:159], v7 offset:14336
v_mfma_f32_16x16x32_bf16 v[252:255], a[116:119], a[220:223], v[252:255]
s_waitcnt lgkmcnt(8)
v_mfma_f32_16x16x32_bf16 v[88:91], a[120:123], a[160:163], v[88:91]
buffer_load_dwordx4 v1, s[4:7], s43 offen offset:3072 sc1 lds
v_mfma_f32_16x16x32_bf16 v[88:91], a[140:143], a[176:179], v[88:91]
s_add_u32 s51, s49, s48
s_add_u32 s62, s50, s71
v_mfma_f32_16x16x32_bf16 v[108:111], a[120:123], a[164:167], v[108:111]
s_and_b32 s63, s64, 15
v_mfma_f32_16x16x32_bf16 v[108:111], a[140:143], a[180:183], v[108:111]
s_lshr_b64 s[64:65], s[64:65], 4
v_mfma_f32_16x16x32_bf16 v[216:219], a[120:123], a[168:171], v[216:219]
s_mul_i32 s42, s63, 524288
v_mfma_f32_16x16x32_bf16 v[216:219], a[140:143], a[184:187], v[216:219]
s_mul_i32 s66, s63, 20480
v_mfma_f32_16x16x32_bf16 v[236:239], a[120:123], a[172:175], v[236:239]
s_add_u32 m0, s44, 4096
v_mfma_f32_16x16x32_bf16 v[236:239], a[140:143], a[188:191], v[236:239]
buffer_load_dwordx4 v63, s[4:7], s43 offen sc1 lds
s_waitcnt lgkmcnt(6)
v_mfma_f32_16x16x32_bf16 v[92:95], a[124:127], a[160:163], v[92:95]
s_add_u32 s42, s42, s45
s_add_u32 s49, s49, 16384
v_mfma_f32_16x16x32_bf16 v[92:95], a[144:147], a[176:179], v[92:95]
s_and_b32 s49, s49, 0xffff
s_sub_u32 s50, s50, 20480
s_cselect_b32 s50, 61440, s50
v_mfma_f32_16x16x32_bf16 v[112:115], a[124:127], a[164:167], v[112:115]
v_mfma_f32_16x16x32_bf16 v[112:115], a[144:147], a[180:183], v[112:115]
v_add_u32 v13, s49, v12
v_add_u32 v14, s50, v18
v_mfma_f32_16x16x32_bf16 v[220:223], a[124:127], a[168:171], v[220:223]
s_mov_b32 s44, s62
s_add_u32 s43, s66, s46
v_mfma_f32_16x16x32_bf16 v[220:223], a[144:147], a[184:187], v[220:223]
s_waitcnt vmcnt(18)
s_waitcnt lgkmcnt(0)
v_mfma_f32_16x16x32_bf16 v[240:243], a[124:127], a[172:175], v[240:243]
s_barrier
ds_read_b64_tr_b16 a[80:81], v13 offset:0
v_mfma_f32_16x16x32_bf16 v[240:243], a[144:147], a[188:191], v[240:243]
ds_read_b64_tr_b16 a[82:83], v13 offset:2048
s_mov_b32 m0, s51
v_mfma_f32_16x16x32_bf16 v[96:99], a[128:131], a[160:163], v[96:99]
buffer_load_dwordx4 v8, s[8:11], s42 offen offset:0 lds
v_mfma_f32_16x16x32_bf16 v[96:99], a[148:151], a[176:179], v[96:99]
ds_read_b128 a[96:99], v14 offset:0
ds_read_b64_tr_b16 a[84:85], v13 offset:4096
v_mfma_f32_16x16x32_bf16 v[116:119], a[128:131], a[164:167], v[116:119]
ds_read_b64_tr_b16 a[86:87], v13 offset:6144
v_mfma_f32_16x16x32_bf16 v[116:119], a[148:151], a[180:183], v[116:119]
buffer_load_dwordx4 v9, s[8:11], s42 offen offset:1024 lds
v_mfma_f32_16x16x32_bf16 v[224:227], a[128:131], a[168:171], v[224:227]
ds_read_b128 a[100:103], v14 offset:5120
ds_read_b64_tr_b16 a[88:89], v13 offset:8192
v_mfma_f32_16x16x32_bf16 v[224:227], a[148:151], a[184:187], v[224:227]
ds_read_b64_tr_b16 a[90:91], v13 offset:10240
ds_read_b128 a[104:107], v14 offset:10240
v_mfma_f32_16x16x32_bf16 v[244:247], a[128:131], a[172:175], v[244:247]
buffer_load_dwordx4 v10, s[8:11], s42 offen offset:2048 lds
v_mfma_f32_16x16x32_bf16 v[244:247], a[148:151], a[188:191], v[244:247]
ds_read_b64_tr_b16 a[92:93], v13 offset:12288
ds_read_b64_tr_b16 a[94:95], v13 offset:14336
v_mfma_f32_16x16x32_bf16 v[100:103], a[132:135], a[160:163], v[100:103]
ds_read_b128 a[108:111], v14 offset:15360
ds_read_b128 a[112:115], v14 offset:1024
v_mfma_f32_16x16x32_bf16 v[100:103], a[152:155], a[176:179], v[100:103]
buffer_load_dwordx4 v11, s[8:11], s42 offen offset:3072 lds
v_mfma_f32_16x16x32_bf16 v[120:123], a[132:135], a[164:167], v[120:123]
ds_read_b128 a[116:119], v14 offset:6144
ds_read_b128 a[192:195], v14 offset:11264
v_mfma_f32_16x16x32_bf16 v[120:123], a[152:155], a[180:183], v[120:123]
ds_read_b128 a[196:199], v14 offset:16384
ds_read_b128 a[200:203], v14 offset:2048
v_mfma_f32_16x16x32_bf16 v[228:231], a[132:135], a[168:171], v[228:231]
ds_read_b128 a[204:207], v14 offset:7168
s_mov_b32 m0, s44
v_mfma_f32_16x16x32_bf16 v[228:231], a[152:155], a[184:187], v[228:231]
buffer_load_dwordx4 v1, s[4:7], s43 offen offset:0 sc1 lds
v_mfma_f32_16x16x32_bf16 v[248:251], a[132:135], a[172:175], v[248:251]
ds_read_b128 a[208:211], v14 offset:12288
ds_read_b128 a[212:215], v14 offset:17408
v_mfma_f32_16x16x32_bf16 v[248:251], a[152:155], a[188:191], v[248:251]
ds_read_b128 a[216:219], v14 offset:3072
v_mfma_f32_16x16x32_bf16 v[104:107], a[136:139], a[160:163], v[104:107]
ds_read_b128 a[220:223], v14 offset:8192
v_mfma_f32_16x16x32_bf16 v[104:107], a[156:159], a[176:179], v[104:107]
buffer_load_dwordx4 v1, s[4:7], s43 offen offset:1024 sc1 lds
v_mfma_f32_16x16x32_bf16 v[124:127], a[136:139], a[164:167], v[124:127]
ds_read_b128 a[224:227], v14 offset:13312
ds_read_b128 a[228:231], v14 offset:18432
v_mfma_f32_16x16x32_bf16 v[124:127], a[156:159], a[180:183], v[124:127]
ds_read_b128 a[232:235], v14 offset:4096
v_mfma_f32_16x16x32_bf16 v[232:235], a[136:139], a[168:171], v[232:235]
ds_read_b128 a[236:239], v14 offset:9216
v_mfma_f32_16x16x32_bf16 v[232:235], a[156:159], a[184:187], v[232:235]
buffer_load_dwordx4 v1, s[4:7], s43 offen offset:2048 sc1 lds
v_mfma_f32_16x16x32_bf16 v[252:255], a[136:139], a[172:175], v[252:255]
ds_read_b128 a[240:243], v14 offset:14336
ds_read_b128 a[244:247], v14 offset:19456
v_mfma_f32_16x16x32_bf16 v[252:255], a[156:159], a[188:191], v[252:255]
s_waitcnt lgkmcnt(15)
v_mfma_f32_16x16x32_bf16 v[192:195], a[96:99], a[80:83], 0
s_lshl_b32 s92, s40, 2
s_add_u32 s92, s92, s55
s_mul_i32 s47, s92, 10240
s_cmp_eq_u32 s40, s55
s_cselect_b32 s47, 0x1000000, s47
s_cselect_b64 s[96:97], -1, 0
v_add_u32 v56, 65792, v1
v_add_u32 v57, 65792, v17
s_add_u32 s51, s49, s48
s_add_u32 s62, s50, s71
v_mfma_f32_16x16x32_bf16 v[192:195], a[100:103], a[84:87], v[192:195]
v_cvt_pk_bf16_f32 v144, v88, v89
buffer_load_dwordx4 v1, s[4:7], s43 offen offset:3072 sc1 lds
v_cvt_pk_bf16_f32 v145, v90, v91
v_cvt_pk_bf16_f32 v146, v92, v93
v_cvt_pk_bf16_f32 v147, v94, v95
v_cvt_pk_bf16_f32 v148, v96, v97
s_and_b32 s63, s64, 15
s_lshr_b64 s[64:65], s[64:65], 4
v_mfma_f32_16x16x32_bf16 v[192:195], a[104:107], a[88:91], v[192:195]
v_cvt_pk_bf16_f32 v149, v98, v99
v_cvt_pk_bf16_f32 v150, v100, v101
v_cvt_pk_bf16_f32 v151, v102, v103
v_cvt_pk_bf16_f32 v152, v104, v105
v_cvt_pk_bf16_f32 v153, v106, v107
s_add_u32 s95, s47, 0
s_mul_i32 s42, s63, 524288
s_mul_i32 s66, s63, 20480
v_mfma_f32_16x16x32_bf16 v[192:195], a[108:111], a[92:95], v[192:195]
buffer_store_dwordx4 v[144:147], v1, s[20:23], s95 offen sc1
buffer_store_dwordx4 v[148:151], v1, s[20:23], s95 offen offset:1024 sc1
buffer_store_dwordx2 v[152:153], v17, s[20:23], s95 offen offset:2048 sc1
s_mov_b64 exec, s[96:97]
ds_write_b128 v56, v[144:147] offset:0
ds_write_b128 v56, v[148:151] offset:1024
ds_write_b64 v57, v[152:153] offset:2048
s_mov_b64 exec, -1
v_cvt_pk_bf16_f32 v156, v108, v109
s_add_u32 s42, s42, s45
s_add_u32 s49, s49, 16384
s_waitcnt lgkmcnt(15)
v_mfma_f32_16x16x32_bf16 v[196:199], a[112:115], a[80:83], 0
v_cvt_pk_bf16_f32 v157, v110, v111
v_cvt_pk_bf16_f32 v158, v112, v113
v_cvt_pk_bf16_f32 v159, v114, v115
v_cvt_pk_bf16_f32 v160, v116, v117
s_add_u32 m0, s44, 4096
s_nop 0
buffer_load_dwordx4 v63, s[4:7], s43 offen sc1 lds
v_cvt_pk_bf16_f32 v161, v118, v119
v_cvt_pk_bf16_f32 v162, v120, v121
s_and_b32 s49, s49, 0xffff
s_sub_u32 s50, s50, 20480
s_cselect_b32 s50, 61440, s50
v_mfma_f32_16x16x32_bf16 v[196:199], a[116:119], a[84:87], v[196:199]
v_cvt_pk_bf16_f32 v163, v122, v123
v_cvt_pk_bf16_f32 v164, v124, v125
v_cvt_pk_bf16_f32 v165, v126, v127
s_add_u32 s95, s47, 2560
buffer_store_dwordx4 v[156:159], v1, s[20:23], s95 offen sc1
v_add_u32 v13, s49, v12
v_add_u32 v14, s50, v18
v_mfma_f32_16x16x32_bf16 v[196:199], a[192:195], a[88:91], v[196:199]
s_mov_b32 s44, s62
s_add_u32 s43, s66, s46
s_waitcnt vmcnt(22)
s_waitcnt lgkmcnt(0)
s_barrier
s_mov_b32 m0, s51
s_nop 0
buffer_load_dwordx4 v8, s[8:11], s42 offen offset:0 lds
v_mfma_f32_16x16x32_bf16 v[196:199], a[196:199], a[92:95], v[196:199]
ds_read_b64_tr_b16 a[120:121], v13 offset:0
ds_read_b64_tr_b16 a[122:123], v13 offset:2048
ds_read_b128 a[136:139], v14 offset:0
buffer_store_dwordx4 v[160:163], v1, s[20:23], s95 offen offset:1024 sc1
buffer_store_dwordx2 v[164:165], v17, s[20:23], s95 offen offset:2048 sc1
s_mov_b64 exec, s[96:97]
ds_write_b128 v56, v[156:159] offset:2560
ds_write_b128 v56, v[160:163] offset:3584
ds_write_b64 v57, v[164:165] offset:4608
s_mov_b64 exec, -1
v_mfma_f32_16x16x32_bf16 v[200:203], a[200:203], a[80:83], 0
ds_read_b64_tr_b16 a[124:125], v13 offset:4096
ds_read_b64_tr_b16 a[126:127], v13 offset:6144
v_cvt_pk_bf16_f32 v168, v216, v217
buffer_load_dwordx4 v9, s[8:11], s42 offen offset:1024 lds
v_cvt_pk_bf16_f32 v169, v218, v219
v_cvt_pk_bf16_f32 v170, v220, v221
v_mfma_f32_16x16x32_bf16 v[200:203], a[204:207], a[84:87], v[200:203]
ds_read_b128 a[140:143], v14 offset:5120
ds_read_b64_tr_b16 a[128:129], v13 offset:8192
v_cvt_pk_bf16_f32 v171, v222, v223
v_cvt_pk_bf16_f32 v172, v224, v225
v_mfma_f32_16x16x32_bf16 v[200:203], a[208:211], a[88:91], v[200:203]
ds_read_b64_tr_b16 a[130:131], v13 offset:10240
ds_read_b128 a[144:147], v14 offset:10240
buffer_load_dwordx4 v10, s[8:11], s42 offen offset:2048 lds
ds_read_b64_tr_b16 a[132:133], v13 offset:12288
v_cvt_pk_bf16_f32 v173, v226, v227
v_cvt_pk_bf16_f32 v174, v228, v229
v_cvt_pk_bf16_f32 v175, v230, v231
v_mfma_f32_16x16x32_bf16 v[200:203], a[212:215], a[92:95], v[200:203]
ds_read_b64_tr_b16 a[134:135], v13 offset:14336
ds_read_b128 a[148:151], v14 offset:15360
v_cvt_pk_bf16_f32 v176, v232, v233
v_cvt_pk_bf16_f32 v177, v234, v235
v_mfma_f32_16x16x32_bf16 v[204:207], a[216:219], a[80:83], 0
buffer_load_dwordx4 v11, s[8:11], s42 offen offset:3072 lds
ds_read_b128 a[152:155], v14 offset:1024
ds_read_b128 a[156:159], v14 offset:6144
s_add_u32 s95, s47, 5120
buffer_store_dwordx4 v[168:171], v1, s[20:23], s95 offen sc1
buffer_store_dwordx4 v[172:175], v1, s[20:23], s95 offen offset:1024 sc1
v_mfma_f32_16x16x32_bf16 v[204:207], a[220:223], a[84:87], v[204:207]
ds_read_b128 a[160:163], v14 offset:11264
ds_read_b128 a[164:167], v14 offset:16384
ds_read_b128 a[168:171], v14 offset:2048
buffer_store_dwordx2 v[176:177], v17, s[20:23], s95 offen offset:2048 sc1
s_mov_b64 exec, s[96:97]
ds_write_b128 v56, v[168:171] offset:5120
ds_write_b128 v56, v[172:175] offset:6144
ds_write_b64 v57, v[176:177] offset:7168
s_mov_b64 exec, -1
v_mfma_f32_16x16x32_bf16 v[204:207], a[224:227], a[88:91], v[204:207]
s_mov_b32 m0, s44
s_nop 0
buffer_load_dwordx4 v1, s[4:7], s43 offen offset:0 sc1 lds
ds_read_b128 a[172:175], v14 offset:7168
ds_read_b128 a[176:179], v14 offset:12288
v_cvt_pk_bf16_f32 v180, v236, v237
v_cvt_pk_bf16_f32 v181, v238, v239
v_cvt_pk_bf16_f32 v182, v240, v241
v_mfma_f32_16x16x32_bf16 v[204:207], a[228:231], a[92:95], v[204:207]
ds_read_b128 a[180:183], v14 offset:17408
ds_read_b128 a[184:187], v14 offset:3072
v_cvt_pk_bf16_f32 v183, v242, v243
v_cvt_pk_bf16_f32 v184, v244, v245
v_mfma_f32_16x16x32_bf16 v[208:211], a[232:235], a[80:83], 0
buffer_load_dwordx4 v1, s[4:7], s43 offen offset:1024 sc1 lds
ds_read_b128 a[188:191], v14 offset:8192
ds_read_b128 a[0:3], v14 offset:13312
ds_read_b128 a[4:7], v14 offset:18432
v_cvt_pk_bf16_f32 v185, v246, v247
v_cvt_pk_bf16_f32 v186, v248, v249
v_cvt_pk_bf16_f32 v187, v250, v251
v_mfma_f32_16x16x32_bf16 v[208:211], a[236:239], a[84:87], v[208:211]
ds_read_b128 a[8:11], v14 offset:4096
ds_read_b128 a[12:15], v14 offset:9216
v_cvt_pk_bf16_f32 v188, v252, v253
buffer_load_dwordx4 v1, s[4:7], s43 offen offset:2048 sc1 lds
v_cvt_pk_bf16_f32 v189, v254, v255
v_mfma_f32_16x16x32_bf16 v[208:211], a[240:243], a[88:91], v[208:211]
ds_read_b128 a[16:19], v14 offset:14336
ds_read_b128 a[20:23], v14 offset:19456
s_add_u32 s95, s47, 7680
buffer_store_dwordx4 v[180:183], v1, s[20:23], s95 offen sc1
buffer_store_dwordx4 v[184:187], v1, s[20:23], s95 offen offset:1024 sc1
v_mfma_f32_16x16x32_bf16 v[208:211], a[244:247], a[92:95], v[208:211]
buffer_store_dwordx2 v[188:189], v17, s[20:23], s95 offen offset:2048 sc1
s_mov_b64 exec, s[96:97]
ds_write_b128 v56, v[180:183] offset:7680
ds_write_b128 v56, v[184:187] offset:8704
ds_write_b64 v57, v[188:189] offset:9728
s_mov_b64 exec, -1
s_waitcnt lgkmcnt(15)
v_mfma_f32_16x16x32_bf16 v[192:195], a[136:139], a[120:123], v[192:195]
v_add_u32 v60, s40, v1
s_add_u32 s51, s49, s48
s_add_u32 s62, s50, s71
v_mfma_f32_16x16x32_bf16 v[192:195], a[140:143], a[124:127], v[192:195]
v_min_u32 v60, 1, v60
buffer_load_dwordx4 v1, s[4:7], s43 offen offset:3072 sc1 lds
s_and_b32 s63, s64, 15
s_lshr_b64 s[64:65], s[64:65], 4
v_mfma_f32_16x16x32_bf16 v[192:195], a[144:147], a[128:131], v[192:195]
s_mul_i32 s42, s63, 524288
s_mul_i32 s66, s63, 20480
v_mfma_f32_16x16x32_bf16 v[192:195], a[148:151], a[132:135], v[192:195]
v_lshlrev_b32 v60, 31, v60
s_add_u32 s42, s42, s45
s_add_u32 s49, s49, 16384
v_mfma_f32_16x16x32_bf16 v[196:199], a[152:155], a[120:123], v[196:199]
v_mov_b32 v61, s82
s_and_b32 s49, s49, 0xffff
s_add_u32 m0, s44, 4096
s_nop 0
buffer_load_dwordx4 v63, s[4:7], s43 offen sc1 lds
s_sub_u32 s50, s50, 20480
s_cselect_b32 s50, 61440, s50
v_mfma_f32_16x16x32_bf16 v[196:199], a[156:159], a[124:127], v[196:199]
v_add_u32 v13, s49, v12
v_add_u32 v14, s50, v18
v_mfma_f32_16x16x32_bf16 v[196:199], a[160:163], a[128:131], v[196:199]
s_mov_b32 s44, s62
s_add_u32 s43, s66, s46
s_waitcnt vmcnt(30)
s_waitcnt lgkmcnt(0)
s_barrier
s_mov_b32 m0, s51
s_nop 0
buffer_load_dwordx4 v8, s[8:11], s42 offen offset:0 lds
v_mfma_f32_16x16x32_bf16 v[196:199], a[164:167], a[132:135], v[196:199]
ds_read_b64_tr_b16 a[80:81], v13 offset:0
ds_read_b64_tr_b16 a[82:83], v13 offset:2048
ds_read_b128 a[96:99], v14 offset:0
s_mul_i32 s92, s40, 2560
v_mfma_f32_16x16x32_bf16 v[200:203], a[168:171], a[120:123], v[200:203]
ds_read_b64_tr_b16 a[84:85], v13 offset:4096
buffer_load_dwordx4 v9, s[8:11], s42 offen offset:1024 lds
ds_read_b64_tr_b16 a[86:87], v13 offset:6144
v_mfma_f32_16x16x32_bf16 v[200:203], a[172:175], a[124:127], v[200:203]
ds_read_b128 a[100:103], v14 offset:5120
ds_read_b64_tr_b16 a[88:89], v13 offset:8192
v_add_u32 v56, s92, v56
v_mfma_f32_16x16x32_bf16 v[200:203], a[176:179], a[128:131], v[200:203]
buffer_load_dwordx4 v10, s[8:11], s42 offen offset:2048 lds
ds_read_b64_tr_b16 a[90:91], v13 offset:10240
ds_read_b128 a[104:107], v14 offset:10240
ds_read_b64_tr_b16 a[92:93], v13 offset:12288
v_mfma_f32_16x16x32_bf16 v[200:203], a[180:183], a[132:135], v[200:203]
ds_read_b64_tr_b16 a[94:95], v13 offset:14336
ds_read_b128 a[108:111], v14 offset:15360
v_add_u32 v57, s92, v57
v_mfma_f32_16x16x32_bf16 v[204:207], a[184:187], a[120:123], v[204:207]
buffer_load_dwordx4 v11, s[8:11], s42 offen offset:3072 lds
ds_read_b128 a[112:115], v14 offset:1024
ds_read_b128 a[116:119], v14 offset:6144
v_mfma_f32_16x16x32_bf16 v[204:207], a[188:191], a[124:127], v[204:207]
ds_read_b128 a[192:195], v14 offset:11264
ds_read_b128 a[196:199], v14 offset:16384
ds_read_b128 a[200:203], v14 offset:2048
ds_read_b128 v[174:177], v56
s_mov_b32 m0, s44
s_nop 0
buffer_load_dwordx4 v1, s[4:7], s43 offen offset:0 sc1 lds
v_mfma_f32_16x16x32_bf16 v[204:207], a[0:3], a[128:131], v[204:207]
ds_read_b128 a[204:207], v14 offset:7168
ds_read_b128 a[208:211], v14 offset:12288
v_mfma_f32_16x16x32_bf16 v[204:207], a[4:7], a[132:135], v[204:207]
ds_read_b128 a[212:215], v14 offset:17408
ds_read_b128 a[216:219], v14 offset:3072
ds_read_b128 v[178:181], v56 offset:1024
buffer_load_dwordx4 v1, s[4:7], s43 offen offset:1024 sc1 lds
v_mfma_f32_16x16x32_bf16 v[208:211], a[8:11], a[120:123], v[208:211]
ds_read_b128 a[220:223], v14 offset:8192
ds_read_b128 a[224:227], v14 offset:13312
ds_read_b128 a[228:231], v14 offset:18432
v_mfma_f32_16x16x32_bf16 v[208:211], a[12:15], a[124:127], v[208:211]
ds_read_b128 a[232:235], v14 offset:4096
buffer_load_dwordx4 v1, s[4:7], s43 offen offset:2048 sc1 lds
ds_read_b128 a[236:239], v14 offset:9216
ds_read_b64 v[182:183], v57 offset:2048
v_mfma_f32_16x16x32_bf16 v[208:211], a[16:19], a[128:131], v[208:211]
ds_read_b128 a[240:243], v14 offset:14336
ds_read_b128 a[244:247], v14 offset:19456
v_mfma_f32_16x16x32_bf16 v[208:211], a[20:23], a[132:135], v[208:211]
s_mov_b32 s83, 3
.p2align 3
L_ga:
s_waitcnt lgkmcnt(15)
v_mfma_f32_16x16x32_bf16 v[192:195], a[96:99], a[80:83], v[192:195]
s_add_u32 s51, s49, s48
s_add_u32 s62, s50, s71
v_mfma_f32_16x16x32_bf16 v[192:195], a[100:103], a[84:87], v[192:195]
s_and_b32 s63, s64, 15
buffer_load_dwordx4 v1, s[4:7], s43 offen offset:3072 sc1 lds
s_lshr_b64 s[64:65], s[64:65], 4
v_mfma_f32_16x16x32_bf16 v[192:195], a[104:107], a[88:91], v[192:195]
s_mul_i32 s42, s63, 524288
s_mul_i32 s66, s63, 20480
v_mfma_f32_16x16x32_bf16 v[192:195], a[108:111], a[92:95], v[192:195]
s_add_u32 s42, s42, s45
s_add_u32 s49, s49, 16384
s_waitcnt lgkmcnt(12)
v_mfma_f32_16x16x32_bf16 v[196:199], a[112:115], a[80:83], v[196:199]
s_and_b32 s49, s49, 0xffff
s_sub_u32 s50, s50, 20480
s_cselect_b32 s50, 61440, s50
s_add_u32 m0, s44, 4096
s_nop 0
buffer_load_dwordx4 v63, s[4:7], s43 offen sc1 lds
v_mfma_f32_16x16x32_bf16 v[196:199], a[116:119], a[84:87], v[196:199]
v_add_u32 v13, s49, v12
v_add_u32 v14, s50, v18
v_mfma_f32_16x16x32_bf16 v[196:199], a[192:195], a[88:91], v[196:199]
s_mov_b32 s44, s62
s_add_u32 s43, s66, s46
s_waitcnt vmcnt(11)
s_waitcnt lgkmcnt(0)
s_barrier
buffer_store_dword v61, v60, s[56:59], s69 offen sc1
s_mov_b32 s69, 0x10000
s_mov_b32 m0, s51
s_nop 0
buffer_load_dwordx4 v8, s[8:11], s42 offen offset:0 lds
v_mfma_f32_16x16x32_bf16 v[196:199], a[196:199], a[92:95], v[196:199]
ds_read_b64_tr_b16 a[120:121], v13 offset:0
ds_read_b64_tr_b16 a[122:123], v13 offset:2048
ds_read_b128 a[136:139], v14 offset:0
v_mfma_f32_16x16x32_bf16 v[200:203], a[200:203], a[80:83], v[200:203]
ds_read_b64_tr_b16 a[124:125], v13 offset:4096
buffer_load_dwordx4 v9, s[8:11], s42 offen offset:1024 lds
ds_read_b64_tr_b16 a[126:127], v13 offset:6144
v_mfma_f32_16x16x32_bf16 v[200:203], a[204:207], a[84:87], v[200:203]
ds_read_b128 a[140:143], v14 offset:5120
ds_read_b64_tr_b16 a[128:129], v13 offset:8192
v_mfma_f32_16x16x32_bf16 v[200:203], a[208:211], a[88:91], v[200:203]
ds_read_b64_tr_b16 a[130:131], v13 offset:10240
buffer_load_dwordx4 v10, s[8:11], s42 offen offset:2048 lds
ds_read_b128 a[144:147], v14 offset:10240
ds_read_b64_tr_b16 a[132:133], v13 offset:12288
v_mfma_f32_16x16x32_bf16 v[200:203], a[212:215], a[92:95], v[200:203]
ds_read_b64_tr_b16 a[134:135], v13 offset:14336
ds_read_b128 a[148:151], v14 offset:15360
v_mfma_f32_16x16x32_bf16 v[204:207], a[216:219], a[80:83], v[204:207]
buffer_load_dwordx4 v11, s[8:11], s42 offen offset:3072 lds
ds_read_b128 a[152:155], v14 offset:1024
ds_read_b128 a[156:159], v14 offset:6144
v_mfma_f32_16x16x32_bf16 v[204:207], a[220:223], a[84:87], v[204:207]
ds_read_b128 a[160:163], v14 offset:11264
ds_read_b128 a[164:167], v14 offset:16384
ds_read_b128 a[168:171], v14 offset:2048
v_mfma_f32_16x16x32_bf16 v[204:207], a[224:227], a[88:91], v[204:207]
s_mov_b32 m0, s44
s_nop 0
buffer_load_dwordx4 v1, s[4:7], s43 offen offset:0 sc1 lds
ds_read_b128 a[172:175], v14 offset:7168
ds_read_b128 a[176:179], v14 offset:12288
v_mfma_f32_16x16x32_bf16 v[204:207], a[228:231], a[92:95], v[204:207]
ds_read_b128 a[180:183], v14 offset:17408
ds_read_b128 a[184:187], v14 offset:3072
buffer_load_dwordx4 v1, s[4:7], s43 offen offset:1024 sc1 lds
v_mfma_f32_16x16x32_bf16 v[208:211], a[232:235], a[80:83], v[208:211]
ds_read_b128 a[188:191], v14 offset:8192
ds_read_b128 a[0:3], v14 offset:13312
ds_read_b128 a[4:7], v14 offset:18432
v_mfma_f32_16x16x32_bf16 v[208:211], a[236:239], a[84:87], v[208:211]
ds_read_b128 a[8:11], v14 offset:4096
buffer_load_dwordx4 v1, s[4:7], s43 offen offset:2048 sc1 lds
ds_read_b128 a[12:15], v14 offset:9216
v_mfma_f32_16x16x32_bf16 v[208:211], a[240:243], a[88:91], v[208:211]
ds_read_b128 a[16:19], v14 offset:14336
ds_read_b128 a[20:23], v14 offset:19456
v_mfma_f32_16x16x32_bf16 v[208:211], a[244:247], a[92:95], v[208:211]
s_cmp_lg_u32 s83, 1
s_cbranch_scc1 L_np_p
buffer_load_dword v62, v15, s[56:59], 0 offen sc1
L_np_p:
s_waitcnt lgkmcnt(15)
v_mfma_f32_16x16x32_bf16 v[192:195], a[136:139], a[120:123], v[192:195]
s_add_u32 s51, s49, s48
s_add_u32 s62, s50, s71
v_mfma_f32_16x16x32_bf16 v[192:195], a[140:143], a[124:127], v[192:195]
buffer_load_dwordx4 v1, s[4:7], s43 offen offset:3072 sc1 lds
s_and_b32 s63, s64, 15
s_lshr_b64 s[64:65], s[64:65], 4
v_mfma_f32_16x16x32_bf16 v[192:195], a[144:147], a[128:131], v[192:195]
s_mul_i32 s42, s63, 524288
s_mul_i32 s66, s63, 20480
v_mfma_f32_16x16x32_bf16 v[192:195], a[148:151], a[132:135], v[192:195]
s_add_u32 s42, s42, s45
s_add_u32 s49, s49, 16384
s_waitcnt lgkmcnt(12)
v_mfma_f32_16x16x32_bf16 v[196:199], a[152:155], a[120:123], v[196:199]
s_and_b32 s49, s49, 0xffff
s_sub_u32 s50, s50, 20480
s_cselect_b32 s50, 61440, s50
s_add_u32 m0, s44, 4096
s_nop 0
buffer_load_dwordx4 v63, s[4:7], s43 offen sc1 lds
v_mfma_f32_16x16x32_bf16 v[196:199], a[156:159], a[124:127], v[196:199]
v_add_u32 v13, s49, v12
v_add_u32 v14, s50, v18
v_mfma_f32_16x16x32_bf16 v[196:199], a[160:163], a[128:131], v[196:199]
s_mov_b32 s44, s62
s_add_u32 s43, s66, s46
s_waitcnt vmcnt(19)
s_waitcnt lgkmcnt(0)
s_barrier
s_mov_b32 m0, s51
s_nop 0
buffer_load_dwordx4 v8, s[8:11], s42 offen offset:0 lds
v_mfma_f32_16x16x32_bf16 v[196:199], a[164:167], a[132:135], v[196:199]
ds_read_b64_tr_b16 a[80:81], v13 offset:0
ds_read_b64_tr_b16 a[82:83], v13 offset:2048
ds_read_b128 a[96:99], v14 offset:0
v_mfma_f32_16x16x32_bf16 v[200:203], a[168:171], a[120:123], v[200:203]
ds_read_b64_tr_b16 a[84:85], v13 offset:4096
buffer_load_dwordx4 v9, s[8:11], s42 offen offset:1024 lds
ds_read_b64_tr_b16 a[86:87], v13 offset:6144
v_mfma_f32_16x16x32_bf16 v[200:203], a[172:175], a[124:127], v[200:203]
ds_read_b128 a[100:103], v14 offset:5120
ds_read_b64_tr_b16 a[88:89], v13 offset:8192
v_mfma_f32_16x16x32_bf16 v[200:203], a[176:179], a[128:131], v[200:203]
ds_read_b64_tr_b16 a[90:91], v13 offset:10240
buffer_load_dwordx4 v10, s[8:11], s42 offen offset:2048 lds
ds_read_b128 a[104:107], v14 offset:10240
ds_read_b64_tr_b16 a[92:93], v13 offset:12288
v_mfma_f32_16x16x32_bf16 v[200:203], a[180:183], a[132:135], v[200:203]
ds_read_b64_tr_b16 a[94:95], v13 offset:14336
ds_read_b128 a[108:111], v14 offset:15360
v_mfma_f32_16x16x32_bf16 v[204:207], a[184:187], a[120:123], v[204:207]
buffer_load_dwordx4 v11, s[8:11], s42 offen offset:3072 lds
ds_read_b128 a[112:115], v14 offset:1024
ds_read_b128 a[116:119], v14 offset:6144
v_mfma_f32_16x16x32_bf16 v[204:207], a[188:191], a[124:127], v[204:207]
ds_read_b128 a[192:195], v14 offset:11264
ds_read_b128 a[196:199], v14 offset:16384
ds_read_b128 a[200:203], v14 offset:2048
v_mfma_f32_16x16x32_bf16 v[204:207], a[0:3], a[128:131], v[204:207]
s_mov_b32 m0, s44
s_nop 0
buffer_load_dwordx4 v1, s[4:7], s43 offen offset:0 sc1 lds
ds_read_b128 a[204:207], v14 offset:7168
ds_read_b128 a[208:211], v14 offset:12288
v_mfma_f32_16x16x32_bf16 v[204:207], a[4:7], a[132:135], v[204:207]
ds_read_b128 a[212:215], v14 offset:17408
ds_read_b128 a[216:219], v14 offset:3072
buffer_load_dwordx4 v1, s[4:7], s43 offen offset:1024 sc1 lds
v_mfma_f32_16x16x32_bf16 v[208:211], a[8:11], a[120:123], v[208:211]
ds_read_b128 a[220:223], v14 offset:8192
ds_read_b128 a[224:227], v14 offset:13312
ds_read_b128 a[228:231], v14 offset:18432
v_mfma_f32_16x16x32_bf16 v[208:211], a[12:15], a[124:127], v[208:211]
ds_read_b128 a[232:235], v14 offset:4096
buffer_load_dwordx4 v1, s[4:7], s43 offen offset:2048 sc1 lds
ds_read_b128 a[236:239], v14 offset:9216
v_mfma_f32_16x16x32_bf16 v[208:211], a[16:19], a[128:131], v[208:211]
ds_read_b128 a[240:243], v14 offset:14336
ds_read_b128 a[244:247], v14 offset:19456
v_mfma_f32_16x16x32_bf16 v[208:211], a[20:23], a[132:135], v[208:211]
s_sub_u32 s83, s83, 1
s_cmp_lg_u32 s83, 0
s_cbranch_scc1 L_ga
s_waitcnt lgkmcnt(15)
v_mfma_f32_16x16x32_bf16 v[192:195], a[96:99], a[80:83], v[192:195]
v_lshlrev_b32 v64, 16, v174
v_and_b32 v65, 0xffff0000, v174
v_lshlrev_b32 v66, 16, v175
v_and_b32 v67, 0xffff0000, v175
s_add_u32 s51, s49, s48
s_add_u32 s62, s50, s71
v_mfma_f32_16x16x32_bf16 v[192:195], a[100:103], a[84:87], v[192:195]
v_lshlrev_b32 v68, 16, v176
v_and_b32 v69, 0xffff0000, v176
buffer_load_dwordx4 v1, s[4:7], s43 offen offset:3072 sc1 lds
v_lshlrev_b32 v70, 16, v177
s_and_b32 s63, s64, 15
s_lshr_b64 s[64:65], s[64:65], 4
v_mfma_f32_16x16x32_bf16 v[192:195], a[104:107], a[88:91], v[192:195]
v_and_b32 v71, 0xffff0000, v177
v_lshlrev_b32 v72, 16, v178
v_and_b32 v73, 0xffff0000, v178
s_mul_i32 s42, s63, 524288
s_mul_i32 s66, s63, 20480
v_mfma_f32_16x16x32_bf16 v[192:195], a[108:111], a[92:95], v[192:195]
v_lshlrev_b32 v74, 16, v179
v_and_b32 v75, 0xffff0000, v179
v_lshlrev_b32 v76, 16, v180
v_and_b32 v77, 0xffff0000, v180
s_add_u32 s42, s42, s45
s_add_u32 s49, s49, 16384
s_waitcnt lgkmcnt(12)
v_mfma_f32_16x16x32_bf16 v[196:199], a[112:115], a[80:83], v[196:199]
v_lshlrev_b32 v78, 16, v181
v_and_b32 v79, 0xffff0000, v181
v_lshlrev_b32 v80, 16, v182
s_add_u32 m0, s44, 4096
s_nop 0
buffer_load_dwordx4 v63, s[4:7], s43 offen sc1 lds
s_and_b32 s49, s49, 0xffff
s_sub_u32 s50, s50, 20480
s_cselect_b32 s50, 61440, s50
v_mfma_f32_16x16x32_bf16 v[196:199], a[116:119], a[84:87], v[196:199]
v_and_b32 v81, 0xffff0000, v182
v_lshlrev_b32 v82, 16, v183
v_and_b32 v83, 0xffff0000, v183
v_add_u32 v13, s49, v12
v_add_u32 v14, s50, v18
v_mfma_f32_16x16x32_bf16 v[196:199], a[192:195], a[88:91], v[196:199]
s_mov_b32 s44, s62
s_add_u32 s43, s66, s46
s_waitcnt vmcnt(19)
s_waitcnt lgkmcnt(0)
s_barrier
s_mov_b32 m0, s51
s_nop 0
buffer_load_dwordx4 v8, s[8:11], s42 offen offset:0 lds
v_mfma_f32_16x16x32_bf16 v[196:199], a[196:199], a[92:95], v[196:199]
ds_read_b64_tr_b16 a[120:121], v13 offset:0
ds_read_b64_tr_b16 a[122:123], v13 offset:2048
ds_read_b128 a[136:139], v14 offset:0
v_mfma_f32_16x16x32_bf16 v[200:203], a[200:203], a[80:83], v[200:203]
ds_read_b64_tr_b16 a[124:125], v13 offset:4096
buffer_load_dwordx4 v9, s[8:11], s42 offen offset:1024 lds
ds_read_b64_tr_b16 a[126:127], v13 offset:6144
v_mfma_f32_16x16x32_bf16 v[200:203], a[204:207], a[84:87], v[200:203]
ds_read_b128 a[140:143], v14 offset:5120
ds_read_b64_tr_b16 a[128:129], v13 offset:8192
v_mfma_f32_16x16x32_bf16 v[200:203], a[208:211], a[88:91], v[200:203]
ds_read_b64_tr_b16 a[130:131], v13 offset:10240
buffer_load_dwordx4 v10, s[8:11], s42 offen offset:2048 lds
ds_read_b128 a[144:147], v14 offset:10240
ds_read_b64_tr_b16 a[132:133], v13 offset:12288
v_mfma_f32_16x16x32_bf16 v[200:203], a[212:215], a[92:95], v[200:203]
ds_read_b64_tr_b16 a[134:135], v13 offset:14336
ds_read_b128 a[148:151], v14 offset:15360
v_mfma_f32_16x16x32_bf16 v[204:207], a[216:219], a[80:83], v[204:207]
buffer_load_dwordx4 v11, s[8:11], s42 offen offset:3072 lds
ds_read_b128 a[152:155], v14 offset:1024
ds_read_b128 a[156:159], v14 offset:6144
v_mfma_f32_16x16x32_bf16 v[204:207], a[220:223], a[84:87], v[204:207]
ds_read_b128 a[160:163], v14 offset:11264
ds_read_b128 a[164:167], v14 offset:16384
ds_read_b128 a[168:171], v14 offset:2048
v_mfma_f32_16x16x32_bf16 v[204:207], a[224:227], a[88:91], v[204:207]
s_mov_b32 m0, s44
s_nop 0
buffer_load_dwordx4 v1, s[4:7], s43 offen offset:0 sc1 lds
ds_read_b128 a[172:175], v14 offset:7168
ds_read_b128 a[176:179], v14 offset:12288
v_mfma_f32_16x16x32_bf16 v[204:207], a[228:231], a[92:95], v[204:207]
ds_read_b128 a[180:183], v14 offset:17408
ds_read_b128 a[184:187], v14 offset:3072
buffer_load_dwordx4 v1, s[4:7], s43 offen offset:1024 sc1 lds
v_mfma_f32_16x16x32_bf16 v[208:211], a[232:235], a[80:83], v[208:211]
ds_read_b128 a[188:191], v14 offset:8192
ds_read_b128 a[0:3], v14 offset:13312
ds_read_b128 a[4:7], v14 offset:18432
v_mfma_f32_16x16x32_bf16 v[208:211], a[236:239], a[84:87], v[208:211]
ds_read_b128 a[8:11], v14 offset:4096
buffer_load_dwordx4 v1, s[4:7], s43 offen offset:2048 sc1 lds
ds_read_b128 a[12:15], v14 offset:9216
v_mfma_f32_16x16x32_bf16 v[208:211], a[240:243], a[88:91], v[208:211]
ds_read_b128 a[16:19], v14 offset:14336
ds_read_b128 a[20:23], v14 offset:19456
v_mfma_f32_16x16x32_bf16 v[208:211], a[244:247], a[92:95], v[208:211]
s_waitcnt lgkmcnt(15)
v_mfma_f32_16x16x32_bf16 v[192:195], a[136:139], a[120:123], v[192:195]
s_add_u32 s51, s49, s48
s_add_u32 s62, s50, s71
v_mfma_f32_16x16x32_bf16 v[192:195], a[140:143], a[124:127], v[192:195]
s_and_b32 s63, s64, 15
buffer_load_dwordx4 v1, s[4:7], s43 offen offset:3072 sc1 lds
s_lshr_b64 s[64:65], s[64:65], 4
v_mfma_f32_16x16x32_bf16 v[192:195], a[144:147], a[128:131], v[192:195]
s_mul_i32 s42, s63, 524288
s_mul_i32 s66, s63, 20480
v_mfma_f32_16x16x32_bf16 v[192:195], a[148:151], a[132:135], v[192:195]
s_add_u32 s42, s42, s45
s_add_u32 s49, s49, 16384
s_waitcnt lgkmcnt(12)
v_mfma_f32_16x16x32_bf16 v[196:199], a[152:155], a[120:123], v[196:199]
s_and_b32 s49, s49, 0xffff
s_sub_u32 s50, s50, 20480
s_cselect_b32 s50, 61440, s50
s_add_u32 m0, s44, 4096
s_nop 0
buffer_load_dwordx4 v63, s[4:7], s43 offen sc1 lds
v_mfma_f32_16x16x32_bf16 v[196:199], a[156:159], a[124:127], v[196:199]
v_add_u32 v13, s49, v12
v_add_u32 v14, s50, v18
v_mfma_f32_16x16x32_bf16 v[196:199], a[160:163], a[128:131], v[196:199]
s_mov_b32 s44, s62
s_add_u32 s43, s66, s46
s_waitcnt vmcnt(18)
s_waitcnt lgkmcnt(0)
s_barrier
v_cmp_ne_u32 vcc, s82, v62
s_nop 3
s_cbranch_vccnz L_spin_p
L_ok_p:
s_mov_b32 m0, s51
s_nop 0
buffer_load_dwordx4 v8, s[8:11], s42 offen offset:0 lds
v_mfma_f32_16x16x32_bf16 v[196:199], a[164:167], a[132:135], v[196:199]
ds_read_b64_tr_b16 a[80:81], v13 offset:0
ds_read_b64_tr_b16 a[82:83], v13 offset:2048
ds_read_b128 a[96:99], v14 offset:0
s_mul_i32 s47, s55, 40960
s_mul_i32 s92, s40, 2560
v_mfma_f32_16x16x32_bf16 v[200:203], a[168:171], a[120:123], v[200:203]
ds_read_b64_tr_b16 a[84:85], v13 offset:4096
ds_read_b64_tr_b16 a[86:87], v13 offset:6144
buffer_load_dwordx4 v9, s[8:11], s42 offen offset:1024 lds
s_add_u32 s47, s47, s92
s_add_u32 s95, s55, 1
v_mfma_f32_16x16x32_bf16 v[200:203], a[172:175], a[124:127], v[200:203]
ds_read_b128 a[100:103], v14 offset:5120
ds_read_b64_tr_b16 a[88:89], v13 offset:8192
s_and_b32 s95, s95, 3
s_mul_i32 s95, s95, 10240
v_mfma_f32_16x16x32_bf16 v[200:203], a[176:179], a[128:131], v[200:203]
ds_read_b64_tr_b16 a[90:91], v13 offset:10240
buffer_load_dwordx4 v10, s[8:11], s42 offen offset:2048 lds
ds_read_b128 a[104:107], v14 offset:10240
ds_read_b64_tr_b16 a[92:93], v13 offset:12288
s_add_u32 s95, s95, s47
buffer_load_dwordx4 v[144:147], v1, s[20:23], s95 offen offset:0 sc1
v_mfma_f32_16x16x32_bf16 v[200:203], a[180:183], a[132:135], v[200:203]
ds_read_b64_tr_b16 a[94:95], v13 offset:14336
ds_read_b128 a[108:111], v14 offset:15360
buffer_load_dwordx4 v[148:151], v1, s[20:23], s95 offen offset:1024 sc1
buffer_load_dwordx2 v[152:153], v17, s[20:23], s95 offen offset:2048 sc1
v_mfma_f32_16x16x32_bf16 v[204:207], a[184:187], a[120:123], v[204:207]
buffer_load_dwordx4 v11, s[8:11], s42 offen offset:3072 lds
ds_read_b128 a[112:115], v14 offset:1024
ds_read_b128 a[116:119], v14 offset:6144
s_add_u32 s95, s55, 2
s_and_b32 s95, s95, 3
v_mfma_f32_16x16x32_bf16 v[204:207], a[188:191], a[124:127], v[204:207]
ds_read_b128 a[192:195], v14 offset:11264
ds_read_b128 a[196:199], v14 offset:16384
ds_read_b128 a[200:203], v14 offset:2048
s_mul_i32 s95, s95, 10240
v_mfma_f32_16x16x32_bf16 v[204:207], a[0:3], a[128:131], v[204:207]
s_mov_b32 m0, s44
s_nop 0
buffer_load_dwordx4 v1, s[4:7], s43 offen offset:0 sc1 lds
ds_read_b128 a[204:207], v14 offset:7168
ds_read_b128 a[208:211], v14 offset:12288
s_add_u32 s95, s95, s47
buffer_load_dwordx4 v[154:157], v1, s[20:23], s95 offen offset:0 sc1
v_mfma_f32_16x16x32_bf16 v[204:207], a[4:7], a[132:135], v[204:207]
ds_read_b128 a[212:215], v14 offset:17408
ds_read_b128 a[216:219], v14 offset:3072
buffer_load_dwordx4 v[158:161], v1, s[20:23], s95 offen offset:1024 sc1
buffer_load_dwordx2 v[162:163], v17, s[20:23], s95 offen offset:2048 sc1
buffer_load_dwordx4 v1, s[4:7], s43 offen offset:1024 sc1 lds
v_mfma_f32_16x16x32_bf16 v[208:211], a[8:11], a[120:123], v[208:211]
ds_read_b128 a[220:223], v14 offset:8192
ds_read_b128 a[224:227], v14 offset:13312
ds_read_b128 a[228:231], v14 offset:18432
s_add_u32 s95, s55, 3
s_and_b32 s95, s95, 3
v_mfma_f32_16x16x32_bf16 v[208:211], a[12:15], a[124:127], v[208:211]
ds_read_b128 a[232:235], v14 offset:4096
ds_read_b128 a[236:239], v14 offset:9216
buffer_load_dwordx4 v1, s[4:7], s43 offen offset:2048 sc1 lds
s_mul_i32 s95, s95, 10240
s_add_u32 s95, s95, s47
v_mfma_f32_16x16x32_bf16 v[208:211], a[16:19], a[128:131], v[208:211]
ds_read_b128 a[240:243], v14 offset:14336
ds_read_b128 a[244:247], v14 offset:19456
buffer_load_dwordx4 v[164:167], v1, s[20:23], s95 offen offset:0 sc1
buffer_load_dwordx4 v[168:171], v1, s[20:23], s95 offen offset:1024 sc1
v_mfma_f32_16x16x32_bf16 v[208:211], a[20:23], a[132:135], v[208:211]
buffer_load_dwordx2 v[172:173], v17, s[20:23], s95 offen offset:2048 sc1
s_waitcnt lgkmcnt(15)
v_mfma_f32_16x16x32_bf16 v[192:195], a[96:99], a[80:83], v[192:195]
s_add_u32 s49, s49, 16384
v_mfma_f32_16x16x32_bf16 v[192:195], a[100:103], a[84:87], v[192:195]
buffer_load_dwordx4 v1, s[4:7], s43 offen offset:3072 sc1 lds
s_and_b32 s49, s49, 0xffff
v_mfma_f32_16x16x32_bf16 v[192:195], a[104:107], a[88:91], v[192:195]
v_mfma_f32_16x16x32_bf16 v[192:195], a[108:111], a[92:95], v[192:195]
s_sub_u32 s50, s50, 20480
s_cselect_b32 s50, 61440, s50
s_waitcnt lgkmcnt(12)
v_mfma_f32_16x16x32_bf16 v[196:199], a[112:115], a[80:83], v[196:199]
v_mfma_f32_16x16x32_bf16 v[196:199], a[116:119], a[84:87], v[196:199]
s_add_u32 m0, s44, 4096
s_nop 0
buffer_load_dwordx4 v63, s[4:7], s43 offen sc1 lds
v_add_u32 v13, s49, v12
v_add_u32 v14, s50, v18
v_mfma_f32_16x16x32_bf16 v[196:199], a[192:195], a[88:91], v[196:199]
s_waitcnt vmcnt(27)
s_waitcnt lgkmcnt(0)
s_barrier
v_mfma_f32_16x16x32_bf16 v[196:199], a[196:199], a[92:95], v[196:199]
ds_read_b64_tr_b16 a[120:121], v13 offset:0
ds_read_b64_tr_b16 a[122:123], v13 offset:2048
ds_read_b128 a[136:139], v14 offset:0
buffer_load_dwordx2 v[32:33], v21, s[24:27], 0 offen offset:0
v_mfma_f32_16x16x32_bf16 v[200:203], a[200:203], a[80:83], v[200:203]
ds_read_b64_tr_b16 a[124:125], v13 offset:4096
ds_read_b64_tr_b16 a[126:127], v13 offset:6144
v_mfma_f32_16x16x32_bf16 v[200:203], a[204:207], a[84:87], v[200:203]
ds_read_b128 a[140:143], v14 offset:5120
ds_read_b64_tr_b16 a[128:129], v13 offset:8192
buffer_load_dwordx2 v[34:35], v21, s[24:27], 0 offen offset:32
v_mfma_f32_16x16x32_bf16 v[200:203], a[208:211], a[88:91], v[200:203]
ds_read_b64_tr_b16 a[130:131], v13 offset:10240
ds_read_b128 a[144:147], v14 offset:10240
ds_read_b64_tr_b16 a[132:133], v13 offset:12288
v_mfma_f32_16x16x32_bf16 v[200:203], a[212:215], a[92:95], v[200:203]
ds_read_b64_tr_b16 a[134:135], v13 offset:14336
ds_read_b128 a[148:151], v14 offset:15360
buffer_load_dwordx2 v[36:37], v21, s[24:27], 0 offen offset:64
v_mfma_f32_16x16x32_bf16 v[204:207], a[216:219], a[80:83], v[204:207]
ds_read_b128 a[152:155], v14 offset:1024
ds_read_b128 a[156:159], v14 offset:6144
v_mfma_f32_16x16x32_bf16 v[204:207], a[220:223], a[84:87], v[204:207]
ds_read_b128 a[160:163], v14 offset:11264
ds_read_b128 a[164:167], v14 offset:16384
ds_read_b128 a[168:171], v14 offset:2048
buffer_load_dwordx2 v[38:39], v21, s[24:27], 0 offen offset:96
v_mfma_f32_16x16x32_bf16 v[204:207], a[224:227], a[88:91], v[204:207]
ds_read_b128 a[172:175], v14 offset:7168
ds_read_b128 a[176:179], v14 offset:12288
v_mfma_f32_16x16x32_bf16 v[204:207], a[228:231], a[92:95], v[204:207]
ds_read_b128 a[180:183], v14 offset:17408
ds_read_b128 a[184:187], v14 offset:3072
buffer_load_dwordx2 v[40:41], v21, s[24:27], 0 offen offset:128
v_mfma_f32_16x16x32_bf16 v[208:211], a[232:235], a[80:83], v[208:211]
ds_read_b128 a[188:191], v14 offset:8192
ds_read_b128 a[0:3], v14 offset:13312
ds_read_b128 a[4:7], v14 offset:18432
v_mfma_f32_16x16x32_bf16 v[208:211], a[236:239], a[84:87], v[208:211]
ds_read_b128 a[8:11], v14 offset:4096
ds_read_b128 a[12:15], v14 offset:9216
buffer_load_ushort v42, v16, s[28:31], 0 offen
v_mfma_f32_16x16x32_bf16 v[208:211], a[240:243], a[88:91], v[208:211]
ds_read_b128 a[16:19], v14 offset:14336
ds_read_b128 a[20:23], v14 offset:19456
v_mfma_f32_16x16x32_bf16 v[208:211], a[244:247], a[92:95], v[208:211]
s_waitcnt lgkmcnt(15)
v_mfma_f32_16x16x32_bf16 v[192:195], a[136:139], a[120:123], v[192:195]
s_add_u32 s49, s49, 16384
v_mfma_f32_16x16x32_bf16 v[192:195], a[140:143], a[124:127], v[192:195]
s_and_b32 s49, s49, 0xffff
v_mfma_f32_16x16x32_bf16 v[192:195], a[144:147], a[128:131], v[192:195]
v_mfma_f32_16x16x32_bf16 v[192:195], a[148:151], a[132:135], v[192:195]
s_sub_u32 s50, s50, 20480
s_cselect_b32 s50, 61440, s50
s_waitcnt lgkmcnt(12)
v_mfma_f32_16x16x32_bf16 v[196:199], a[152:155], a[120:123], v[196:199]
v_mfma_f32_16x16x32_bf16 v[196:199], a[156:159], a[124:127], v[196:199]
v_add_u32 v13, s49, v12
v_add_u32 v14, s50, v18
v_mfma_f32_16x16x32_bf16 v[196:199], a[160:163], a[128:131], v[196:199]
s_waitcnt vmcnt(24)
s_waitcnt lgkmcnt(0)
s_barrier
v_mfma_f32_16x16x32_bf16 v[196:199], a[164:167], a[132:135], v[196:199]
ds_read_b64_tr_b16 a[80:81], v13 offset:0
ds_read_b64_tr_b16 a[82:83], v13 offset:2048
ds_read_b128 a[96:99], v14 offset:0
v_mfma_f32_16x16x32_bf16 v[200:203], a[168:171], a[120:123], v[200:203]
ds_read_b64_tr_b16 a[84:85], v13 offset:4096
ds_read_b64_tr_b16 a[86:87], v13 offset:6144
v_mfma_f32_16x16x32_bf16 v[200:203], a[172:175], a[124:127], v[200:203]
ds_read_b128 a[100:103], v14 offset:5120
ds_read_b64_tr_b16 a[88:89], v13 offset:8192
v_mfma_f32_16x16x32_bf16 v[200:203], a[176:179], a[128:131], v[200:203]
ds_read_b64_tr_b16 a[90:91], v13 offset:10240
ds_read_b128 a[104:107], v14 offset:10240
ds_read_b64_tr_b16 a[92:93], v13 offset:12288
v_mfma_f32_16x16x32_bf16 v[200:203], a[180:183], a[132:135], v[200:203]
ds_read_b64_tr_b16 a[94:95], v13 offset:14336
ds_read_b128 a[108:111], v14 offset:15360
v_mfma_f32_16x16x32_bf16 v[204:207], a[184:187], a[120:123], v[204:207]
ds_read_b128 a[112:115], v14 offset:1024
ds_read_b128 a[116:119], v14 offset:6144
v_mfma_f32_16x16x32_bf16 v[204:207], a[188:191], a[124:127], v[204:207]
ds_read_b128 a[192:195], v14 offset:11264
ds_read_b128 a[196:199], v14 offset:16384
ds_read_b128 a[200:203], v14 offset:2048
v_mfma_f32_16x16x32_bf16 v[204:207], a[0:3], a[128:131], v[204:207]
ds_read_b128 a[204:207], v14 offset:7168
ds_read_b128 a[208:211], v14 offset:12288
v_mfma_f32_16x16x32_bf16 v[204:207], a[4:7], a[132:135], v[204:207]
ds_read_b128 a[212:215], v14 offset:17408
ds_read_b128 a[216:219], v14 offset:3072
v_mfma_f32_16x16x32_bf16 v[208:211], a[8:11], a[120:123], v[208:211]
ds_read_b128 a[220:223], v14 offset:8192
ds_read_b128 a[224:227], v14 offset:13312
ds_read_b128 a[228:231], v14 offset:18432
v_mfma_f32_16x16x32_bf16 v[208:211], a[12:15], a[124:127], v[208:211]
ds_read_b128 a[232:235], v14 offset:4096
ds_read_b128 a[236:239], v14 offset:9216
v_mfma_f32_16x16x32_bf16 v[208:211], a[16:19], a[128:131], v[208:211]
ds_read_b128 a[240:243], v14 offset:14336
ds_read_b128 a[244:247], v14 offset:19456
v_mfma_f32_16x16x32_bf16 v[208:211], a[20:23], a[132:135], v[208:211]
s_waitcnt lgkmcnt(15)
v_mfma_f32_16x16x32_bf16 v[192:195], a[96:99], a[80:83], v[192:195]
s_add_u32 s49, s49, 16384
v_mfma_f32_16x16x32_bf16 v[192:195], a[100:103], a[84:87], v[192:195]
s_and_b32 s49, s49, 0xffff
v_mfma_f32_16x16x32_bf16 v[192:195], a[104:107], a[88:91], v[192:195]
v_mfma_f32_16x16x32_bf16 v[192:195], a[108:111], a[92:95], v[192:195]
s_sub_u32 s50, s50, 20480
s_cselect_b32 s50, 61440, s50
s_waitcnt lgkmcnt(12)
v_mfma_f32_16x16x32_bf16 v[196:199], a[112:115], a[80:83], v[196:199]
v_mfma_f32_16x16x32_bf16 v[196:199], a[116:119], a[84:87], v[196:199]
v_add_u32 v13, s49, v12
v_add_u32 v14, s50, v18
v_mfma_f32_16x16x32_bf16 v[196:199], a[192:195], a[88:91], v[196:199]
s_waitcnt vmcnt(6)
s_waitcnt lgkmcnt(0)
s_barrier
v_mfma_f32_16x16x32_bf16 v[196:199], a[196:199], a[92:95], v[196:199]
ds_read_b64_tr_b16 a[120:121], v13 offset:0
ds_read_b64_tr_b16 a[122:123], v13 offset:2048
v_lshlrev_b32 v84, 16, v144
v_and_b32 v85, 0xffff0000, v144
v_lshlrev_b32 v86, 16, v145
v_and_b32 v87, 0xffff0000, v145
v_lshlrev_b32 v88, 16, v146
v_mfma_f32_16x16x32_bf16 v[200:203], a[200:203], a[80:83], v[200:203]
ds_read_b128 a[136:139], v14 offset:0
v_and_b32 v89, 0xffff0000, v146
v_lshlrev_b32 v90, 16, v147
v_and_b32 v91, 0xffff0000, v147
v_lshlrev_b32 v92, 16, v148
v_and_b32 v93, 0xffff0000, v148
v_mfma_f32_16x16x32_bf16 v[200:203], a[204:207], a[84:87], v[200:203]
ds_read_b64_tr_b16 a[124:125], v13 offset:4096
v_lshlrev_b32 v94, 16, v149
v_and_b32 v95, 0xffff0000, v149
v_lshlrev_b32 v96, 16, v150
v_and_b32 v97, 0xffff0000, v150
v_mfma_f32_16x16x32_bf16 v[200:203], a[208:211], a[88:91], v[200:203]
ds_read_b64_tr_b16 a[126:127], v13 offset:6144
v_lshlrev_b32 v98, 16, v151
v_and_b32 v99, 0xffff0000, v151
v_lshlrev_b32 v100, 16, v152
v_and_b32 v101, 0xffff0000, v152
v_lshlrev_b32 v102, 16, v153
v_mfma_f32_16x16x32_bf16 v[200:203], a[212:215], a[92:95], v[200:203]
ds_read_b128 a[140:143], v14 offset:5120
v_and_b32 v103, 0xffff0000, v153
v_pk_add_f32 v[64:65], v[64:65], v[84:85]
v_pk_add_f32 v[66:67], v[66:67], v[86:87]
v_pk_add_f32 v[68:69], v[68:69], v[88:89]
v_pk_add_f32 v[70:71], v[70:71], v[90:91]
v_mfma_f32_16x16x32_bf16 v[204:207], a[216:219], a[80:83], v[204:207]
ds_read_b128 a[152:155], v14 offset:1024
v_pk_add_f32 v[72:73], v[72:73], v[92:93]
v_pk_add_f32 v[74:75], v[74:75], v[94:95]
v_pk_add_f32 v[76:77], v[76:77], v[96:97]
v_pk_add_f32 v[78:79], v[78:79], v[98:99]
v_mfma_f32_16x16x32_bf16 v[204:207], a[220:223], a[84:87], v[204:207]
ds_read_b128 a[156:159], v14 offset:6144
ds_read_b128 a[168:171], v14 offset:2048
v_pk_add_f32 v[80:81], v[80:81], v[100:101]
v_pk_add_f32 v[82:83], v[82:83], v[102:103]
v_lshlrev_b32 v84, 16, v154
v_and_b32 v85, 0xffff0000, v154
v_lshlrev_b32 v86, 16, v155
v_mfma_f32_16x16x32_bf16 v[204:207], a[224:227], a[88:91], v[204:207]
ds_read_b128 a[172:175], v14 offset:7168
v_and_b32 v87, 0xffff0000, v155
v_lshlrev_b32 v88, 16, v156
v_and_b32 v89, 0xffff0000, v156
v_lshlrev_b32 v90, 16, v157
v_mfma_f32_16x16x32_bf16 v[204:207], a[228:231], a[92:95], v[204:207]
ds_read_b128 a[184:187], v14 offset:3072
v_and_b32 v91, 0xffff0000, v157
v_lshlrev_b32 v92, 16, v158
v_and_b32 v93, 0xffff0000, v158
v_lshlrev_b32 v94, 16, v159
v_and_b32 v95, 0xffff0000, v159
v_mfma_f32_16x16x32_bf16 v[208:211], a[232:235], a[80:83], v[208:211]
ds_read_b128 a[188:191], v14 offset:8192
v_lshlrev_b32 v96, 16, v160
v_and_b32 v97, 0xffff0000, v160
v_lshlrev_b32 v98, 16, v161
v_and_b32 v99, 0xffff0000, v161
v_lshlrev_b32 v100, 16, v162
v_mfma_f32_16x16x32_bf16 v[208:211], a[236:239], a[84:87], v[208:211]
ds_read_b128 a[8:11], v14 offset:4096
v_and_b32 v101, 0xffff0000, v162
v_lshlrev_b32 v102, 16, v163
v_and_b32 v103, 0xffff0000, v163
v_pk_add_f32 v[64:65], v[64:65], v[84:85]
v_mfma_f32_16x16x32_bf16 v[208:211], a[240:243], a[88:91], v[208:211]
ds_read_b128 a[12:15], v14 offset:9216
v_pk_add_f32 v[66:67], v[66:67], v[86:87]
v_pk_add_f32 v[68:69], v[68:69], v[88:89]
v_pk_add_f32 v[70:71], v[70:71], v[90:91]
v_pk_add_f32 v[72:73], v[72:73], v[92:93]
v_pk_add_f32 v[74:75], v[74:75], v[94:95]
v_mfma_f32_16x16x32_bf16 v[208:211], a[244:247], a[92:95], v[208:211]
v_pk_add_f32 v[76:77], v[76:77], v[96:97]
v_pk_add_f32 v[78:79], v[78:79], v[98:99]
v_pk_add_f32 v[80:81], v[80:81], v[100:101]
v_pk_add_f32 v[82:83], v[82:83], v[102:103]
s_waitcnt lgkmcnt(8)
v_mfma_f32_16x16x32_bf16 v[192:195], a[136:139], a[120:123], v[192:195]
v_lshlrev_b32 v84, 16, v164
v_and_b32 v85, 0xffff0000, v164
v_lshlrev_b32 v86, 16, v165
v_and_b32 v87, 0xffff0000, v165
v_lshlrev_b32 v88, 16, v166
v_mfma_f32_16x16x32_bf16 v[192:195], a[140:143], a[124:127], v[192:195]
v_and_b32 v89, 0xffff0000, v166
v_lshlrev_b32 v90, 16, v167
v_and_b32 v91, 0xffff0000, v167
v_lshlrev_b32 v92, 16, v168
v_and_b32 v93, 0xffff0000, v168
s_waitcnt lgkmcnt(6)
v_mfma_f32_16x16x32_bf16 v[196:199], a[152:155], a[120:123], v[196:199]
v_lshlrev_b32 v94, 16, v169
v_and_b32 v95, 0xffff0000, v169
v_lshlrev_b32 v96, 16, v170
v_and_b32 v97, 0xffff0000, v170
v_lshlrev_b32 v98, 16, v171
v_mfma_f32_16x16x32_bf16 v[196:199], a[156:159], a[124:127], v[196:199]
v_and_b32 v99, 0xffff0000, v171
v_lshlrev_b32 v100, 16, v172
v_and_b32 v101, 0xffff0000, v172
v_lshlrev_b32 v102, 16, v173
v_and_b32 v103, 0xffff0000, v173
s_waitcnt lgkmcnt(4)
v_mfma_f32_16x16x32_bf16 v[200:203], a[168:171], a[120:123], v[200:203]
v_pk_add_f32 v[64:65], v[64:65], v[84:85]
v_pk_add_f32 v[66:67], v[66:67], v[86:87]
v_pk_add_f32 v[68:69], v[68:69], v[88:89]
v_pk_add_f32 v[70:71], v[70:71], v[90:91]
v_pk_add_f32 v[72:73], v[72:73], v[92:93]
v_mfma_f32_16x16x32_bf16 v[200:203], a[172:175], a[124:127], v[200:203]
v_pk_add_f32 v[74:75], v[74:75], v[94:95]
v_pk_add_f32 v[76:77], v[76:77], v[96:97]
v_pk_add_f32 v[78:79], v[78:79], v[98:99]
v_pk_add_f32 v[80:81], v[80:81], v[100:101]
v_pk_add_f32 v[82:83], v[82:83], v[102:103]
s_waitcnt lgkmcnt(2)
v_mfma_f32_16x16x32_bf16 v[204:207], a[184:187], a[120:123], v[204:207]
v_mfma_f32_16x16x32_bf16 v[204:207], a[188:191], a[124:127], v[204:207]
s_waitcnt vmcnt(5)
v_lshlrev_b32 v112, 16, v32
v_and_b32 v113, 0xffff0000, v32
v_lshlrev_b32 v114, 16, v33
v_and_b32 v115, 0xffff0000, v33
s_waitcnt vmcnt(4)
v_lshlrev_b32 v116, 16, v34
v_and_b32 v117, 0xffff0000, v34
v_lshlrev_b32 v118, 16, v35
s_waitcnt lgkmcnt(0)
v_mfma_f32_16x16x32_bf16 v[208:211], a[8:11], a[120:123], v[208:211]
v_and_b32 v119, 0xffff0000, v35
s_waitcnt vmcnt(3)
v_lshlrev_b32 v120, 16, v36
v_and_b32 v121, 0xffff0000, v36
v_lshlrev_b32 v122, 16, v37
v_and_b32 v123, 0xffff0000, v37
s_waitcnt vmcnt(2)
v_lshlrev_b32 v124, 16, v38
v_and_b32 v125, 0xffff0000, v38
v_mfma_f32_16x16x32_bf16 v[208:211], a[12:15], a[124:127], v[208:211]
v_lshlrev_b32 v126, 16, v39
v_and_b32 v127, 0xffff0000, v39
s_waitcnt vmcnt(1)
v_lshlrev_b32 v128, 16, v40
v_and_b32 v129, 0xffff0000, v40
v_lshlrev_b32 v130, 16, v41
v_and_b32 v131, 0xffff0000, v41
s_waitcnt vmcnt(0)
v_lshlrev_b32 v42, 16, v42
v_pk_add_f32 v[192:193], v[192:193], v[42:43] op_sel_hi:[1,0]
v_pk_add_f32 v[194:195], v[194:195], v[42:43] op_sel_hi:[1,0]
v_pk_add_f32 v[196:197], v[196:197], v[42:43] op_sel_hi:[1,0]
v_pk_add_f32 v[198:199], v[198:199], v[42:43] op_sel_hi:[1,0]
v_pk_add_f32 v[200:201], v[200:201], v[42:43] op_sel_hi:[1,0]
v_pk_add_f32 v[202:203], v[202:203], v[42:43] op_sel_hi:[1,0]
v_pk_add_f32 v[204:205], v[204:205], v[42:43] op_sel_hi:[1,0]
v_pk_add_f32 v[206:207], v[206:207], v[42:43] op_sel_hi:[1,0]
v_pk_add_f32 v[208:209], v[208:209], v[42:43] op_sel_hi:[1,0]
v_pk_add_f32 v[210:211], v[210:211], v[42:43] op_sel_hi:[1,0]
s_mov_b32 s92, 0xbfb8aa3b
v_mul_f32 v84, s92, v192
v_mul_f32 v85, s92, v193
v_mul_f32 v86, s92, v194
v_mul_f32 v87, s92, v195
v_mul_f32 v88, s92, v196
v_mul_f32 v89, s92, v197
v_mul_f32 v90, s92, v198
v_mul_f32 v91, s92, v199
v_mul_f32 v92, s92, v200
v_mul_f32 v93, s92, v201
v_mul_f32 v94, s92, v202
v_mul_f32 v95, s92, v203
v_mul_f32 v96, s92, v204
v_mul_f32 v97, s92, v205
v_mul_f32 v98, s92, v206
v_mul_f32 v99, s92, v207
v_mul_f32 v100, s92, v208
v_mul_f32 v101, s92, v209
v_mul_f32 v102, s92, v210
v_mul_f32 v103, s92, v211
v_exp_f32 v84, v84
v_exp_f32 v85, v85
v_exp_f32 v86, v86
v_exp_f32 v87, v87
v_exp_f32 v88, v88
v_exp_f32 v89, v89
v_exp_f32 v90, v90
v_exp_f32 v91, v91
v_exp_f32 v92, v92
v_exp_f32 v93, v93
v_exp_f32 v94, v94
v_exp_f32 v95, v95
v_exp_f32 v96, v96
v_exp_f32 v97, v97
v_exp_f32 v98, v98
v_exp_f32 v99, v99
v_exp_f32 v100, v100
v_exp_f32 v101, v101
v_exp_f32 v102, v102
v_exp_f32 v103, v103
v_add_f32 v84, 1.0, v84
v_add_f32 v85, 1.0, v85
v_add_f32 v86, 1.0, v86
v_add_f32 v87, 1.0, v87
v_add_f32 v88, 1.0, v88
v_add_f32 v89, 1.0, v89
v_add_f32 v90, 1.0, v90
v_add_f32 v91, 1.0, v91
v_add_f32 v92, 1.0, v92
v_add_f32 v93, 1.0, v93
v_add_f32 v94, 1.0, v94
v_add_f32 v95, 1.0, v95
v_add_f32 v96, 1.0, v96
v_add_f32 v97, 1.0, v97
v_add_f32 v98, 1.0, v98
v_add_f32 v99, 1.0, v99
v_add_f32 v100, 1.0, v100
v_add_f32 v101, 1.0, v101
v_add_f32 v102, 1.0, v102
v_add_f32 v103, 1.0, v103
v_rcp_f32 v84, v84
v_rcp_f32 v85, v85
v_rcp_f32 v86, v86
v_rcp_f32 v87, v87
v_rcp_f32 v88, v88
v_rcp_f32 v89, v89
v_rcp_f32 v90, v90
v_rcp_f32 v91, v91
v_rcp_f32 v92, v92
v_rcp_f32 v93, v93
v_rcp_f32 v94, v94
v_rcp_f32 v95, v95
v_rcp_f32 v96, v96
v_rcp_f32 v97, v97
v_rcp_f32 v98, v98
v_rcp_f32 v99, v99
v_rcp_f32 v100, v100
v_rcp_f32 v101, v101
v_rcp_f32 v102, v102
v_rcp_f32 v103, v103
v_pk_mul_f32 v[64:65], v[64:65], v[192:193]
v_pk_mul_f32 v[66:67], v[66:67], v[194:195]
v_pk_mul_f32 v[68:69], v[68:69], v[196:197]
v_pk_mul_f32 v[70:71], v[70:71], v[198:199]
v_pk_mul_f32 v[72:73], v[72:73], v[200:201]
v_pk_mul_f32 v[74:75], v[74:75], v[202:203]
v_pk_mul_f32 v[76:77], v[76:77], v[204:205]
v_pk_mul_f32 v[78:79], v[78:79], v[206:207]
v_pk_mul_f32 v[80:81], v[80:81], v[208:209]
v_pk_mul_f32 v[82:83], v[82:83], v[210:211]
v_pk_fma_f32 v[112:113], v[64:65], v[84:85], v[112:113]
v_pk_fma_f32 v[114:115], v[66:67], v[86:87], v[114:115]
v_pk_fma_f32 v[116:117], v[68:69], v[88:89], v[116:117]
v_pk_fma_f32 v[118:119], v[70:71], v[90:91], v[118:119]
v_pk_fma_f32 v[120:121], v[72:73], v[92:93], v[120:121]
v_pk_fma_f32 v[122:123], v[74:75], v[94:95], v[122:123]
v_pk_fma_f32 v[124:125], v[76:77], v[96:97], v[124:125]
v_pk_fma_f32 v[126:127], v[78:79], v[98:99], v[126:127]
v_pk_fma_f32 v[128:129], v[80:81], v[100:101], v[128:129]
v_pk_fma_f32 v[130:131], v[82:83], v[102:103], v[130:131]
v_cvt_pk_bf16_f32 v64, v112, v113
v_cvt_pk_bf16_f32 v65, v114, v115
v_cvt_pk_bf16_f32 v66, v116, v117
v_cvt_pk_bf16_f32 v67, v118, v119
v_cvt_pk_bf16_f32 v68, v120, v121
v_cvt_pk_bf16_f32 v69, v122, v123
v_cvt_pk_bf16_f32 v70, v124, v125
v_cvt_pk_bf16_f32 v71, v126, v127
v_cvt_pk_bf16_f32 v72, v128, v129
v_cvt_pk_bf16_f32 v73, v130, v131
buffer_store_dwordx2 v[64:65], v21, s[36:39], 0 offen offset:0
buffer_store_dwordx2 v[66:67], v21, s[36:39], 0 offen offset:32
buffer_store_dwordx2 v[68:69], v21, s[36:39], 0 offen offset:64
buffer_store_dwordx2 v[70:71], v21, s[36:39], 0 offen offset:96
buffer_store_dwordx2 v[72:73], v21, s[36:39], 0 offen offset:128
L_done:
s_endpgm
L_at_retry:
s_waitcnt vmcnt(0) lgkmcnt(0)
s_mov_b32 s44, 1
s_mov_b32 s41, 0
s_mov_b32 m0, s50
s_mov_b32 s45, 0x1000000
s_mov_b32 s34, 0
s_mul_i32 s46, s40, 5120
s_add_u32 s71, s46, 81920
s_add_u32 s63, s91, s90
s_and_b32 s63, s63, 3
s_mov_b32 s64, 0x65832140
s_mov_b32 s65, 0xfedba9c7
s_cmp_eq_u32 s63, 1
s_cselect_b32 s64, 0x69432501, s64
s_cselect_b32 s65, 0xfecbad87, s65
s_cmp_eq_u32 s63, 2
s_cselect_b32 s64, 0xa5436102, s64
s_cselect_b32 s65, 0xfdcbe987, s65
s_cmp_eq_u32 s63, 3
s_cselect_b32 s64, 0x65472103, s64
s_cselect_b32 s65, 0xedcfa98b, s65
v_mov_b32 v56, 0xff800000
v_mov_b32 v57, 0xff800000
v_mov_b32 v58, 0xff800000
v_mov_b32 v59, 0xff800000
.p2align 3
L_at_maxpass:
s_barrier
buffer_load_dwordx4 v14, s[12:15], s41 offen offset:0 lds
buffer_load_dwordx4 v15, s[12:15], s41 offen offset:1024 lds
buffer_load_dwordx4 v16, s[12:15], s41 offen offset:2048 lds
buffer_load_dwordx4 v17, s[12:15], s41 offen offset:3072 lds
s_waitcnt vmcnt(0)
s_barrier
ds_read_b128 a[128:131], v2 offset:32768
ds_read_b128 a[132:135], v3 offset:32768
ds_read_b128 a[136:139], v4 offset:32768
ds_read_b128 a[140:143], v5 offset:32768
ds_read_b128 a[144:147], v2 offset:36864
ds_read_b128 a[148:151], v3 offset:36864
ds_read_b128 a[152:155], v4 offset:36864
ds_read_b128 a[156:159], v5 offset:36864
ds_read_b128 a[160:163], v2 offset:40960
ds_read_b128 a[164:167], v3 offset:40960
ds_read_b128 a[168:171], v4 offset:40960
ds_read_b128 a[172:175], v5 offset:40960
ds_read_b128 a[176:179], v2 offset:45056
ds_read_b128 a[180:183], v3 offset:45056
ds_read_b128 a[184:187], v4 offset:45056
ds_read_b128 a[188:191], v5 offset:45056
s_waitcnt lgkmcnt(8)
v_mfma_f32_16x16x32_bf16 v[64:67], a[128:131], v[192:195], 0
v_mfma_f32_16x16x32_bf16 v[64:67], a[132:135], v[196:199], v[64:67]
v_mfma_f32_16x16x32_bf16 v[64:67], a[136:139], v[200:203], v[64:67]
v_mfma_f32_16x16x32_bf16 v[64:67], a[140:143], v[204:207], v[64:67]
v_mfma_f32_16x16x32_bf16 v[68:71], a[128:131], v[208:211], 0
v_mfma_f32_16x16x32_bf16 v[68:71], a[132:135], v[212:215], v[68:71]
v_mfma_f32_16x16x32_bf16 v[68:71], a[136:139], v[216:219], v[68:71]
v_mfma_f32_16x16x32_bf16 v[68:71], a[140:143], v[220:223], v[68:71]
v_mfma_f32_16x16x32_bf16 v[72:75], a[128:131], v[224:227], 0
v_mfma_f32_16x16x32_bf16 v[72:75], a[132:135], v[228:231], v[72:75]
v_mfma_f32_16x16x32_bf16 v[72:75], a[136:139], v[232:235], v[72:75]
v_mfma_f32_16x16x32_bf16 v[72:75], a[140:143], v[236:239], v[72:75]
v_mfma_f32_16x16x32_bf16 v[76:79], a[128:131], v[240:243], 0
v_mfma_f32_16x16x32_bf16 v[76:79], a[132:135], v[244:247], v[76:79]
v_mfma_f32_16x16x32_bf16 v[76:79], a[136:139], v[248:251], v[76:79]
v_mfma_f32_16x16x32_bf16 v[76:79], a[140:143], v[252:255], v[76:79]
v_mfma_f32_16x16x32_bf16 v[80:83], a[144:147], v[192:195], 0
v_mfma_f32_16x16x32_bf16 v[80:83], a[148:151], v[196:199], v[80:83]
v_mfma_f32_16x16x32_bf16 v[80:83], a[152:155], v[200:203], v[80:83]
v_mfma_f32_16x16x32_bf16 v[80:83], a[156:159], v[204:207], v[80:83]
v_mfma_f32_16x16x32_bf16 v[84:87], a[144:147], v[208:211], 0
v_mfma_f32_16x16x32_bf16 v[84:87], a[148:151], v[212:215], v[84:87]
v_mfma_f32_16x16x32_bf16 v[84:87], a[152:155], v[216:219], v[84:87]
v_mfma_f32_16x16x32_bf16 v[84:87], a[156:159], v[220:223], v[84:87]
v_mfma_f32_16x16x32_bf16 v[88:91], a[144:147], v[224:227], 0
v_mfma_f32_16x16x32_bf16 v[88:91], a[148:151], v[228:231], v[88:91]
v_mfma_f32_16x16x32_bf16 v[88:91], a[152:155], v[232:235], v[88:91]
v_mfma_f32_16x16x32_bf16 v[88:91], a[156:159], v[236:239], v[88:91]
v_mfma_f32_16x16x32_bf16 v[92:95], a[144:147], v[240:243], 0
v_mfma_f32_16x16x32_bf16 v[92:95], a[148:151], v[244:247], v[92:95]
v_mfma_f32_16x16x32_bf16 v[92:95], a[152:155], v[248:251], v[92:95]
v_mfma_f32_16x16x32_bf16 v[92:95], a[156:159], v[252:255], v[92:95]
s_waitcnt lgkmcnt(0)
v_mfma_f32_16x16x32_bf16 v[96:99], a[160:163], v[192:195], 0
v_mfma_f32_16x16x32_bf16 v[96:99], a[164:167], v[196:199], v[96:99]
v_mfma_f32_16x16x32_bf16 v[96:99], a[168:171], v[200:203], v[96:99]
v_mfma_f32_16x16x32_bf16 v[96:99], a[172:175], v[204:207], v[96:99]
v_mfma_f32_16x16x32_bf16 v[100:103], a[160:163], v[208:211], 0
v_mfma_f32_16x16x32_bf16 v[100:103], a[164:167], v[212:215], v[100:103]
v_mfma_f32_16x16x32_bf16 v[100:103], a[168:171], v[216:219], v[100:103]
v_mfma_f32_16x16x32_bf16 v[100:103], a[172:175], v[220:223], v[100:103]
v_mfma_f32_16x16x32_bf16 v[104:107], a[160:163], v[224:227], 0
v_mfma_f32_16x16x32_bf16 v[104:107], a[164:167], v[228:231], v[104:107]
v_mfma_f32_16x16x32_bf16 v[104:107], a[168:171], v[232:235], v[104:107]
v_mfma_f32_16x16x32_bf16 v[104:107], a[172:175], v[236:239], v[104:107]
v_mfma_f32_16x16x32_bf16 v[108:111], a[160:163], v[240:243], 0
v_mfma_f32_16x16x32_bf16 v[108:111], a[164:167], v[244:247], v[108:111]
v_mfma_f32_16x16x32_bf16 v[108:111], a[168:171], v[248:251], v[108:111]
v_mfma_f32_16x16x32_bf16 v[108:111], a[172:175], v[252:255], v[108:111]
v_mfma_f32_16x16x32_bf16 v[112:115], a[176:179], v[192:195], 0
v_mfma_f32_16x16x32_bf16 v[112:115], a[180:183], v[196:199], v[112:115]
v_mfma_f32_16x16x32_bf16 v[112:115], a[184:187], v[200:203], v[112:115]
v_mfma_f32_16x16x32_bf16 v[112:115], a[188:191], v[204:207], v[112:115]
v_mfma_f32_16x16x32_bf16 v[116:119], a[176:179], v[208:211], 0
v_mfma_f32_16x16x32_bf16 v[116:119], a[180:183], v[212:215], v[116:119]
v_mfma_f32_16x16x32_bf16 v[116:119], a[184:187], v[216:219], v[116:119]
v_mfma_f32_16x16x32_bf16 v[116:119], a[188:191], v[220:223], v[116:119]
v_mfma_f32_16x16x32_bf16 v[120:123], a[176:179], v[224:227], 0
v_mfma_f32_16x16x32_bf16 v[120:123], a[180:183], v[228:231], v[120:123]
v_mfma_f32_16x16x32_bf16 v[120:123], a[184:187], v[232:235], v[120:123]
v_mfma_f32_16x16x32_bf16 v[120:123], a[188:191], v[236:239], v[120:123]
v_mfma_f32_16x16x32_bf16 v[124:127], a[176:179], v[240:243], 0
v_mfma_f32_16x16x32_bf16 v[124:127], a[180:183], v[244:247], v[124:127]
v_mfma_f32_16x16x32_bf16 v[124:127], a[184:187], v[248:251], v[124:127]
v_mfma_f32_16x16x32_bf16 v[124:127], a[188:191], v[252:255], v[124:127]
v_max3_f32 v56, v56, v64, v65
v_max3_f32 v57, v57, v68, v69
v_max3_f32 v58, v58, v72, v73
v_max3_f32 v59, v59, v76, v77
v_max3_f32 v56, v56, v66, v67
v_max3_f32 v57, v57, v70, v71
v_max3_f32 v58, v58, v74, v75
v_max3_f32 v59, v59, v78, v79
v_max3_f32 v56, v56, v80, v81
v_max3_f32 v57, v57, v84, v85
v_max3_f32 v58, v58, v88, v89
v_max3_f32 v59, v59, v92, v93
v_max3_f32 v56, v56, v82, v83
v_max3_f32 v57, v57, v86, v87
v_max3_f32 v58, v58, v90, v91
v_max3_f32 v59, v59, v94, v95
v_max3_f32 v56, v56, v96, v97
v_max3_f32 v57, v57, v100, v101
v_max3_f32 v58, v58, v104, v105
v_max3_f32 v59, v59, v108, v109
v_max3_f32 v56, v56, v98, v99
v_max3_f32 v57, v57, v102, v103
v_max3_f32 v58, v58, v106, v107
v_max3_f32 v59, v59, v110, v111
v_max3_f32 v56, v56, v112, v113
v_max3_f32 v57, v57, v116, v117
v_max3_f32 v58, v58, v120, v121
v_max3_f32 v59, v59, v124, v125
v_max3_f32 v56, v56, v114, v115
v_max3_f32 v57, v57, v118, v119
v_max3_f32 v58, v58, v122, v123
v_max3_f32 v59, v59, v126, v127
s_add_u32 s41, s41, 16384
s_cmp_lt_u32 s41, 524288
s_cbranch_scc1 L_at_maxpass
s_barrier
s_mov_b32 s42, 0
s_mov_b32 m0, s50
s_nop 0
buffer_load_dwordx4 v14, s[12:15], s42 offen offset:0 lds
buffer_load_dwordx4 v15, s[12:15], s42 offen offset:1024 lds
buffer_load_dwordx4 v16, s[12:15], s42 offen offset:2048 lds
buffer_load_dwordx4 v17, s[12:15], s42 offen offset:3072 lds
s_mov_b32 s42, 16384
s_mov_b32 m0, s51
s_nop 0
buffer_load_dwordx4 v14, s[12:15], s42 offen offset:0 lds
buffer_load_dwordx4 v15, s[12:15], s42 offen offset:1024 lds
buffer_load_dwordx4 v16, s[12:15], s42 offen offset:2048 lds
buffer_load_dwordx4 v17, s[12:15], s42 offen offset:3072 lds
s_mov_b32 s43, 32768
s_mov_b32 m0, s54
s_nop 0
buffer_load_dwordx4 v18, s[16:19], s43 offen offset:0 lds
buffer_load_dwordx4 v19, s[16:19], s43 offen offset:1024 lds
buffer_load_dwordx4 v18, s[16:19], s43 offen offset:2048 lds
buffer_load_dwordx4 v19, s[16:19], s43 offen offset:3072 lds
s_mov_b32 s42, 32768
s_mov_b32 m0, s48
s_nop 0
buffer_load_dwordx4 v14, s[12:15], s42 offen offset:0 lds
buffer_load_dwordx4 v15, s[12:15], s42 offen offset:1024 lds
buffer_load_dwordx4 v16, s[12:15], s42 offen offset:2048 lds
buffer_load_dwordx4 v17, s[12:15], s42 offen offset:3072 lds
s_mov_b32 s43, 49152
s_mov_b32 m0, s55
s_nop 0
buffer_load_dwordx4 v18, s[16:19], s43 offen offset:0 lds
buffer_load_dwordx4 v19, s[16:19], s43 offen offset:1024 lds
buffer_load_dwordx4 v18, s[16:19], s43 offen offset:2048 lds
buffer_load_dwordx4 v19, s[16:19], s43 offen offset:3072 lds
s_mov_b32 s42, 49152
s_mov_b32 m0, s49
s_nop 0
buffer_load_dwordx4 v14, s[12:15], s42 offen offset:0 lds
buffer_load_dwordx4 v15, s[12:15], s42 offen offset:1024 lds
buffer_load_dwordx4 v16, s[12:15], s42 offen offset:2048 lds
buffer_load_dwordx4 v17, s[12:15], s42 offen offset:3072 lds
s_waitcnt vmcnt(0)
s_barrier
ds_read_b128 a[128:131], v2 offset:32768
ds_read_b128 a[132:135], v3 offset:32768
ds_read_b128 a[136:139], v4 offset:32768
ds_read_b128 a[140:143], v5 offset:32768
ds_read_b128 a[144:147], v2 offset:36864
ds_read_b128 a[148:151], v3 offset:36864
ds_read_b128 a[152:155], v4 offset:36864
ds_read_b128 a[156:159], v5 offset:36864
ds_read_b128 a[160:163], v2 offset:40960
ds_read_b128 a[164:167], v3 offset:40960
ds_read_b128 a[168:171], v4 offset:40960
ds_read_b128 a[172:175], v5 offset:40960
ds_read_b128 a[176:179], v2 offset:45056
ds_read_b128 a[180:183], v3 offset:45056
ds_read_b128 a[184:187], v4 offset:45056
ds_read_b128 a[188:191], v5 offset:45056
v_accvgpr_write_b32 a0, 0
v_accvgpr_write_b32 a1, 0
v_accvgpr_write_b32 a2, 0
v_accvgpr_write_b32 a3, 0
v_accvgpr_write_b32 a4, 0
v_accvgpr_write_b32 a5, 0
v_accvgpr_write_b32 a6, 0
v_accvgpr_write_b32 a7, 0
v_accvgpr_write_b32 a8, 0
v_accvgpr_write_b32 a9, 0
v_accvgpr_write_b32 a10, 0
v_accvgpr_write_b32 a11, 0
v_accvgpr_write_b32 a12, 0
v_accvgpr_write_b32 a13, 0
v_accvgpr_write_b32 a14, 0
v_accvgpr_write_b32 a15, 0
v_accvgpr_write_b32 a16, 0
v_accvgpr_write_b32 a17, 0
v_accvgpr_write_b32 a18, 0
v_accvgpr_write_b32 a19, 0
v_accvgpr_write_b32 a20, 0
v_accvgpr_write_b32 a21, 0
v_accvgpr_write_b32 a22, 0
v_accvgpr_write_b32 a23, 0
v_accvgpr_write_b32 a24, 0
v_accvgpr_write_b32 a25, 0
v_accvgpr_write_b32 a26, 0
v_accvgpr_write_b32 a27, 0
v_accvgpr_write_b32 a28, 0
v_accvgpr_write_b32 a29, 0
v_accvgpr_write_b32 a30, 0
v_accvgpr_write_b32 a31, 0
v_accvgpr_write_b32 a32, 0
v_accvgpr_write_b32 a33, 0
v_accvgpr_write_b32 a34, 0
v_accvgpr_write_b32 a35, 0
v_accvgpr_write_b32 a36, 0
v_accvgpr_write_b32 a37, 0
v_accvgpr_write_b32 a38, 0
v_accvgpr_write_b32 a39, 0
v_accvgpr_write_b32 a40, 0
v_accvgpr_write_b32 a41, 0
v_accvgpr_write_b32 a42, 0
v_accvgpr_write_b32 a43, 0
v_accvgpr_write_b32 a44, 0
v_accvgpr_write_b32 a45, 0
v_accvgpr_write_b32 a46, 0
v_accvgpr_write_b32 a47, 0
v_accvgpr_write_b32 a48, 0
v_accvgpr_write_b32 a49, 0
v_accvgpr_write_b32 a50, 0
v_accvgpr_write_b32 a51, 0
v_accvgpr_write_b32 a52, 0
v_accvgpr_write_b32 a53, 0
v_accvgpr_write_b32 a54, 0
v_accvgpr_write_b32 a55, 0
v_accvgpr_write_b32 a56, 0
v_accvgpr_write_b32 a57, 0
v_accvgpr_write_b32 a58, 0
v_accvgpr_write_b32 a59, 0
v_accvgpr_write_b32 a60, 0
v_accvgpr_write_b32 a61, 0
v_accvgpr_write_b32 a62, 0
v_accvgpr_write_b32 a63, 0
v_accvgpr_write_b32 a64, 0
v_accvgpr_write_b32 a65, 0
v_accvgpr_write_b32 a66, 0
v_accvgpr_write_b32 a67, 0
v_accvgpr_write_b32 a68, 0
v_accvgpr_write_b32 a69, 0
v_accvgpr_write_b32 a70, 0
v_accvgpr_write_b32 a71, 0
v_accvgpr_write_b32 a72, 0
v_accvgpr_write_b32 a73, 0
v_accvgpr_write_b32 a74, 0
v_accvgpr_write_b32 a75, 0
v_accvgpr_write_b32 a76, 0
v_accvgpr_write_b32 a77, 0
v_accvgpr_write_b32 a78, 0
v_accvgpr_write_b32 a79, 0
v_accvgpr_write_b32 a80, 0
v_accvgpr_write_b32 a81, 0
v_accvgpr_write_b32 a82, 0
v_accvgpr_write_b32 a83, 0
v_accvgpr_write_b32 a84, 0
v_accvgpr_write_b32 a85, 0
v_accvgpr_write_b32 a86, 0
v_accvgpr_write_b32 a87, 0
v_accvgpr_write_b32 a88, 0
v_accvgpr_write_b32 a89, 0
v_accvgpr_write_b32 a90, 0
v_accvgpr_write_b32 a91, 0
v_accvgpr_write_b32 a92, 0
v_accvgpr_write_b32 a93, 0
v_accvgpr_write_b32 a94, 0
v_accvgpr_write_b32 a95, 0
v_accvgpr_write_b32 a96, 0
v_accvgpr_write_b32 a97, 0
v_accvgpr_write_b32 a98, 0
v_accvgpr_write_b32 a99, 0
v_accvgpr_write_b32 a100, 0
v_accvgpr_write_b32 a101, 0
v_accvgpr_write_b32 a102, 0
v_accvgpr_write_b32 a103, 0
v_accvgpr_write_b32 a104, 0
v_accvgpr_write_b32 a105, 0
v_accvgpr_write_b32 a106, 0
v_accvgpr_write_b32 a107, 0
v_accvgpr_write_b32 a108, 0
v_accvgpr_write_b32 a109, 0
v_accvgpr_write_b32 a110, 0
v_accvgpr_write_b32 a111, 0
v_accvgpr_write_b32 a112, 0
v_accvgpr_write_b32 a113, 0
v_accvgpr_write_b32 a114, 0
v_accvgpr_write_b32 a115, 0
v_accvgpr_write_b32 a116, 0
v_accvgpr_write_b32 a117, 0
v_accvgpr_write_b32 a118, 0
v_accvgpr_write_b32 a119, 0
v_accvgpr_write_b32 a120, 0
v_accvgpr_write_b32 a121, 0
v_accvgpr_write_b32 a122, 0
v_accvgpr_write_b32 a123, 0
v_accvgpr_write_b32 a124, 0
v_accvgpr_write_b32 a125, 0
v_accvgpr_write_b32 a126, 0
v_accvgpr_write_b32 a127, 0
v_mov_b32 v55, 0
v_mov_b32 v54, 0
v_mov_b32 v53, 0
v_mov_b32 v52, 0
v_mov_b32 v51, 0
v_mov_b32 v50, 0
v_mov_b32 v49, 0
v_mov_b32 v48, 0
v_mov_b32 v47, 0
v_mov_b32 v46, 0
v_mov_b32 v45, 0
v_mov_b32 v44, 0
v_mov_b32 v43, 0
v_mov_b32 v42, 0
v_mov_b32 v41, 0
v_mov_b32 v40, 0
s_waitcnt lgkmcnt(8)
v_mfma_f32_16x16x32_bf16 v[64:67], a[128:131], v[192:195], 0
v_mfma_f32_16x16x32_bf16 v[64:67], a[132:135], v[196:199], v[64:67]
v_mfma_f32_16x16x32_bf16 v[64:67], a[136:139], v[200:203], v[64:67]
v_mfma_f32_16x16x32_bf16 v[64:67], a[140:143], v[204:207], v[64:67]
v_mfma_f32_16x16x32_bf16 v[68:71], a[128:131], v[208:211], 0
v_mfma_f32_16x16x32_bf16 v[68:71], a[132:135], v[212:215], v[68:71]
v_mfma_f32_16x16x32_bf16 v[68:71], a[136:139], v[216:219], v[68:71]
v_mfma_f32_16x16x32_bf16 v[68:71], a[140:143], v[220:223], v[68:71]
v_mfma_f32_16x16x32_bf16 v[72:75], a[128:131], v[224:227], 0
v_mfma_f32_16x16x32_bf16 v[72:75], a[132:135], v[228:231], v[72:75]
v_mfma_f32_16x16x32_bf16 v[72:75], a[136:139], v[232:235], v[72:75]
v_mfma_f32_16x16x32_bf16 v[72:75], a[140:143], v[236:239], v[72:75]
v_mfma_f32_16x16x32_bf16 v[76:79], a[128:131], v[240:243], 0
v_mfma_f32_16x16x32_bf16 v[76:79], a[132:135], v[244:247], v[76:79]
v_mfma_f32_16x16x32_bf16 v[76:79], a[136:139], v[248:251], v[76:79]
v_mfma_f32_16x16x32_bf16 v[76:79], a[140:143], v[252:255], v[76:79]
s_waitcnt lgkmcnt(0)
s_nop 7
s_branch L_at_start
L_spin_x:
s_mov_b32 s70, 0
L_spin2_x:
s_sleep 4
buffer_load_dword v55, v54, s[56:59], 0 offen sc1
s_waitcnt vmcnt(0)
v_cmp_ne_u32 vcc, s82, v55
s_add_u32 s70, s70, 1
s_nop 2
s_cbranch_vccz L_ok_x
s_cmp_lt_u32 s70, 0x40000
s_cbranch_scc1 L_spin2_x
s_branch L_ok_x
L_spin_h:
s_mov_b32 s70, 0
L_spin2_h:
s_sleep 4
buffer_load_dwordx4 v[160:163], v164, s[56:59], 0 offen sc1
s_waitcnt vmcnt(0)
v_xor_b32 v160, s82, v160
v_xor_b32 v161, s82, v161
v_xor_b32 v162, s82, v162
v_xor_b32 v163, s82, v163
v_or_b32 v160, v160, v161
v_or3_b32 v160, v160, v162, v163
v_cmp_ne_u32 vcc, 0, v160
s_add_u32 s70, s70, 1
s_nop 2
s_cbranch_vccz L_ok_h
s_cmp_lt_u32 s70, 0x40000
s_cbranch_scc1 L_spin2_h
s_branch L_ok_h
L_spin_o:
s_mov_b32 s70, 0
L_spin2_o:
s_sleep 4
buffer_load_dword v156, v5, s[56:59], 0 offen sc1
s_waitcnt vmcnt(0)
v_cmp_ne_u32 vcc, s82, v156
s_add_u32 s70, s70, 1
s_nop 2
s_cbranch_vccz L_ok_o
s_cmp_lt_u32 s70, 0x40000
s_cbranch_scc1 L_spin2_o
s_branch L_ok_o
L_spin_l:
s_mov_b32 s70, 0
L_spin2_l:
s_sleep 4
buffer_load_dword v157, v6, s[56:59], 0 offen sc1
s_waitcnt vmcnt(0)
v_cmp_ne_u32 vcc, s82, v157
s_add_u32 s70, s70, 1
s_nop 2
s_cbranch_vccz L_ok_l
s_cmp_lt_u32 s70, 0x40000
s_cbranch_scc1 L_spin2_l
s_branch L_ok_l
L_spin_u:
s_mov_b32 s70, 0
L_spin2_u:
s_sleep 4
buffer_load_dword v62, v5, s[56:59], 0 offen sc1
s_waitcnt vmcnt(0)
v_cmp_ne_u32 vcc, s82, v62
s_add_u32 s70, s70, 1
s_nop 2
s_cbranch_vccz L_ok_u
s_cmp_lt_u32 s70, 0x40000
s_cbranch_scc1 L_spin2_u
s_branch L_ok_u
L_spin_p:
s_mov_b32 s70, 0
L_spin2_p:
s_sleep 4
buffer_load_dword v62, v15, s[56:59], 0 offen sc1
s_waitcnt vmcnt(0)
v_cmp_ne_u32 vcc, s82, v62
s_add_u32 s70, s70, 1
s_nop 2
s_cbranch_vccz L_ok_p
s_cmp_lt_u32 s70, 0x40000
s_cbranch_scc1 L_spin2_p
s_branch L_ok_p
L_end:
.section .rodata,"a"
.p2align 6
.amdhsa_kernel recurrent_scan__gqa_block_cached__mixer_token_mlp__prompt_kernel
  .amdhsa_next_free_vgpr 512
  .amdhsa_next_free_sgpr 102
  .amdhsa_accum_offset 256
  .amdhsa_group_segment_fixed_size 0
  .amdhsa_kernarg_size 104
  .amdhsa_user_sgpr_count 2
  .amdhsa_user_sgpr_kernarg_segment_ptr 1
  .amdhsa_system_sgpr_workgroup_id_x 1
.end_amdhsa_kernel
```
